```python
import torch

def _softmax(x, axis=-1):
    return torch.softmax(x, dim=axis)

def _gelu(x):
    return torch.nn.functional.gelu(x, approximate='tanh')

def _silu(x):
    return torch.nn.functional.silu(x)

def _sigmoid(x):
    return torch.sigmoid(x)

def _layernorm(x, axis=-1, eps=1e-05):
    m = x.mean(dim=axis, keepdim=True)
    v = x.var(dim=axis, keepdim=True, unbiased=False)
    return (x - m) / torch.sqrt(v + eps)

def _scatter_add(tgt, idx, src, axis=0):
    return tgt.clone().index_add_(axis, idx, src)

def _segment_sum(src, seg, n):
    out = torch.zeros((n,) + src.shape[1:], dtype=src.dtype)
    return out.index_add_(0, seg, src)

def _pad(x, pw):
    flat = tuple((v for pair in reversed(pw) for v in pair))
    return torch.nn.functional.pad(x, flat)
kernel_name = 'standalone__neighborhood_dinat__vision'

def setup_inputs():

    _w = lambda a: (lambda t: t.to(torch.bfloat16) if t.is_floating_point() else t)(torch.as_tensor(a))
    ks, dil, nh = (7, 2, 4)
    H = W = max(ks * dil, 224 // dil * dil)
    C = max(nh, 96 // nh * nh)
    return {'x': _w((lambda *s: torch.randn(*s, dtype=torch.bfloat16) * 0.4)(1, H, W, C)), 'wqkv': _w((lambda *s: torch.randn(*s, dtype=torch.bfloat16) * 0.4)(C, 3 * C)), 'wo': _w((lambda *s: torch.randn(*s, dtype=torch.bfloat16) * 0.4)(C, C)), 'rpb': _w((lambda *s: torch.randn(*s, dtype=torch.bfloat16) * 0.4)(nh, 2 * ks - 1, 2 * ks - 1))}

def reference(x, wqkv, wo, rpb):
    B, H, W, C = x.shape
    ks, dil, nh = (7, 2, 4)
    hd = C // nh
    scale = hd ** (-0.5)
    qkv = (x @ wqkv).reshape(B, H, W, 3, nh, hd)
    q = qkv[:, :, :, 0].clone()
    k = qkv[:, :, :, 1].clone()
    v = qkv[:, :, :, 2].clone()
    ih = torch.arange(H)
    iw = torch.arange(W)
    m = torch.arange(ks)
    sh = torch.clip(ih // dil - ks // 2, 0, H // dil - ks)
    sw = torch.clip(iw // dil - ks // 2, 0, W // dil - ks)
    kh = (sh[:, None] + m[None, :]) * dil + (ih % dil)[:, None]
    kw = (sw[:, None] + m[None, :]) * dil + (iw % dil)[:, None]
    rh = sh[:, None] + m[None, :] - (ih // dil)[:, None] + (ks - 1)
    rw = sw[:, None] + m[None, :] - (iw // dil)[:, None] + (ks - 1)
    ih4 = kh[:, :, None, None].clone()
    iw4 = kw[None, None, :, :].clone()
    kg = (lambda x, *d: x.permute(*d))(k[:, ih4, iw4, :, :], 0, 1, 3, 5, 2, 4, 6).reshape(B, H, W, nh, ks * ks, hd)
    vg = (lambda x, *d: x.permute(*d))(v[:, ih4, iw4, :, :], 0, 1, 3, 5, 2, 4, 6).reshape(B, H, W, nh, ks * ks, hd)
    bg = (lambda x, *d: x.permute(*d))(rpb[:, rh[:, :, None, None], rw[None, None, :, :]], 1, 3, 0, 2, 4).reshape(1, H, W, nh, ks * ks)
    logits = torch.einsum('bhwnd,bhwnkd->bhwnk', q, kg) * scale + bg
    attn = _softmax(logits, axis=-1)
    out = torch.einsum('bhwnk,bhwnkd->bhwnd', attn, vg).reshape(B, H, W, C)
    return out @ wo
```

```asm
; @launch grid=(256,1,1) block=(512,1,1) lds=163840
.amdgcn_target "amdgcn-amd-amdhsa--gfx950"
.text
.globl standalone__neighborhood_dinat__vision_kernel
.p2align 12
.p2align 8
.type standalone__neighborhood_dinat__vision_kernel,@function
standalone__neighborhood_dinat__vision_kernel:
    s_load_dwordx2 s[24:25], s[0:1], 24
    s_load_dwordx2 s[16:17], s[0:1], 0
    s_load_dwordx2 s[20:21], s[0:1], 8
    s_load_dwordx2 s[32:33], s[0:1], 16
    s_load_dwordx2 s[28:29], s[0:1], 32
    s_setprio 2
    s_cmp_ge_u32 s2, 256
    s_cbranch_scc1 L_end
    v_lshrrev_b32 v1, 6, v0
    v_and_b32 v152, 63, v0
    s_bfe_u32 s47, s2, 0x20004
    v_readfirstlane_b32 s36, v1
    s_and_b32 s57, s2, 4
    v_mul_u32_u24 v244, 43, v152
    s_or_b32 s47, s47, s57
    s_mul_i32 s41, s47, 14
    s_sub_u32 s41, s41, 3
    s_movk_i32 s43, 384
    s_movk_i32 s44, 111
    s_and_b32 s37, s36, 3
    s_mul_i32 s56, s37, 5
    s_lshr_b32 s46, s2, 6
    s_and_b32 s57, s2, 2
    v_lshrrev_b32 v244, 9, v244
    s_lshl1_add_u32 s46, s57, s46
    s_and_b32 s58, s2, 1
    v_mad_i32_i24 v245, v244, -12, v152
    s_bfe_u32 s59, s2, 0x10003
    s_mulk_i32 s59, 192
    v_add_u32 v244, s56, v244
    s_mov_b32 s38, 86016
    s_cmp_eq_u32 s46, 7
    v_xor_b32 v246, s36, v244
    s_cselect_b32 s45, 1, 0
    s_cselect_b32 s46, 0, s46
    v_add_u32 v244, s41, v244
    s_cselect_b32 s57, 222, 0
    s_cselect_b32 s38, -86016, s38
    v_lshrrev_b32 v246, 1, v246
    s_add_u32 s57, s57, s58
    s_mul_i32 s39, s57, 43008
    v_med3_i32 v244, v244, 0, s44
    s_add_u32 s39, s39, s59
    s_mul_i32 s40, s46, 14
    v_and_b32 v246, 2, v246
    s_sub_u32 s40, s40, 3
    s_mov_b32 s18, 9633792
    v_mul_u32_u24 v244, s43, v244
    s_mov_b32 s19, 0x00020000
    v_xor_b32 v245, v245, v246
    v_lshl_add_u32 v136, v245, 4, v244
    s_mul_i32 s42, s36, 960
    s_cmp_ge_u32 s36, 4
    s_cbranch_scc1 L_f1
    v_lshrrev_b32 v154, 4, v152
    v_lshrrev_b32 v155, 2, v152
    v_and_b32 v156, 3, v152
    s_mov_b32 s22, 55296
    s_mov_b32 s23, s19
    v_and_b32 v245, 2, v154
    v_mul_u32_u24 v244, 576, v155
    v_xor_b32 v245, v245, v156
    v_lshl_add_u32 v139, v245, 4, v244
    v_and_b32 v153, 15, v152
    s_mul_i32 s60, s37, 338
    s_cmp_eq_u32 s45, 1
    s_cselect_b32 s61, -26, 26
    s_cselect_b32 s62, 312, 0
    s_add_u32 s60, s60, s62
    s_movk_i32 s26, 1352
    s_mov_b32 s27, s19
    v_lshl_add_u32 v244, v153, 1, s60
    v_mad_i32_i24 v208, v154, s61, v244
    s_lshl_b32 s61, s61, 2
    v_add_u32 v209, s61, v208
    v_add_u32 v210, s61, v209
    v_add_u32 v211, s61, v210
    s_waitcnt lgkmcnt(0)
    buffer_load_ushort v208, v208, s[24:27], 0 offen
    buffer_load_ushort v209, v209, s[24:27], 0 offen
    buffer_load_ushort v210, v210, s[24:27], 0 offen
    buffer_load_ushort v211, v211, s[24:27], 0 offen
    s_and_b32 s56, s40, 7
    s_max_i32 s56, s56, s40
    s_mul_i32 s56, s56, s38
    v_xor_b32 v14, 32, v136
    s_add_u32 s56, s56, s39
    s_mov_b32 m0, s42
    s_mov_b32 exec_hi, 0x0fffffff
    s_waitcnt lgkmcnt(0)
    buffer_load_dwordx4 v136, s[16:19], s56 offen lds
    s_add_u32 m0, s42, 3840
    s_add_u32 s57, s56, s38
    buffer_load_dwordx4 v14, s[16:19], s57 offen lds
    s_add_u32 m0, s42, 7680
    s_add_u32 s58, s57, s38
    buffer_load_dwordx4 v136, s[16:19], s58 offen lds
    s_add_u32 s59, s40, 3
    s_mul_i32 s59, s59, s38
    s_add_u32 m0, s42, 11520
    s_add_u32 s59, s59, s39
    buffer_load_dwordx4 v14, s[16:19], s59 offen lds
    s_mov_b32 exec_hi, -1
    s_lshl_b32 s55, s37, 10
    s_mul_i32 s4, s37, 9216
    s_add_u32 m0, s55, 88896
    s_nop 0
    buffer_load_dwordx4 v139, s[20:23], s4 offen offset:192 lds
    s_add_u32 m0, s55, 94976
    s_nop 0
    buffer_load_dwordx4 v139, s[20:23], s4 offen offset:256 lds
    s_add_u32 m0, s55, 101056
    s_nop 0
    buffer_load_dwordx4 v139, s[20:23], s4 offen offset:320 lds
    s_setprio 0
    s_branch L_c1
L_f1:
    s_lshr_b32 s60, s2, 3
    s_lshl2_add_u32 s60, s60, s37
    s_lshl_b32 s60, s60, 7
    v_lshrrev_b32 v154, 4, v152
    v_lshrrev_b32 v155, 2, v152
    v_and_b32 v156, 3, v152
    s_mov_b32 s22, 55296
    s_mov_b32 s23, s19
    v_and_b32 v245, 2, v154
    v_mul_u32_u24 v244, 576, v155
    v_xor_b32 v245, v245, v156
    v_lshl_add_u32 v139, v245, 4, v244
    v_and_b32 v153, 15, v152
    s_mul_i32 s60, s37, 338
    s_cmp_eq_u32 s45, 1
    s_cselect_b32 s61, -26, 26
    s_cselect_b32 s62, 312, 0
    s_add_u32 s60, s60, s62
    s_movk_i32 s26, 1352
    s_mov_b32 s27, s19
    v_lshl_add_u32 v244, v153, 1, s60
    v_mad_i32_i24 v208, v154, s61, v244
    s_lshl_b32 s61, s61, 2
    v_add_u32 v209, s61, v208
    v_add_u32 v210, s61, v209
    v_add_u32 v211, s61, v210
    s_waitcnt lgkmcnt(0)
    buffer_load_ushort v208, v208, s[24:27], 0 offen
    buffer_load_ushort v209, v209, s[24:27], 0 offen
    buffer_load_ushort v210, v210, s[24:27], 0 offen
    buffer_load_ushort v211, v211, s[24:27], 0 offen
    s_load_dword s9, s[32:33], s60
    s_load_dword s8, s[20:21], s60
    s_add_u32 s60, s60, 16384
    s_load_dword s3, s[20:21], s60
    s_add_u32 s60, s60, 16384
    s_load_dword s6, s[20:21], s60
    s_add_u32 s60, s60, 16384
    s_min_u32 s60, s60, 55168
    s_load_dword s7, s[20:21], s60
    s_setprio 0
    s_mov_b64 exec, 0
    s_cmp_eq_u32 s37, 0
    s_cbranch_scc1 L_t4
    s_cmp_eq_u32 s37, 1
    s_cbranch_scc1 L_t5
    s_cmp_eq_u32 s37, 2
    s_cbranch_scc1 L_t6
    s_branch L_t7
L_back1:
    s_mov_b64 exec, -1
L_c1:
    s_lshr_b32 s57, s36, 2
    s_add_u32 s57, s57, s40
    s_add_u32 s57, s57, 2
    s_mul_i32 s48, s57, s38
    s_add_u32 s48, s48, s39
    s_mov_b32 s47, s39
    s_lshl_b32 s39, s38, 1
    s_mov_b32 s30, s18
    s_mov_b32 s31, s19
    s_movk_i32 s34, 18432
    s_mov_b32 s35, s19
    s_mov_b32 s61, 52224
    s_movk_i32 s62, 6144
    s_mul_i32 s63, s37, 3
    v_lshl_add_u32 v15, v154, 9, s61
    v_and_b32 v17, 12, v152
    v_lshl_add_u32 v15, v17, 4, v15
    v_lshrrev_b32 v161, 3, v152
    v_and_b32 v161, 2, v161
    v_lshrrev_b32 v16, 1, v156
    v_and_b32 v162, v16, v156
    v_add3_u32 v17, s63, v156, 12
    v_mad_u32_u24 v17, v162, 11, v17
    v_lshrrev_b32 v18, 2, v17
    v_mad_u32_u24 v132, v18, s62, v15
    v_xor_b32 v17, v17, v161
    v_xor_b32 v17, v17, v162
    v_and_b32 v17, 3, v17
    v_lshl_add_u32 v132, v17, 4, v132
    v_lshl_add_u32 v132, v16, 3, v132
    v_xor_b32 v133, 8, v132
    v_add3_u32 v20, s63, v16, 24
    v_lshrrev_b32 v21, 2, v20
    v_mad_u32_u24 v134, v21, s62, v15
    v_xor_b32 v20, v20, v161
    v_xor_b32 v20, 1, v20
    v_and_b32 v20, 3, v20
    v_lshl_add_u32 v134, v20, 4, v134
    v_and_b32 v19, 1, v156
    v_lshl_add_u32 v134, v19, 3, v134
    v_lshrrev_b32 v22, 1, v153
    v_and_b32 v22, 2, v22
    v_xor_b32 v22, v22, v154
    v_mul_u32_u24 v23, 192, v153
    v_lshl_add_u32 v0, v22, 4, v23
    s_mul_i32 s49, s37, 7936
    s_add_u32 s49, s49, 95296
    v_mul_u32_u24 v163, 1280, v154
    v_add_u32 v163, s49, v163
    v_lshl_add_u32 v1, v153, 4, v163
    v_mul_u32_u24 v23, 704, v154
    v_lshl_add_u32 v22, v153, 3, s49
    v_add_u32 v2, v22, v23
    s_mul_i32 s56, s45, 86016
    s_sub_u32 s48, s48, s56
    s_max_i32 s57, s41, 0
    s_add_u32 s58, s41, 20
    s_min_i32 s58, s58, s44
    s_sub_u32 s57, s57, s58
    s_mul_i32 s57, s57, s43
    s_add_u32 s57, s57, s38
    s_cmp_eq_u32 s37, 3
    s_cselect_b32 s57, s57, 0
    v_cmp_lt_u32 vcc, 59, v152
    v_mov_b32 v24, s57
    v_add_u32 v159, 4, v152
    v_cndmask_b32 v24, 0, v24, vcc
    v_add3_u32 v136, v136, v24, s56
    v_bfe_u32 v157, v159, 3, 1
    v_and_b32 v159, 7, v159
    v_min_u32 v158, 6, v159
    v_lshrrev_b32 v160, 1, v154
    v_and_b32 v160, v160, v154
    s_lshr_b32 s56, s36, 2
    s_mul_i32 s56, s56, 7
    s_add_u32 s56, s56, s41
    v_add_u32 v36, s56, v158
    v_max_i32 v36, 0, v36
    v_min_i32 v36, 105, v36
    v_subrev_u32 v33, s56, v36
    v_sub_u32 v36, v159, v158
    v_lshl_add_u32 v33, v36, 6, v33
    s_lshl_b32 s5, s36, 10
    s_add_u32 s5, s5, 56320
    s_add_u32 s59, s5, 192
    v_lshlrev_b32 v36, 6, v157
    v_sub_u32 v34, s59, v36
    v_sub_u32 v35, 3, v158
    v_mov_b32 v91, 0xff800000
    v_mov_b32 v37, 0x6408640c
    v_sub_u32 v38, v154, v160
    v_lshl_add_u32 v39, v160, 6, v34
    v_lshlrev_b32 v25, 2, v154
    v_sub_u32 v40, v25, v33
    v_add_u32 v25, v25, v35
    v_cmp_gt_u32 s[64:65], 7, v40
    v_lshl_add_u32 v26, v38, 2, 1
    v_sub_u32 v41, v26, v33
    v_cndmask_b32 v25, 13, v25, s[64:65]
    v_lshl_add_u32 v25, v25, 2, v34
    v_add_u32 v26, v26, v35
    v_cmp_gt_u32 s[66:67], 7, v41
    v_lshl_add_u32 v27, v38, 2, 2
    v_sub_u32 v42, v27, v33
    v_cndmask_b32 v26, 13, v26, s[66:67]
    v_lshl_add_u32 v26, v26, 2, v39
    v_add_u32 v27, v27, v35
    v_cmp_gt_u32 s[68:69], 7, v42
    v_lshl_add_u32 v28, v38, 2, 3
    v_sub_u32 v43, v28, v33
    v_cndmask_b32 v27, 13, v27, s[68:69]
    v_lshl_add_u32 v27, v27, 2, v39
    v_add_u32 v28, v28, v35
    v_cmp_gt_u32 s[70:71], 7, v43
    v_lshl_add_u32 v29, v154, 1, 0
    v_sub_u32 v44, v29, v33
    v_cndmask_b32 v28, 13, v28, s[70:71]
    v_lshl_add_u32 v28, v28, 2, v39
    v_add_u32 v29, v29, v35
    v_cmp_gt_u32 s[64:65], 7, v44
    v_lshl_add_u32 v30, v154, 1, 1
    v_sub_u32 v45, v30, v33
    v_cndmask_b32 v29, 13, v29, s[64:65]
    v_lshl_add_u32 v29, v29, 2, v34
    v_add_u32 v30, v30, v35
    v_cmp_gt_u32 s[66:67], 7, v45
    v_lshlrev_b32 v46, 3, v154
    v_bfe_u32 v31, v37, v46, 8
    v_cndmask_b32 v30, 13, v30, s[66:67]
    v_lshl_add_u32 v30, v30, 2, v34
    v_sub_u32 v46, v31, v33
    v_add_u32 v31, v31, v35
    v_cmp_gt_u32 s[68:69], 7, v46
    s_nop 1
    v_cndmask_b32 v31, 13, v31, s[68:69]
    v_lshl_add_u32 v31, v31, 2, v34
    s_cmp_ge_u32 s36, 4
    s_cbranch_scc1 L_o1
L_p1:
    s_lshl_b32 s55, s37, 10
    s_mul_i32 s4, s37, 9216
    s_and_b32 s56, s37, 1
    s_add_u32 s56, s56, 4
    s_lshl_b32 s58, s56, 10
    s_mul_i32 s59, s56, 9216
    s_and_b32 s56, s37, 2
    s_lshl_b32 s57, s56, 3
    v_xor_b32 v13, s57, v139
    s_mul_i32 s57, s56, 96
    s_add_u32 s57, s57, s59
    s_mul_i32 s56, s56, 9216
    s_add_u32 s58, s58, s56
    v_xor_b32 v12, 16, v139
    s_add_u32 m0, s55, 107136
    s_nop 0
    buffer_load_dwordx4 v12, s[20:23], s4 offen offset:384 lds
    s_add_u32 m0, s55, 113216
    s_nop 0
    buffer_load_dwordx4 v12, s[20:23], s4 offen offset:448 lds
    s_add_u32 m0, s55, 119296
    s_nop 0
    buffer_load_dwordx4 v12, s[20:23], s4 offen offset:512 lds
    s_add_u32 m0, s58, 88896
    s_nop 0
    buffer_load_dwordx4 v13, s[20:23], s57 offen offset:192 lds
    s_add_u32 m0, s58, 94976
    s_nop 0
    buffer_load_dwordx4 v13, s[20:23], s57 offen offset:256 lds
    s_add_u32 m0, s58, 101056
    s_nop 0
    buffer_load_dwordx4 v13, s[20:23], s57 offen offset:320 lds
    s_waitcnt vmcnt(16)
    v_lshlrev_b32 v208, 16, v208
    s_waitcnt vmcnt(15)
    v_lshlrev_b32 v209, 16, v209
    s_waitcnt vmcnt(14)
    v_lshlrev_b32 v210, 16, v210
    s_waitcnt vmcnt(13)
    v_lshlrev_b32 v211, 16, v211
    s_branch L_c2
L_o1:
    s_waitcnt vmcnt(3)
    v_lshlrev_b32 v208, 16, v208
    s_waitcnt vmcnt(2)
    v_lshlrev_b32 v209, 16, v209
    s_waitcnt vmcnt(1)
    v_lshlrev_b32 v210, 16, v210
    s_waitcnt vmcnt(0)
    v_lshlrev_b32 v211, 16, v211
L_c2:
    v_lshl_add_u32 v32, v152, 2, s5
    v_cmp_gt_u32 vcc, 13, v153
    v_mul_f32 v208, 0x3fb8aa3b, v208
    v_mul_f32 v209, 0x3fb8aa3b, v209
    v_cndmask_b32 v208, v91, v208, vcc
    v_cndmask_b32 v209, v91, v209, vcc
    v_mul_f32 v210, 0x3fb8aa3b, v210
    v_cndmask_b32 v210, v91, v210, vcc
    v_mul_f32 v211, 0x3fb8aa3b, v211
    v_cndmask_b32 v211, v91, v211, vcc
    ds_write_b32 v32, v208
    ds_write_b32 v32, v209 offset:256
    ds_write_b32 v32, v210 offset:512
    ds_write_b32 v32, v211 offset:768
    ds_read_b32 v164, v25 offset:512
    ds_read_b32 v165, v26 offset:512
    ds_read_b32 v166, v27 offset:512
    ds_read_b32 v167, v28 offset:512
    ds_read_b32 v168, v29 offset:576
    ds_read_b32 v169, v30 offset:576
    ds_read_b32 v170, v31 offset:576
    ds_read_b32 v84, v25
    ds_read_b32 v85, v26
    ds_read_b32 v86, v27
    ds_read_b32 v87, v28
    ds_read_b32 v88, v29 offset:64
    ds_read_b32 v89, v30 offset:64
    ds_read_b32 v90, v31 offset:64
    ds_read_b32 v92, v25 offset:128
    ds_read_b32 v93, v26 offset:128
    ds_read_b32 v94, v27 offset:128
    ds_read_b32 v95, v28 offset:128
    ds_read_b32 v96, v29 offset:192
    ds_read_b32 v97, v30 offset:192
    ds_read_b32 v98, v31 offset:192
    ds_read_b32 v100, v25 offset:256
    ds_read_b32 v101, v26 offset:256
    ds_read_b32 v102, v27 offset:256
    ds_read_b32 v103, v28 offset:256
    ds_read_b32 v104, v29 offset:320
    ds_read_b32 v105, v30 offset:320
    ds_read_b32 v106, v31 offset:320
    ds_read_b32 v108, v25 offset:384
    ds_read_b32 v109, v26 offset:384
    ds_read_b32 v110, v27 offset:384
    ds_read_b32 v111, v28 offset:384
    ds_read_b32 v112, v29 offset:448
    ds_read_b32 v113, v30 offset:448
    ds_read_b32 v114, v31 offset:448
    s_cmp_ge_u32 s36, 4
    s_cbranch_scc1 L_o2
L_p2:
    s_add_u32 s48, s48, s39
    s_add_u32 m0, s42, 15360
    s_nop 0
    buffer_load_dwordx4 v136, s[16:19], s48 offen lds
    s_add_u32 s48, s48, s39
    s_add_u32 m0, s42, 23040
    s_nop 0
    buffer_load_dwordx4 v136, s[16:19], s48 offen lds
    s_mov_b64 exec, 0
    s_cmp_eq_u32 s37, 0
    s_cbranch_scc1 L_t0
    s_cmp_eq_u32 s37, 1
    s_cbranch_scc1 L_t1
    s_cmp_eq_u32 s37, 2
    s_cbranch_scc1 L_t2
    s_branch L_t3
L_t2:
L_t3:
L_back0:
    s_mov_b64 exec, -1
    v_mov_b32 v47, 0x01201514
    v_mov_b32 v220, 0x03021716
    v_mov_b32 v221, 0x1d1c1918
    v_mov_b32 v222, 0x1f1e1b1a
    v_add_u32 v223, 3, v153
    v_and_b32 v223, 16, v223
    v_add_u32 v223, v223, v153
    v_and_b32 v225, 7, v153
    v_or_b32 v225, 0x0c0c0c00, v225
    v_cmp_gt_u32 s[70:71], 8, v153
    v_perm_b32 v226, v220, v47, v225
    v_perm_b32 v224, v222, v221, v225
    v_cndmask_b32 v224, v224, v226, s[70:71]
    v_lshl_add_u32 v3, v223, 4, v163
    v_lshl_add_u32 v4, v224, 4, v163
    v_add_u32 v227, 3, v155
    v_and_b32 v227, 16, v227
    v_add_u32 v227, v227, v155
    v_and_b32 v229, 7, v155
    v_or_b32 v229, 0x0c0c0c00, v229
    v_cmp_gt_u32 s[64:65], 8, v155
    v_perm_b32 v230, v220, v47, v229
    v_perm_b32 v228, v222, v221, v229
    v_cndmask_b32 v228, v228, v230, s[64:65]
    v_mul_u32_u24 v233, 704, v156
    v_add_u32 v233, s49, v233
    v_lshl_add_u32 v5, v227, 3, v233
    v_lshl_add_u32 v6, v228, 3, v233
    s_add_u32 s56, s49, 3840
    v_lshl_add_u32 v231, v156, 3, s56
    v_cmp_gt_u32 s[66:67], 2, v156
    v_lshl_add_u32 v7, v227, 4, v231
    v_lshl_add_u32 v8, v228, 4, v231
    v_mov_b32 v232, 127040
    v_cndmask_b32 v7, v232, v7, s[66:67]
    v_cndmask_b32 v8, v232, v8, s[66:67]
    v_mov_b32 v220, 0x3f803f80
    v_mov_b32 v221, 0x3f803f80
    v_mov_b32 v9, 0
    s_movk_i32 s61, -18432
    v_mad_i32_i24 v135, v162, s61, v132
    v_xor_b32 v137, 8, v135
    v_mad_u32_u24 v234, v157, 20, v158
    v_add_u32 v234, 63, v234
    v_lshrrev_b32 v235, 1, v234
    v_and_b32 v235, 2, v235
    v_xor_b32 v235, v235, v154
    v_mul_u32_u24 v236, 192, v234
    v_lshl_add_u32 v11, v235, 4, v236
    v_sub_u32 v10, v159, v158
    v_or_b32 v10, v10, v160
    v_add_u32 v10, -1, v10
    v_and_b32 v10, 0x3e96c740, v10
    ds_write_b64 v232, v[220:221]
    ds_write_b64 v232, v[220:221] offset:640
    ds_write_b64 v232, v[220:221] offset:32400
    ds_write_b64 v232, v[220:221] offset:33040
    s_branch L_m0
L_o2:
    s_add_u32 s48, s48, s39
    s_add_u32 m0, s42, 15360
    s_nop 0
    buffer_load_dwordx4 v136, s[16:19], s48 offen lds
    s_add_u32 s48, s48, s39
    s_add_u32 m0, s42, 23040
    s_nop 0
    buffer_load_dwordx4 v136, s[16:19], s48 offen lds
    s_branch L_m1
.p2align 12
L_t4:
    s_cbranch_execz L_back1
L_m0:
    s_waitcnt vmcnt(2)
    s_barrier
    s_mov_b32 s66, 0x0ff00ff0
    s_waitcnt lgkmcnt(15)
    ds_read_b128 v[220:223], v0
    ds_read_b64_tr_b16 v[14:15], v132 offset:18688
    s_add_u32 m0, s55, 70656
    s_nop 0
    buffer_load_dwordx4 v139, s[20:23], s4 offen lds
    ds_read_b64_tr_b16 v[30:31], v133 offset:20736
    s_waitcnt lgkmcnt(2)
    ds_read_b64_tr_b16 v[18:19], v132 offset:20736
    s_mov_b32 s71, 0xf00ff00f
    ds_read_b64_tr_b16 v[34:35], v133 offset:22784
    s_mov_b32 s65, 0x0ff00ff0
    ds_read_b64_tr_b16 v[32:33], v133 offset:22528
    ds_read_b64_tr_b16 v[12:13], v132 offset:18432
    ds_read_b128 v[240:243], v0 offset:6272
    ds_read_b64_tr_b16 v[22:23], v132 offset:22784
    ds_read_b128 v[228:231], v0 offset:128
    s_waitcnt lgkmcnt(6)
    s_mov_b32 s64, 0x0ff00ff0
    ds_read_b64_tr_b16 v[44:45], v134 offset:22528
    s_waitcnt lgkmcnt(5)
    s_mov_b32 s69, 0xf00f0000
    s_add_u32 m0, s55, 76736
    ds_read_b64_tr_b16 v[24:25], v133 offset:18432
    ds_read_b64_tr_b16 v[40:41], v134 offset:20480
    s_waitcnt lgkmcnt(1)
    ds_read_b64_tr_b16 v[26:27], v133 offset:18688
    buffer_load_dwordx4 v139, s[20:23], s4 offen offset:64 lds
    v_cndmask_b32 v84, v84, v91, s[64:65]
    s_add_u32 m0, s55, 82816
    s_mov_b32 s68, 0x00000000
    s_cmp_eq_u32 s46, 0
    v_mul_u32_u24 v50, 192, v155
    s_mov_b32 s67, 0x00000ff0
    s_cselect_b64 s[64:65], -1, 0
    v_cndmask_b32 v87, v87, v91, s[66:67]
    v_cndmask_b32 v164, v84, v164, s[64:65]
    v_cndmask_b32 v170, v90, v170, s[64:65]
    ds_read_b64_tr_b16 v[46:47], v134 offset:22784
    ds_read_b64_tr_b16 v[38:39], v134 offset:18688
    v_cndmask_b32 v85, v85, v91, s[66:67]
    v_cndmask_b32 v86, v86, v91, s[66:67]
    s_waitcnt lgkmcnt(2)
    s_mov_b32 s66, s64
    buffer_load_dwordx4 v139, s[20:23], s4 offen offset:128 lds
    s_and_b32 s67, s64, 0xffff
    v_cndmask_b32 v77, v93, v91, s[66:67]
    v_cndmask_b32 v167, v87, v167, s[64:65]
    v_cndmask_b32 v79, v95, v91, s[66:67]
    v_cndmask_b32 v82, v86, v91, s[66:67]
    v_cndmask_b32 v166, v86, v166, s[64:65]
    s_waitcnt lgkmcnt(1)
    s_mov_b32 s70, 0xf00ff00f
    ds_read_b128 v[224:227], v0 offset:64
    v_cndmask_b32 v81, v85, v91, s[66:67]
    v_cndmask_b32 v169, v89, v169, s[64:65]
    v_cndmask_b32 v83, v87, v91, s[66:67]
    v_cndmask_b32 v76, v92, v91, s[64:65]
    v_cndmask_b32 v78, v94, v91, s[66:67]
    s_waitcnt lgkmcnt(1)
    ds_read_b64_tr_b16 v[16:17], v132 offset:20480
    v_cndmask_b32 v165, v85, v165, s[64:65]
    s_andn2_b64 s[66:67], s[68:69], s[64:65]
    v_cndmask_b32 v80, v84, v91, s[64:65]
    ds_read_b64_tr_b16 v[20:21], v132 offset:22528
    s_waitcnt lgkmcnt(1)
    ds_read_b128 v[232:235], v0 offset:6144
    ds_read_b64_tr_b16 v[42:43], v134 offset:20736
    s_waitcnt lgkmcnt(2)
    v_cndmask_b32 v168, v88, v168, s[64:65]
    s_andn2_b64 s[64:65], s[70:71], s[64:65]
    s_lshr_b32 s56, s37, 1
    ds_read_b64_tr_b16 v[36:37], v134 offset:18432
    s_and_b32 s50, s37, 1
    s_mul_i32 s51, s56, 3072
    v_cndmask_b32 v114, v114, v91, s[64:65]
    s_lshl_b32 s59, s56, 10
    s_lshl3_add_u32 s59, s50, s59
    v_lshl_add_u32 v99, v152, 4, s59
    s_lshl_b32 s59, s37, 2
    s_sub_u32 s51, s51, s59
    v_lshl_add_u32 v107, v152, 4, s59
    ds_read_b64_tr_b16 v[28:29], v133 offset:20480
    v_mfma_f32_16x16x32_bf16 v[244:247], v[12:15], v[220:223], 0
    v_mfma_f32_16x16x32_bf16 v[244:247], v[16:19], v[224:227], v[244:247]
    ds_read_b128 v[236:239], v0 offset:6208
    s_waitcnt lgkmcnt(2)
    v_mfma_f32_16x16x32_bf16 v[244:247], v[20:23], v[228:231], v[244:247]
    v_mfma_f32_16x16x32_bf16 v[252:255], v[36:39], v[220:223], 0
    v_lshl_add_u32 v138, v156, 4, v50
    v_cndmask_b32 v109, v109, v91, s[66:67]
    v_mfma_f32_16x16x32_bf16 v[252:255], v[40:43], v[224:227], v[252:255]
    v_mfma_f32_16x16x32_bf16 v[248:251], v[24:27], v[220:223], 0
    s_mul_i32 s56, s56, 7
    s_waitcnt lgkmcnt(1)
    v_mfma_f32_16x16x32_bf16 v[248:251], v[28:31], v[224:227], v[248:251]
    s_mul_i32 s59, s50, 128
    s_add_u32 s56, s56, s41
    s_add_u32 s56, s56, 3
    v_cvt_pk_bf16_f32 v244, v244, v245
    s_add_u32 s59, s59, s47
    v_lshl_add_u32 v49, v154, 4, s59
    v_add_u32 v48, s56, v158
    v_cndmask_b32 v110, v110, v91, s[66:67]
    v_mfma_f32_16x16x32_bf16 v[248:251], v[32:35], v[228:231], v[248:251]
    s_mul_i32 s59, s45, 12
    s_add_u32 s59, s59, s40
    v_cmp_gt_u32 vcc, 7, v159
    s_add_u32 s59, s59, 3
    v_mfma_f32_16x16x32_bf16 v[252:255], v[44:47], v[228:231], v[252:255]
    v_cvt_pk_bf16_f32 v245, v246, v247
    s_nop 1
    v_cvt_pk_bf16_f32 v247, v250, v251
    v_cvt_pk_bf16_f32 v246, v248, v249
    v_mfma_f32_16x16x32_bf16 v[248:251], v[24:27], v[232:235], 0
    s_waitcnt lgkmcnt(0)
    v_mad_u32_u24 v48, v48, s43, v49
    v_cvt_pk_bf16_f32 v252, v252, v253
    v_mfma_f32_16x16x32_bf16 v[248:251], v[28:31], v[236:239], v[248:251]
    s_add_u32 s48, s48, s39
    s_add_u32 m0, s42, 30720
    v_cvt_pk_bf16_f32 v253, v254, v255
    buffer_load_dwordx4 v136, s[16:19], s48 offen lds
    ds_write_b64 v2, v[252:253] offset:37520
    v_mfma_f32_16x16x32_bf16 v[252:255], v[36:39], v[232:235], 0
    ds_write_b128 v1, v[244:247] offset:32400
    v_mfma_f32_16x16x32_bf16 v[252:255], v[40:43], v[236:239], v[252:255]
    v_mfma_f32_16x16x32_bf16 v[252:255], v[44:47], v[240:243], v[252:255]
    s_add_u32 s48, s48, s39
    v_mfma_f32_16x16x32_bf16 v[244:247], v[12:15], v[232:235], 0
    v_mfma_f32_16x16x32_bf16 v[244:247], v[16:19], v[236:239], v[244:247]
    s_setprio 0
    s_add_u32 m0, s42, 38400
    s_nop 2
    v_cvt_pk_bf16_f32 v252, v252, v253
    v_mfma_f32_16x16x32_bf16 v[244:247], v[20:23], v[240:243], v[244:247]
    buffer_load_dwordx4 v136, s[16:19], s48 offen lds
    v_add_u32 v49, s59, v157
    v_cvt_pk_bf16_f32 v253, v254, v255
    v_mfma_f32_16x16x32_bf16 v[248:251], v[32:35], v[240:243], v[248:251]
    s_add_u32 s48, s48, s39
    s_add_u32 m0, s42, 46080
    s_nop 0
    buffer_load_dwordx4 v136, s[16:19], s48 offen lds
    v_mad_i32_i24 v48, v49, s38, v48
    s_add_u32 s48, s48, s39
    v_cvt_pk_bf16_f32 v244, v244, v245
    v_cvt_pk_bf16_f32 v245, v246, v247
    v_mov_b32 v49, 0x80000000
    v_cvt_pk_bf16_f32 v247, v250, v251
    v_cndmask_b32 v115, v49, v48, vcc
    v_cvt_pk_bf16_f32 v246, v248, v249
    ds_write_b128 v1, v[244:247] offset:32912
    ds_write_b64 v2, v[252:253] offset:37776
    s_waitcnt vmcnt(3) lgkmcnt(0)
    s_barrier
    ds_read_b64_tr_b16 v[62:63], v137 offset:256
    ds_read_b128 v[220:223], v0 offset:15360
    ds_read_b64_tr_b16 v[50:51], v135 offset:256
    ds_read_b128 v[240:243], v11 offset:128
    ds_read_b128 v[176:179], v4 offset:32400
    ds_read_b64_tr_b16 v[58:59], v135 offset:4352
    s_add_u32 m0, s42, 53760
    ds_read_b128 v[172:175], v3 offset:32400
    ds_read_b64_tr_b16 v[64:65], v137 offset:2048
    ds_read_b128 v[224:227], v0 offset:15424
    ds_read_b64_tr_b16 v[52:53], v135 offset:2048
    ds_read_b64_tr_b16 v[190:191], v6 offset:37520
    s_waitcnt lgkmcnt(9)
    v_mfma_f32_16x16x32_bf16 v[252:255], v[36:39], v[220:223], 0
    buffer_load_dwordx4 v136, s[16:19], s48 offen lds
    ds_read_b128 v[180:183], v3 offset:33040
    ds_read_b64_tr_b16 v[188:189], v5 offset:37520
    s_waitcnt lgkmcnt(10)
    v_mfma_f32_16x16x32_bf16 v[244:247], v[12:15], v[220:223], 0
    ds_read_b64_tr_b16 v[70:71], v137 offset:4352
    ds_read_b64_tr_b16 v[48:49], v135
    s_waitcnt lgkmcnt(6)
    ds_read_b64_tr_b16 v[68:69], v137 offset:4096
    ds_read_b128 v[228:231], v0 offset:15488
    ds_read_b128 v[184:187], v4 offset:33040
    ds_read_b64_tr_b16 v[66:67], v137 offset:2304
    ds_read_b128 v[236:239], v11 offset:64
    v_mfma_f32_16x16x32_bf16 v[248:251], v[24:27], v[220:223], 0
    s_waitcnt lgkmcnt(10)
    v_mfma_f32_16x16x32_bf16 v[248:251], v[28:31], v[224:227], v[248:251]
    ds_read_b64_tr_b16 v[54:55], v135 offset:2304
    ds_read_b64_tr_b16 v[56:57], v135 offset:4096
    s_add_u32 s48, s48, s39
    ds_read_b128 v[232:235], v11
    s_waitcnt lgkmcnt(12)
    s_add_u32 m0, s42, 61440
    ds_read_b64_tr_b16 v[192:193], v7 offset:32400
    v_mfma_f32_16x16x32_bf16 v[252:255], v[40:43], v[224:227], v[252:255]
    ds_read_b64_tr_b16 v[60:61], v137
    v_mfma_f32_16x16x32_bf16 v[244:247], v[16:19], v[224:227], v[244:247]
    s_setprio 3
    s_waitcnt lgkmcnt(8)
    v_mfma_f32_16x16x32_bf16 v[252:255], v[44:47], v[228:231], v[252:255]
    v_mfma_f32_16x16x32_bf16 v[248:251], v[32:35], v[228:231], v[248:251]
    s_setprio 2
    v_mfma_f32_16x16x32_bf16 v[244:247], v[20:23], v[228:231], v[244:247]
    ds_read_b128 v[228:231], v11 offset:7808
    s_nop 6
    v_cvt_pk_bf16_f32 v244, v244, v245
    v_cvt_pk_bf16_f32 v245, v246, v247
    v_cvt_pk_bf16_f32 v247, v250, v251
    v_cvt_pk_bf16_f32 v246, v248, v249
    s_waitcnt lgkmcnt(3)
    v_cvt_pk_bf16_f32 v252, v252, v253
    buffer_load_dwordx4 v136, s[16:19], s48 offen lds
    ds_write_b128 v1, v[244:247]
    v_mfma_f32_16x16x32_bf16 v[244:247], v[48:51], v[232:235], 0
    s_waitcnt lgkmcnt(1)
    v_mfma_f32_16x16x32_bf16 v[248:251], v[60:63], v[232:235], 0
    ds_read_b128 v[232:235], v0 offset:21504
    v_mfma_f32_16x16x32_bf16 v[244:247], v[52:55], v[236:239], v[244:247]
    v_mfma_f32_16x16x32_bf16 v[244:247], v[56:59], v[240:243], v[244:247]
    ds_read_b128 v[220:223], v11 offset:7680
    v_cndmask_b32 v112, v112, v91, s[64:65]
    v_mfma_f32_16x16x32_bf16 v[248:251], v[64:67], v[236:239], v[248:251]
    ds_read_b128 v[224:227], v11 offset:7744
    v_mfma_f32_16x16x32_bf16 v[248:251], v[68:71], v[240:243], v[248:251]
    ds_read_b128 v[236:239], v0 offset:21568
    s_nop 1
    v_mul_f32 v246, v10, v246
    v_mul_f32 v247, v10, v247
    v_cvt_pk_bf16_f32 v73, v246, v247
    v_mul_f32 v245, v10, v245
    s_nop 0
    v_mul_f32 v250, v10, v250
    v_mul_f32 v251, v10, v251
    v_mul_f32 v249, v10, v249
    s_waitcnt lgkmcnt(2)
    v_mul_f32 v244, v10, v244
    v_cvt_pk_bf16_f32 v72, v244, v245
    v_mfma_f32_16x16x32_bf16 v[244:247], v[48:51], v[220:223], 0
    v_mul_f32 v248, v10, v248
    s_waitcnt lgkmcnt(1)
    v_mfma_f32_16x16x32_bf16 v[244:247], v[52:55], v[224:227], v[244:247]
    s_mul_i32 s52, s37, 3072
    v_cvt_pk_bf16_f32 v75, v250, v251
    v_cvt_pk_bf16_f32 v253, v254, v255
    v_mfma_f32_16x16x32_bf16 v[244:247], v[56:59], v[228:231], v[244:247]
    v_cvt_pk_bf16_f32 v74, v248, v249
    v_mfma_f32_16x16x32_bf16 v[248:251], v[60:63], v[220:223], 0
    ds_read_b128 v[240:243], v0 offset:21632
    v_mfma_f32_16x16x32_bf16 v[248:251], v[64:67], v[224:227], v[248:251]
    s_waitcnt lgkmcnt(1)
    v_mfma_f32_16x16x32_bf16 v[204:207], v[172:175], v[72:75], v[164:167]
    ds_write_b64 v2, v[252:253] offset:5120
    v_mfma_f32_16x16x32_bf16 v[252:255], v[36:39], v[232:235], 0
    v_mul_f32 v245, v10, v245
    v_mul_f32 v247, v10, v247
    v_mfma_f32_16x16x32_bf16 v[248:251], v[68:71], v[228:231], v[248:251]
    v_mul_f32 v244, v10, v244
    v_mfma_f32_16x16x32_bf16 v[208:211], v[176:179], v[72:75], v[168:171]
    v_cvt_pk_bf16_f32 v116, v244, v245
    v_mul_f32 v246, v10, v246
    v_mfma_f32_16x16x32_bf16 v[252:255], v[40:43], v[236:239], v[252:255]
    v_exp_f32 v206, v206
    v_mfma_f32_16x16x32_bf16 v[200:203], v[184:187], v[72:75], v[96:99]
    v_cvt_pk_bf16_f32 v117, v246, v247
    v_exp_f32 v204, v204
    v_mfma_f32_16x16x32_bf16 v[244:247], v[12:15], v[232:235], 0
    v_mul_f32 v251, v10, v251
    v_mul_f32 v249, v10, v249
    v_mfma_f32_16x16x32_bf16 v[196:199], v[180:183], v[72:75], v[76:79]
    v_exp_f32 v207, v207
    v_exp_f32 v205, v205
    s_nop 0
    v_cvt_pk_bf16_f32 v216, v204, v205
    s_waitcnt lgkmcnt(1)
    v_mfma_f32_16x16x32_bf16 v[252:255], v[44:47], v[240:243], v[252:255]
    ds_read_b64_tr_b16 v[194:195], v8 offset:32400
    v_mfma_f32_16x16x32_bf16 v[244:247], v[16:19], v[236:239], v[244:247]
    v_mul_f32 v250, v10, v250
    s_add_u32 m0, s52, 76864
    v_exp_f32 v209, v209
    v_mul_f32 v248, v10, v248
    v_exp_f32 v208, v208
    v_cvt_pk_bf16_f32 v118, v248, v249
    v_cvt_pk_bf16_f32 v119, v250, v251
    v_mfma_f32_16x16x32_bf16 v[248:251], v[24:27], v[232:235], 0
    v_exp_f32 v210, v210
    s_nop 0
    v_cvt_pk_bf16_f32 v219, v210, 0
    v_mfma_f32_16x16x32_bf16 v[248:251], v[28:31], v[236:239], v[248:251]
    v_cvt_pk_bf16_f32 v218, v208, v209
    v_mfma_f32_16x16x32_bf16 v[248:251], v[32:35], v[240:243], v[248:251]
    v_exp_f32 v199, v199
    v_cvt_pk_bf16_f32 v217, v206, v207
    v_mfma_f32_16x16x32_bf16 v[244:247], v[20:23], v[240:243], v[244:247]
    s_setprio 1
    v_cvt_pk_bf16_f32 v252, v252, v253
    s_waitcnt lgkmcnt(0)
    v_mfma_f32_16x16x32_bf16 v[140:143], v[188:191], v[216:219], 0
    v_mfma_f32_16x16x32_bf16 v[144:147], v[192:195], v[216:219], 0
    ds_read_b128 v[220:223], v0 offset:27648
    s_nop 1
    v_cvt_pk_bf16_f32 v244, v244, v245
    s_mul_i32 s53, s37, 4608
    v_cvt_pk_bf16_f32 v253, v254, v255
    ds_write_b64 v2, v[252:253] offset:5376
    v_cvt_pk_bf16_f32 v245, v246, v247
    v_cvt_pk_bf16_f32 v246, v248, v249
    v_cvt_pk_bf16_f32 v247, v250, v251
    ds_read_b64_tr_b16 v[194:195], v8 offset:33040
    ds_read_b64_tr_b16 v[190:191], v6 offset:37840
    s_mul_i32 s57, s39, 1
    s_waitcnt lgkmcnt(3)
    ds_read_b128 v[228:231], v0 offset:27776
    ds_read_b128 v[224:227], v0 offset:27712
    v_mfma_f32_16x16x32_bf16 v[248:251], v[24:27], v[220:223], 0
    ds_write_b128 v1, v[244:247] offset:512
    v_mfma_f32_16x16x32_bf16 v[244:247], v[12:15], v[220:223], 0
    s_waitcnt lgkmcnt(1)
    v_mfma_f32_16x16x32_bf16 v[244:247], v[16:19], v[224:227], v[244:247]
    v_mfma_f32_16x16x32_bf16 v[252:255], v[36:39], v[220:223], 0
    ds_read_b64_tr_b16 v[192:193], v7 offset:33040
    v_mfma_f32_16x16x32_bf16 v[252:255], v[40:43], v[224:227], v[252:255]
    v_mfma_f32_16x16x32_bf16 v[252:255], v[44:47], v[228:231], v[252:255]
    ds_read_b64_tr_b16 v[188:189], v5 offset:37840
    v_mfma_f32_16x16x32_bf16 v[244:247], v[20:23], v[228:231], v[244:247]
    v_exp_f32 v197, v197
    v_exp_f32 v196, v196
    s_nop 0
    v_cvt_pk_bf16_f32 v212, v196, v197
    v_mfma_f32_16x16x32_bf16 v[248:251], v[28:31], v[224:227], v[248:251]
    v_exp_f32 v202, v202
    v_mfma_f32_16x16x32_bf16 v[248:251], v[32:35], v[228:231], v[248:251]
    s_nop 0
    v_cvt_pk_bf16_f32 v244, v244, v245
    v_cvt_pk_bf16_f32 v252, v252, v253
    v_exp_f32 v201, v201
    s_waitcnt lgkmcnt(1)
    v_cvt_pk_bf16_f32 v253, v254, v255
    v_cvt_pk_bf16_f32 v245, v246, v247
    s_nop 0
    v_cvt_pk_bf16_f32 v247, v250, v251
    v_cvt_pk_bf16_f32 v246, v248, v249
    s_setprio 0
    s_setprio 1
    v_exp_f32 v200, v200
    ds_write_b128 v1, v[244:247] offset:1024
    ds_write_b64 v2, v[252:253] offset:5632
    v_exp_f32 v198, v198
    s_nop 0
    v_cvt_pk_bf16_f32 v213, v198, v199
    v_cvt_pk_bf16_f32 v214, v200, v201
    v_cvt_pk_bf16_f32 v215, v202, 0
    s_waitcnt lgkmcnt(2)
    s_nop 0
    v_mfma_f32_16x16x32_bf16 v[140:143], v[188:191], v[212:215], v[140:143]
    s_setprio 1
    s_waitcnt vmcnt(3) lgkmcnt(0)
    s_barrier
    v_mfma_f32_16x16x32_bf16 v[204:207], v[180:183], v[116:119], v[80:83]
    ds_read_b128 v[176:179], v4
    buffer_load_dwordx4 v138, s[32:35], s53 offen lds
    v_add_u32 v0, 30720, v0
    v_mfma_f32_16x16x32_bf16 v[144:147], v[192:195], v[212:215], v[144:147]
    s_nop 3
    v_exp_f32 v204, v204
    v_exp_f32 v205, v205
    v_mfma_f32_16x16x32_bf16 v[208:211], v[184:187], v[116:119], v[88:91]
    v_exp_f32 v206, v206
    s_setprio 2
    s_waitcnt lgkmcnt(0)
    v_mfma_f32_16x16x32_bf16 v[200:203], v[176:179], v[72:75], v[104:107]
    ds_read_b128 v[172:175], v3
    ds_read_b128 v[240:243], v11 offset:15488
    v_exp_f32 v207, v207
    s_nop 0
    v_cvt_pk_bf16_f32 v217, v206, v207
    v_exp_f32 v208, v208
    ds_read_b128 v[224:227], v0 offset:64
    ds_read_b128 v[232:235], v11 offset:15360
    v_exp_f32 v209, v209
    s_add_u32 m0, s52, 77824
    s_waitcnt lgkmcnt(3)
    v_cvt_pk_bf16_f32 v216, v204, v205
    v_cvt_pk_bf16_f32 v218, v208, v209
    v_mfma_f32_16x16x32_bf16 v[204:207], v[172:175], v[116:119], v[92:95]
    v_exp_f32 v210, v210
    ds_read_b128 v[236:239], v11 offset:15424
    s_waitcnt lgkmcnt(1)
    v_mfma_f32_16x16x32_bf16 v[248:251], v[60:63], v[232:235], 0
    v_exp_f32 v200, v200
    ds_read_b128 v[184:187], v4 offset:640
    s_setprio 1
    v_cvt_pk_bf16_f32 v219, v210, 0
    v_exp_f32 v207, v207
    v_exp_f32 v205, v205
    v_mfma_f32_16x16x32_bf16 v[196:199], v[172:175], v[72:75], v[100:103]
    s_waitcnt lgkmcnt(1)
    ds_read_b128 v[220:223], v0
    v_mfma_f32_16x16x32_bf16 v[248:251], v[64:67], v[236:239], v[248:251]
    v_mfma_f32_16x16x32_bf16 v[208:211], v[176:179], v[116:119], v[96:99]
    ds_read_b128 v[180:183], v3 offset:640
    v_mfma_f32_16x16x32_bf16 v[244:247], v[48:51], v[232:235], 0
    v_cndmask_b32 v113, v113, v91, s[64:65]
    v_mfma_f32_16x16x32_bf16 v[248:251], v[68:71], v[240:243], v[248:251]
    s_waitcnt lgkmcnt(1)
    v_mfma_f32_16x16x32_bf16 v[244:247], v[52:55], v[236:239], v[244:247]
    ds_read_b128 v[236:239], v11 offset:23104
    v_mfma_f32_16x16x32_bf16 v[148:151], v[188:191], v[216:219], 0
    ds_read_b64_tr_b16 v[190:191], v6 offset:5120
    v_exp_f32 v210, v210
    v_mfma_f32_16x16x32_bf16 v[152:155], v[192:195], v[216:219], 0
    ds_read_b64_tr_b16 v[194:195], v8
    ds_read_b128 v[232:235], v11 offset:23040
    v_mul_f32 v248, v10, v248
    v_mfma_f32_16x16x32_bf16 v[244:247], v[56:59], v[240:243], v[244:247]
    ds_read_b64_tr_b16 v[192:193], v7
    v_mul_f32 v251, v10, v251
    v_mul_f32 v249, v10, v249
    buffer_load_dwordx4 v138, s[32:35], s53 offen offset:64 lds
    s_add_u32 m0, s52, 78784
    ds_read_b128 v[228:231], v0 offset:128
    v_cvt_pk_bf16_f32 v219, v210, 0
    s_add_u32 s48, s48, s39
    s_waitcnt lgkmcnt(4)
    ds_read_b128 v[240:243], v11 offset:23168
    v_exp_f32 v198, v198
    v_mul_f32 v246, v10, v246
    s_waitcnt lgkmcnt(0)
    buffer_load_dwordx4 v138, s[32:35], s53 offen offset:128 lds
    v_mul_f32 v250, v10, v250
    v_cndmask_b32 v111, v111, v91, s[66:67]
    v_cvt_pk_bf16_f32 v123, v250, v251
    v_cvt_pk_bf16_f32 v122, v248, v249
    v_exp_f32 v208, v208
    v_mfma_f32_16x16x32_bf16 v[252:255], v[36:39], v[220:223], 0
    v_exp_f32 v197, v197
    v_mfma_f32_16x16x32_bf16 v[248:251], v[24:27], v[220:223], 0
    ds_read_b64_tr_b16 v[188:189], v5 offset:5120
    v_mul_f32 v245, v10, v245
    v_exp_f32 v206, v206
    s_nop 0
    v_cvt_pk_bf16_f32 v217, v206, v207
    v_exp_f32 v196, v196
    s_add_u32 m0, s42, 69120
    s_nop 0
    buffer_load_dwordx4 v136, s[16:19], s48 offen lds
    v_exp_f32 v202, v202
    v_mul_f32 v244, v10, v244
    v_mul_f32 v247, v10, v247
    v_cvt_pk_bf16_f32 v120, v244, v245
    v_cvt_pk_bf16_f32 v215, v202, 0
    v_exp_f32 v201, v201
    v_mfma_f32_16x16x32_bf16 v[248:251], v[28:31], v[224:227], v[248:251]
    v_exp_f32 v204, v204
    v_cvt_pk_bf16_f32 v121, v246, v247
    v_mfma_f32_16x16x32_bf16 v[244:247], v[12:15], v[220:223], 0
    v_exp_f32 v199, v199
    v_cvt_pk_bf16_f32 v214, v200, v201
    v_mfma_f32_16x16x32_bf16 v[252:255], v[40:43], v[224:227], v[252:255]
    v_cvt_pk_bf16_f32 v212, v196, v197
    v_mfma_f32_16x16x32_bf16 v[244:247], v[16:19], v[224:227], v[244:247]
    v_cvt_pk_bf16_f32 v216, v204, v205
    v_cvt_pk_bf16_f32 v213, v198, v199
    v_mfma_f32_16x16x32_bf16 v[204:207], v[180:183], v[72:75], v[108:111]
    v_mfma_f32_16x16x32_bf16 v[196:199], v[172:175], v[120:123], v[84:87]
    ds_read_b128 v[224:227], v0 offset:6208
    v_exp_f32 v209, v209
    v_mfma_f32_16x16x32_bf16 v[200:203], v[176:179], v[120:123], v[88:91]
    s_mul_i32 s54, s45, 1032192
    ds_read_b128 v[220:223], v0 offset:6144
    s_nop 1
    v_exp_f32 v204, v204
    v_cvt_pk_bf16_f32 v218, v208, v209
    s_nop 1
    v_exp_f32 v202, v202
    v_mfma_f32_16x16x32_bf16 v[208:211], v[184:187], v[72:75], v[112:115]
    s_setprio 3
    v_exp_f32 v200, v200
    v_exp_f32 v206, v206
    v_exp_f32 v198, v198
    v_exp_f32 v201, v201
    v_exp_f32 v199, v199
    v_mfma_f32_16x16x32_bf16 v[244:247], v[20:23], v[228:231], v[244:247]
    v_mfma_f32_16x16x32_bf16 v[248:251], v[32:35], v[228:231], v[248:251]
    s_waitcnt lgkmcnt(2)
    v_exp_f32 v197, v197
    v_mfma_f32_16x16x32_bf16 v[152:155], v[192:195], v[216:219], v[152:155]
    v_mfma_f32_16x16x32_bf16 v[148:151], v[188:191], v[216:219], v[148:151]
    s_setprio 3
    v_mfma_f32_16x16x32_bf16 v[252:255], v[44:47], v[228:231], v[252:255]
    s_waitcnt lgkmcnt(0)
    v_exp_f32 v196, v196
    v_mfma_f32_16x16x32_bf16 v[144:147], v[192:195], v[212:215], v[144:147]
    ds_read_b128 v[228:231], v0 offset:6272
    v_cvt_pk_bf16_f32 v244, v244, v245
    v_mfma_f32_16x16x32_bf16 v[140:143], v[188:191], v[212:215], v[140:143]
    v_cvt_pk_bf16_f32 v212, v196, v197
    v_cvt_pk_bf16_f32 v213, v198, v199
    v_exp_f32 v207, v207
    v_mfma_f32_16x16x32_bf16 v[196:199], v[180:183], v[116:119], v[100:103]
    v_exp_f32 v210, v210
    v_exp_f32 v205, v205
    v_cvt_pk_bf16_f32 v215, v202, 0
    v_cvt_pk_bf16_f32 v252, v252, v253
    v_exp_f32 v209, v209
    v_cvt_pk_bf16_f32 v214, v200, v201
    v_cvt_pk_bf16_f32 v245, v246, v247
    v_mfma_f32_16x16x32_bf16 v[200:203], v[184:187], v[116:119], v[104:107]
    v_cvt_pk_bf16_f32 v246, v248, v249
    s_waitcnt lgkmcnt(0)
    v_cvt_pk_bf16_f32 v247, v250, v251
    v_mfma_f32_16x16x32_bf16 v[248:251], v[60:63], v[232:235], 0
    ds_write_b128 v1, v[244:247] offset:32400
    v_mfma_f32_16x16x32_bf16 v[156:159], v[188:191], v[212:215], 0
    v_mfma_f32_16x16x32_bf16 v[160:163], v[192:195], v[212:215], 0
    ds_read_b64_tr_b16 v[192:193], v7 offset:640
    v_exp_f32 v197, v197
    v_mfma_f32_16x16x32_bf16 v[244:247], v[48:51], v[232:235], 0
    v_mfma_f32_16x16x32_bf16 v[248:251], v[64:67], v[236:239], v[248:251]
    v_mfma_f32_16x16x32_bf16 v[248:251], v[68:71], v[240:243], v[248:251]
    ds_read_b64_tr_b16 v[194:195], v8 offset:640
    v_exp_f32 v208, v208
    v_mfma_f32_16x16x32_bf16 v[244:247], v[52:55], v[236:239], v[244:247]
    v_exp_f32 v202, v202
    v_mfma_f32_16x16x32_bf16 v[244:247], v[56:59], v[240:243], v[244:247]
    ds_read_b64_tr_b16 v[188:189], v5 offset:5440
    s_nop 1
    v_mul_f32 v250, v10, v250
    v_cvt_pk_bf16_f32 v218, v208, v209
    v_mul_f32 v251, v10, v251
    v_cvt_pk_bf16_f32 v127, v250, v251
    v_cvt_pk_bf16_f32 v217, v206, v207
    v_mul_f32 v246, v10, v246
    v_mul_f32 v248, v10, v248
    v_mul_f32 v244, v10, v244
    v_mul_f32 v249, v10, v249
    v_mul_f32 v245, v10, v245
    v_cvt_pk_bf16_f32 v216, v204, v205
    s_waitcnt lgkmcnt(1)
    s_setprio 0
    v_mul_f32 v247, v10, v247
    v_cvt_pk_bf16_f32 v124, v244, v245
    v_cvt_pk_bf16_f32 v219, v210, 0
    v_cvt_pk_bf16_f32 v253, v254, v255
    ds_read_b64_tr_b16 v[190:191], v6 offset:5440
    ds_write_b64 v2, v[252:253] offset:37520
    v_mfma_f32_16x16x32_bf16 v[204:207], v[180:183], v[120:123], v[92:95]
    v_cvt_pk_bf16_f32 v125, v246, v247
    v_mfma_f32_16x16x32_bf16 v[144:147], v[192:195], v[216:219], v[144:147]
    s_nop 7
    v_permlane32_swap_b32 v144, v146
    v_rcp_f32 v146, v146
    v_mfma_f32_16x16x32_bf16 v[244:247], v[12:15], v[220:223], 0
    s_waitcnt lgkmcnt(1)
    v_mfma_f32_16x16x32_bf16 v[140:143], v[188:191], v[216:219], v[140:143]
    s_setprio 3
    v_mfma_f32_16x16x32_bf16 v[208:211], v[184:187], v[120:123], v[96:99]
    v_mfma_f32_16x16x32_bf16 v[252:255], v[36:39], v[220:223], 0
    v_mfma_f32_16x16x32_bf16 v[252:255], v[40:43], v[224:227], v[252:255]
    v_cvt_pk_bf16_f32 v126, v248, v249
    v_mfma_f32_16x16x32_bf16 v[248:251], v[24:27], v[220:223], 0
    v_mfma_f32_16x16x32_bf16 v[244:247], v[16:19], v[224:227], v[244:247]
    s_nop 0
    v_mul_f32 v141, v146, v141
    v_permlane32_swap_b32 v145, v147
    v_mfma_f32_16x16x32_bf16 v[252:255], v[44:47], v[228:231], v[252:255]
    v_exp_f32 v205, v205
    v_mfma_f32_16x16x32_bf16 v[244:247], v[20:23], v[228:231], v[244:247]
    v_mul_f32 v142, v146, v142
    v_mul_f32 v140, v146, v140
    v_mul_f32 v143, v146, v143
    v_cvt_pk_bf16_f32 v140, v140, v141
    v_cvt_pk_bf16_f32 v141, v142, v143
    v_mfma_f32_16x16x32_bf16 v[248:251], v[28:31], v[224:227], v[248:251]
    v_exp_f32 v200, v200
    v_mfma_f32_16x16x32_bf16 v[248:251], v[32:35], v[228:231], v[248:251]
    v_cvt_pk_bf16_f32 v244, v244, v245
    v_cvt_pk_bf16_f32 v245, v246, v247
    s_setprio 1
    ds_write_b64 v99, v[140:141] offset:6144
    v_cvt_pk_bf16_f32 v252, v252, v253
    v_mul_f32 v144, v146, v144
    v_cvt_pk_bf16_f32 v253, v254, v255
    v_mul_f32 v145, v146, v145
    v_cvt_pk_bf16_f32 v247, v250, v251
    v_cvt_pk_bf16_f32 v246, v248, v249
    ds_write_b128 v1, v[244:247] offset:32912
    ds_write_b64 v2, v[252:253] offset:37776
    v_exp_f32 v204, v204
    v_exp_f32 v201, v201
    v_exp_f32 v199, v199
    v_exp_f32 v210, v210
    s_setprio 3
    v_cvt_pk_bf16_f32 v215, v202, 0
    v_cvt_pk_bf16_f32 v142, v144, v145
    v_cvt_pk_bf16_f32 v219, v210, 0
    s_setprio 2
    ds_write_b32 v107, v142 offset:8192
    v_exp_f32 v209, v209
    v_exp_f32 v206, v206
    v_cvt_pk_bf16_f32 v216, v204, v205
    v_exp_f32 v196, v196
    v_exp_f32 v208, v208
    v_exp_f32 v198, v198
    v_cvt_pk_bf16_f32 v212, v196, v197
    v_exp_f32 v207, v207
    v_cvt_pk_bf16_f32 v218, v208, v209
    v_cvt_pk_bf16_f32 v214, v200, v201
    v_cvt_pk_bf16_f32 v213, v198, v199
    v_cvt_pk_bf16_f32 v217, v206, v207
    s_nop 0
    v_mfma_f32_16x16x32_bf16 v[152:155], v[192:195], v[212:215], v[152:155]
    v_mfma_f32_16x16x32_bf16 v[148:151], v[188:191], v[212:215], v[148:151]
    v_mfma_f32_16x16x32_bf16 v[160:163], v[192:195], v[216:219], v[160:163]
    s_waitcnt vmcnt(1) lgkmcnt(0)
    s_barrier
    ds_read_b128 v[232:235], v11 offset:30720
    ds_read_b128 v[236:239], v11 offset:30784
    v_mfma_f32_16x16x32_bf16 v[196:199], v[180:183], v[124:127], v[84:87]
    ds_read_b128 v[220:223], v11 offset:38400
    ds_read_b128 v[240:243], v11 offset:30848
    ds_read_b128 v[172:175], v3 offset:32400
L_t6:
    s_cbranch_execz L_back1
    v_mfma_f32_16x16x32_bf16 v[200:203], v[184:187], v[124:127], v[88:91]
    s_nop 3
    v_exp_f32 v196, v196
    v_mfma_f32_16x16x32_bf16 v[156:159], v[188:191], v[216:219], v[156:159]
    s_waitcnt lgkmcnt(3)
    ds_read_b128 v[176:179], v4 offset:32400
    v_exp_f32 v199, v199
    v_exp_f32 v197, v197
    v_mfma_f32_16x16x32_bf16 v[244:247], v[48:51], v[232:235], 0
    v_mfma_f32_16x16x32_bf16 v[244:247], v[52:55], v[236:239], v[244:247]
    v_exp_f32 v200, v200
    v_mfma_f32_16x16x32_bf16 v[248:251], v[60:63], v[232:235], 0
    v_exp_f32 v198, v198
    v_mfma_f32_16x16x32_bf16 v[248:251], v[64:67], v[236:239], v[248:251]
    s_waitcnt lgkmcnt(2)
    v_mfma_f32_16x16x32_bf16 v[244:247], v[56:59], v[240:243], v[244:247]
    v_cvt_pk_bf16_f32 v213, v198, v199
    s_waitcnt lgkmcnt(1)
    v_mfma_f32_16x16x32_bf16 v[204:207], v[172:175], v[116:119], v[108:111]
    s_lshl_b32 s61, s37, 2
    ds_read_b128 v[224:227], v11 offset:38464
    s_waitcnt lgkmcnt(1)
    v_mfma_f32_16x16x32_bf16 v[208:211], v[176:179], v[116:119], v[112:115]
    ds_read_b128 v[228:231], v11 offset:38528
    v_cvt_pk_bf16_f32 v212, v196, v197
    v_mfma_f32_16x16x32_bf16 v[196:199], v[172:175], v[120:123], v[100:103]
    s_sub_u32 s61, 76864, s61
    v_cndmask_b32 v114, v114, v91, s[70:71]
    v_mul_f32 v246, v10, v246
    v_mul_f32 v247, v10, v247
    v_cvt_pk_bf16_f32 v129, v246, v247
    v_mfma_f32_16x16x32_bf16 v[248:251], v[68:71], v[240:243], v[248:251]
    v_exp_f32 v209, v209
    s_nop 0
    v_exp_f32 v198, v198
    v_cndmask_b32 v109, v109, v91, s[68:69]
    v_exp_f32 v202, v202
    s_nop 0
    v_cvt_pk_bf16_f32 v215, v202, 0
    v_exp_f32 v201, v201
    s_nop 0
    v_cvt_pk_bf16_f32 v214, v200, v201
    v_exp_f32 v196, v196
    v_exp_f32 v206, v206
    v_mfma_f32_16x16x32_bf16 v[168:171], v[192:195], v[212:215], 0
    ds_read_b64_tr_b16 v[194:195], v8 offset:32400
    v_exp_f32 v204, v204
    v_mul_f32 v248, v10, v248
    v_exp_f32 v210, v210
    v_mul_f32 v249, v10, v249
    v_exp_f32 v207, v207
    v_cvt_pk_bf16_f32 v130, v248, v249
    v_mul_f32 v244, v10, v244
    v_mul_f32 v245, v10, v245
    v_mfma_f32_16x16x32_bf16 v[200:203], v[176:179], v[120:123], v[104:107]
    s_waitcnt lgkmcnt(1)
    ds_read_b128 v[184:187], v4 offset:33040
    v_mfma_f32_16x16x32_bf16 v[164:167], v[188:191], v[212:215], 0
    v_mul_f32 v250, v10, v250
    v_mul_f32 v251, v10, v251
    ds_read_b64_tr_b16 v[188:189], v5 offset:37520
    v_cvt_pk_bf16_f32 v131, v250, v251
    s_nop 0
    v_exp_f32 v200, v200
    v_cvt_pk_bf16_f32 v128, v244, v245
    v_mfma_f32_16x16x32_bf16 v[248:251], v[60:63], v[220:223], 0
    ds_read_b128 v[236:239], v11 offset:46144
    v_mfma_f32_16x16x32_bf16 v[248:251], v[64:67], v[224:227], v[248:251]
    v_exp_f32 v197, v197
    v_exp_f32 v205, v205
    v_mfma_f32_16x16x32_bf16 v[248:251], v[68:71], v[228:231], v[248:251]
    ds_read_b64_tr_b16 v[192:193], v7 offset:32400
    v_mfma_f32_16x16x32_bf16 v[244:247], v[48:51], v[220:223], 0
    v_exp_f32 v208, v208
    v_max3_f32 v9, v9, v146, v147
    v_mfma_f32_16x16x32_bf16 v[244:247], v[52:55], v[224:227], v[244:247]
    v_cvt_pk_bf16_f32 v218, v208, v209
    s_lshl_b32 s63, s50, 11
    s_setprio 3
    s_waitcnt lgkmcnt(2)
    ds_read_b128 v[180:183], v3 offset:33040
    v_exp_f32 v199, v199
    s_waitcnt lgkmcnt(1)
    v_cvt_pk_bf16_f32 v216, v204, v205
    v_cvt_pk_bf16_f32 v217, v206, v207
    v_mfma_f32_16x16x32_bf16 v[204:207], v[172:175], v[124:127], v[92:95]
    v_cvt_pk_bf16_f32 v219, v210, 0
    s_nop 6
    v_exp_f32 v206, v206
    v_cvt_pk_bf16_f32 v213, v198, v199
    v_mfma_f32_16x16x32_bf16 v[244:247], v[56:59], v[228:231], v[244:247]
    v_exp_f32 v202, v202
    v_exp_f32 v204, v204
    v_mfma_f32_16x16x32_bf16 v[152:155], v[192:195], v[216:219], v[152:155]
    v_mfma_f32_16x16x32_bf16 v[208:211], v[176:179], v[124:127], v[96:99]
    s_add_u32 s63, s63, s61
    v_exp_f32 v205, v205
    ds_read_b128 v[220:223], v0 offset:15360
    v_mul_f32 v248, v10, v248
    v_mul_f32 v249, v10, v249
    ds_read_b64_tr_b16 v[190:191], v6 offset:37520
    v_mul_f32 v246, v10, v246
    v_permlane32_swap_b32 v152, v154
    v_mul_f32 v245, v10, v245
    v_mul_f32 v247, v10, v247
    v_cvt_pk_bf16_f32 v133, v246, v247
    v_rcp_f32 v154, v154
    ds_read_b128 v[232:235], v11 offset:46080
    v_cvt_pk_bf16_f32 v212, v196, v197
    v_exp_f32 v210, v210
    ds_read_b128 v[240:243], v11 offset:46208
    v_exp_f32 v207, v207
    v_cndmask_b32 v110, v110, v91, s[68:69]
    v_mul_f32 v251, v10, v251
    v_permlane32_swap_b32 v153, v155
    v_cndmask_b32 v112, v112, v91, s[70:71]
    ds_read_b128 v[228:231], v0 offset:15488
    s_waitcnt lgkmcnt(3)
    v_exp_f32 v201, v201
    v_cvt_pk_bf16_f32 v215, v202, 0
    s_waitcnt lgkmcnt(2)
    v_mul_f32 v152, v154, v152
    v_mfma_f32_16x16x32_bf16 v[148:151], v[188:191], v[216:219], v[148:151]
    v_exp_f32 v208, v208
    v_mul_f32 v244, v10, v244
    v_cvt_pk_bf16_f32 v132, v244, v245
    ds_read_b128 v[224:227], v0 offset:15424
    v_mul_f32 v250, v10, v250
    s_nop 2
    v_mul_f32 v149, v154, v149
    v_mfma_f32_16x16x32_bf16 v[196:199], v[172:175], v[128:131], v[84:87]
    v_mul_f32 v153, v154, v153
    v_mul_f32 v151, v154, v151
    v_cvt_pk_bf16_f32 v135, v250, v251
    v_mul_f32 v148, v154, v148
    s_waitcnt lgkmcnt(2)
    v_cvt_pk_bf16_f32 v217, v206, v207
    v_cvt_pk_bf16_f32 v148, v148, v149
    s_setprio 3
    v_mfma_f32_16x16x32_bf16 v[244:247], v[48:51], v[232:235], 0
    v_cndmask_b32 v111, v111, v91, s[68:69]
    s_waitcnt lgkmcnt(0)
    s_mul_i32 s59, s39, 5
    v_cvt_pk_bf16_f32 v214, v200, v201
    v_mfma_f32_16x16x32_bf16 v[200:203], v[176:179], v[128:131], v[88:91]
    v_exp_f32 v197, v197
    v_mul_f32 v150, v154, v150
    v_cvt_pk_bf16_f32 v149, v150, v151
    v_cvt_pk_bf16_f32 v150, v152, v153
    v_mfma_f32_16x16x32_bf16 v[244:247], v[52:55], v[236:239], v[244:247]
    ds_write_b64 v99, v[148:149] offset:12288
    v_mfma_f32_16x16x32_bf16 v[244:247], v[56:59], v[240:243], v[244:247]
    v_cvt_pk_bf16_f32 v134, v248, v249
    v_mfma_f32_16x16x32_bf16 v[248:251], v[60:63], v[232:235], 0
    ds_write_b32 v107, v150 offset:14336
    v_mfma_f32_16x16x32_bf16 v[248:251], v[64:67], v[236:239], v[248:251]
    ds_read_b128 v[232:235], v0 offset:21504
    s_setprio 1
    s_nop 1
    v_mul_f32 v246, v10, v246
    v_mfma_f32_16x16x32_bf16 v[248:251], v[68:71], v[240:243], v[248:251]
    ds_read_b128 v[240:243], v0 offset:21632
    ds_read_b128 v[236:239], v0 offset:21568
    v_cndmask_b32 v113, v113, v91, s[70:71]
    v_cvt_pk_bf16_f32 v216, v204, v205
    v_exp_f32 v198, v198
    s_nop 2
    v_mul_f32 v249, v10, v249
    v_mul_f32 v247, v10, v247
    v_mfma_f32_16x16x32_bf16 v[156:159], v[188:191], v[212:215], v[156:159]
    v_cvt_pk_bf16_f32 v137, v246, v247
    v_mfma_f32_16x16x32_bf16 v[160:163], v[192:195], v[212:215], v[160:163]
    v_add_u32 v247, s63, v107
    ds_read_b64_tr_b16 v[68:69], v247 offset:12296
    v_mul_f32 v244, v10, v244
    v_exp_f32 v201, v201
    v_mfma_f32_16x16x32_bf16 v[252:255], v[36:39], v[220:223], 0
    v_mul_f32 v250, v10, v250
    s_waitcnt lgkmcnt(1)
    s_setprio 1
    v_mul_f32 v245, v10, v245
    v_exp_f32 v200, v200
    s_nop 0
    v_cvt_pk_bf16_f32 v214, v200, v201
    v_mfma_f32_16x16x32_bf16 v[252:255], v[40:43], v[224:227], v[252:255]
    ds_read_b64_tr_b16 v[50:51], v247 offset:3072
    v_mul_f32 v248, v10, v248
    v_mfma_f32_16x16x32_bf16 v[252:255], v[44:47], v[228:231], v[252:255]
    v_cvt_pk_bf16_f32 v136, v244, v245
    v_exp_f32 v209, v209
    v_cvt_pk_bf16_f32 v219, v210, 0
    v_mul_f32 v251, v10, v251
    v_bfe_u32 v245, v107, 4, 2
    v_cvt_pk_bf16_f32 v139, v250, v251
    v_cvt_pk_bf16_f32 v218, v208, v209
    v_exp_f32 v196, v196
    v_mfma_f32_16x16x32_bf16 v[204:207], v[180:183], v[120:123], v[108:111]
    v_bfe_u32 v244, v107, 8, 2
    v_exp_f32 v202, v202
    v_mad_i32_i24 v11, v244, -8, v115
    v_mad_i32_i24 v246, v245, -8, v107
    v_cvt_pk_bf16_f32 v252, v252, v253
    ds_read_b64_tr_b16 v[48:49], v247
    s_nop 1
    v_exp_f32 v204, v204
    ds_read_b64_tr_b16 v[62:63], v247 offset:3080
    v_cvt_pk_bf16_f32 v215, v202, 0
    v_cvt_pk_bf16_f32 v138, v248, v249
    s_setprio 1
    s_lshl_b32 s60, s50, 5
    v_mfma_f32_16x16x32_bf16 v[168:171], v[192:195], v[216:219], v[168:171]
    s_setprio 0
    ds_read_b64_tr_b16 v[64:65], v247 offset:6152
    s_add_u32 s60, s60, s61
    v_mfma_f32_16x16x32_bf16 v[248:251], v[24:27], v[220:223], 0
    ds_read_b64_tr_b16 v[60:61], v247 offset:8
    ds_read_b64_tr_b16 v[58:59], v247 offset:15360
    v_exp_f32 v207, v207
    ds_read_b64_tr_b16 v[54:55], v247 offset:9216
    v_add_u32 v246, s60, v246
    v_exp_f32 v205, v205
    v_mfma_f32_16x16x32_bf16 v[164:167], v[188:191], v[216:219], v[164:167]
    v_exp_f32 v199, v199
    v_exp_f32 v206, v206
    v_cvt_pk_bf16_f32 v253, v254, v255
    v_mfma_f32_16x16x32_bf16 v[200:203], v[184:187], v[124:127], v[104:107]
    v_cvt_pk_bf16_f32 v217, v206, v207
    v_cvt_pk_bf16_f32 v213, v198, v199
    s_setprio 1
    v_mfma_f32_16x16x32_bf16 v[208:211], v[184:187], v[120:123], v[112:115]
    v_cvt_pk_bf16_f32 v212, v196, v197
    s_waitcnt lgkmcnt(7)
    v_mfma_f32_16x16x32_bf16 v[196:199], v[180:183], v[124:127], v[100:103]
    v_max3_f32 v9, v9, v154, v155
    v_cvt_pk_bf16_f32 v216, v204, v205
    v_mfma_f32_16x16x32_bf16 v[248:251], v[28:31], v[224:227], v[248:251]
    ds_read_b64_tr_b16 v[82:83], v246 offset:16384
    v_mfma_f32_16x16x32_bf16 v[204:207], v[180:183], v[128:131], v[92:95]
    s_waitcnt lgkmcnt(7)
    v_exp_f32 v209, v209
    v_exp_f32 v210, v210
    v_exp_f32 v199, v199
    ds_read_b64_tr_b16 v[66:67], v247 offset:9224
    v_exp_f32 v197, v197
    v_cvt_pk_bf16_f32 v219, v210, 0
    v_mfma_f32_16x16x32_bf16 v[248:251], v[32:35], v[228:231], v[248:251]
    v_exp_f32 v208, v208
    ds_read_b64_tr_b16 v[74:75], v246 offset:4096
    ds_read_b64_tr_b16 v[76:77], v246 offset:7168
    v_mfma_f32_16x16x32_bf16 v[144:147], v[192:195], v[212:215], 0
    v_exp_f32 v198, v198
    s_waitcnt lgkmcnt(7)
    s_setprio 3
    ds_read_b64_tr_b16 v[56:57], v247 offset:12288
    v_cvt_pk_bf16_f32 v218, v208, v209
    v_mfma_f32_16x16x32_bf16 v[208:211], v[184:187], v[128:131], v[96:99]
    ds_read_b64_tr_b16 v[78:79], v246 offset:10240
    v_exp_f32 v207, v207
    v_exp_f32 v205, v205
    v_exp_f32 v206, v206
    ds_read_b64_tr_b16 v[52:53], v247 offset:6144
    s_setprio 0
    v_mfma_f32_16x16x32_bf16 v[140:143], v[188:191], v[212:215], 0
    ds_read_b64_tr_b16 v[190:191], v6 offset:37840
    ds_read_b64_tr_b16 v[188:189], v5 offset:37840
    ds_read_b64_tr_b16 v[72:73], v246 offset:1024
    ds_read_b64_tr_b16 v[70:71], v247 offset:15368
    v_exp_f32 v204, v204
    ds_read_b64_tr_b16 v[80:81], v246 offset:13312
    ds_write_b64 v2, v[252:253] offset:5120
    ds_read_b64_tr_b16 v[192:193], v7 offset:33040
    v_mfma_f32_16x16x32_bf16 v[244:247], v[12:15], v[220:223], 0
    v_mfma_f32_16x16x32_bf16 v[244:247], v[16:19], v[224:227], v[244:247]
    s_waitcnt lgkmcnt(7)
    ds_read_b64_tr_b16 v[194:195], v8 offset:33040
    v_mfma_f32_16x16x32_bf16 v[252:255], v[36:39], v[232:235], 0
    ds_read_b128 v[224:227], v0 offset:27712
    v_mfma_f32_16x16x32_bf16 v[244:247], v[20:23], v[228:231], v[244:247]
    ds_read_b128 v[228:231], v0 offset:27776
    v_exp_f32 v202, v202
    s_nop 0
    v_cvt_pk_bf16_f32 v215, v202, 0
    v_cvt_pk_bf16_f32 v213, v198, v199
    v_exp_f32 v208, v208
    v_mfma_f32_16x16x32_bf16 v[252:255], v[40:43], v[236:239], v[252:255]
    s_waitcnt lgkmcnt(7)
    v_exp_f32 v200, v200
    v_cvt_pk_bf16_f32 v244, v244, v245
    v_cvt_pk_bf16_f32 v245, v246, v247
    s_waitcnt lgkmcnt(3)
    v_cvt_pk_bf16_f32 v247, v250, v251
    v_cvt_pk_bf16_f32 v246, v248, v249
    v_mfma_f32_16x16x32_bf16 v[248:251], v[24:27], v[232:235], 0
    v_exp_f32 v210, v210
    s_waitcnt lgkmcnt(2)
    v_mfma_f32_16x16x32_bf16 v[248:251], v[28:31], v[236:239], v[248:251]
    ds_write_b128 v1, v[244:247]
    v_add_u32 v10, s51, v107
    v_mfma_f32_16x16x32_bf16 v[244:247], v[12:15], v[232:235], 0
    v_exp_f32 v209, v209
    v_mfma_f32_16x16x32_bf16 v[244:247], v[16:19], v[236:239], v[244:247]
    v_mfma_f32_16x16x32_bf16 v[244:247], v[20:23], v[240:243], v[244:247]
    ds_read_b128 v[220:223], v0 offset:27648
    v_mfma_f32_16x16x32_bf16 v[160:163], v[192:195], v[216:219], v[160:163]
    s_waitcnt lgkmcnt(3)
    v_mfma_f32_16x16x32_bf16 v[248:251], v[32:35], v[240:243], v[248:251]
    s_nop 3
    v_cvt_pk_bf16_f32 v244, v244, v245
    s_nop 0
    v_permlane32_swap_b32 v161, v163
    v_cvt_pk_bf16_f32 v245, v246, v247
    v_mfma_f32_16x16x32_bf16 v[252:255], v[44:47], v[240:243], v[252:255]
    s_waitcnt lgkmcnt(0)
    v_cvt_pk_bf16_f32 v246, v248, v249
    v_exp_f32 v196, v196
    v_permlane32_swap_b32 v160, v162
    v_mfma_f32_16x16x32_bf16 v[156:159], v[188:191], v[216:219], v[156:159]
    v_cvt_pk_bf16_f32 v219, v210, 0
    v_cvt_pk_bf16_f32 v247, v250, v251
    v_rcp_f32 v162, v162
    ds_write_b128 v1, v[244:247] offset:512
    v_mfma_f32_16x16x32_bf16 v[244:247], v[12:15], v[220:223], 0
    v_mul_f32 v161, v162, v161
    v_cvt_pk_bf16_f32 v252, v252, v253
    s_nop 0
    v_mul_f32 v158, v162, v158
    v_cvt_pk_bf16_f32 v253, v254, v255
    ds_write_b64 v2, v[252:253] offset:5376
    v_mfma_f32_16x16x32_bf16 v[248:251], v[24:27], v[220:223], 0
    v_mul_f32 v156, v162, v156
    v_mul_f32 v159, v162, v159
    v_mfma_f32_16x16x32_bf16 v[252:255], v[36:39], v[220:223], 0
    v_exp_f32 v201, v201
    v_mfma_f32_16x16x32_bf16 v[252:255], v[40:43], v[224:227], v[252:255]
    s_setprio 3
    v_mul_f32 v157, v162, v157
    v_cvt_pk_bf16_f32 v156, v156, v157
    v_mfma_f32_16x16x32_bf16 v[244:247], v[16:19], v[224:227], v[244:247]
    v_cvt_pk_bf16_f32 v157, v158, v159
    v_mul_f32 v160, v162, v160
    v_cvt_pk_bf16_f32 v158, v160, v161
    v_mfma_f32_16x16x32_bf16 v[248:251], v[28:31], v[224:227], v[248:251]
    s_setprio 0
    ds_write_b32 v107, v158 offset:20480
    v_mfma_f32_16x16x32_bf16 v[248:251], v[32:35], v[228:231], v[248:251]
    s_setprio 0
    ds_write_b64 v99, v[156:157] offset:18432
    v_mfma_f32_16x16x32_bf16 v[252:255], v[44:47], v[228:231], v[252:255]
    v_mfma_f32_16x16x32_bf16 v[244:247], v[20:23], v[228:231], v[244:247]
    s_setprio 0
    ds_read_b128 v[220:223], v0 offset:30720
    ds_read_b128 v[224:227], v0 offset:30784
    s_nop 3
    v_cvt_pk_bf16_f32 v252, v252, v253
    v_cvt_pk_bf16_f32 v244, v244, v245
    v_cvt_pk_bf16_f32 v245, v246, v247
    v_cvt_pk_bf16_f32 v246, v248, v249
    v_cvt_pk_bf16_f32 v218, v208, v209
    v_cvt_pk_bf16_f32 v247, v250, v251
    v_cvt_pk_bf16_f32 v253, v254, v255
    ds_write_b64 v2, v[252:253] offset:5632
    ds_write_b128 v1, v[244:247] offset:1024
    v_cvt_pk_bf16_f32 v214, v200, v201
    v_mfma_f32_16x16x32_bf16 v[200:203], v[184:187], v[132:135], v[88:91]
    v_cvt_pk_bf16_f32 v216, v204, v205
    v_cvt_pk_bf16_f32 v217, v206, v207
    s_nop 1
    v_mfma_f32_16x16x32_bf16 v[140:143], v[188:191], v[216:219], v[140:143]
    v_mfma_f32_16x16x32_bf16 v[144:147], v[192:195], v[216:219], v[144:147]
    s_waitcnt vmcnt(0) lgkmcnt(0)
    s_barrier
    ds_read_b128 v[172:175], v3
    ds_read_b128 v[176:179], v4
    v_cvt_pk_bf16_f32 v212, v196, v197
    v_mfma_f32_16x16x32_bf16 v[196:199], v[180:183], v[132:135], v[84:87]
    v_exp_f32 v202, v202
    ds_read_b128 v[232:235], v10 offset:12288
    v_mfma_f32_16x16x32_bf16 v[168:171], v[192:195], v[212:215], v[168:171]
    s_setprio 2
    v_exp_f32 v200, v200
    v_mfma_f32_16x16x32_bf16 v[164:167], v[188:191], v[212:215], v[164:167]
    v_cvt_pk_bf16_f32 v215, v202, 0
    s_waitcnt lgkmcnt(1)
    v_exp_f32 v196, v196
    v_mfma_f32_16x16x32_bf16 v[208:211], v[176:179], v[124:127], v[112:115]
    ds_read_b128 v[236:239], v10 offset:13312
    v_mfma_f32_16x16x32_bf16 v[204:207], v[172:175], v[124:127], v[108:111]
    s_mul_i32 s62, s50, 96
    v_exp_f32 v201, v201
    s_nop 0
    v_cvt_pk_bf16_f32 v214, v200, v201
    s_waitcnt lgkmcnt(1)
    v_exp_f32 v197, v197
    v_exp_f32 v199, v199
    v_exp_f32 v198, v198
    v_cvt_pk_bf16_f32 v212, v196, v197
    v_cvt_pk_bf16_f32 v213, v198, v199
    v_mfma_f32_16x16x32_bf16 v[196:199], v[172:175], v[128:131], v[100:103]
    v_exp_f32 v206, v206
    s_setprio 3
    v_exp_f32 v205, v205
    v_mfma_f32_16x16x32_bf16 v[252:255], v[72:75], v[232:235], 0
    v_max3_f32 v9, v9, v162, v163
    v_exp_f32 v207, v207
    v_exp_f32 v209, v209
    v_mfma_f32_16x16x32_bf16 v[244:247], v[48:51], v[232:235], 0
    ds_read_b128 v[240:243], v10 offset:14336
    v_mfma_f32_16x16x32_bf16 v[248:251], v[60:63], v[232:235], 0
    v_mfma_f32_16x16x32_bf16 v[148:151], v[188:191], v[212:215], 0
    ds_read_b64_tr_b16 v[188:189], v5 offset:5120
    v_mfma_f32_16x16x32_bf16 v[152:155], v[192:195], v[212:215], 0
    ds_read_b64_tr_b16 v[192:193], v7
    ds_read_b64_tr_b16 v[190:191], v6 offset:5120
    ds_read_b128 v[232:235], v0 offset:36864
    s_waitcnt lgkmcnt(5)
    v_exp_f32 v199, v199
    v_mfma_f32_16x16x32_bf16 v[248:251], v[64:67], v[236:239], v[248:251]
    s_waitcnt lgkmcnt(4)
    v_exp_f32 v208, v208
    s_waitcnt lgkmcnt(1)
    ds_read_b128 v[180:183], v3 offset:640
    v_cvt_pk_bf16_f32 v217, v206, v207
    v_exp_f32 v210, v210
    v_exp_f32 v204, v204
    v_mfma_f32_16x16x32_bf16 v[252:255], v[76:79], v[236:239], v[252:255]
    ds_read_b128 v[228:231], v0 offset:30848
    v_mfma_f32_16x16x32_bf16 v[244:247], v[52:55], v[236:239], v[244:247]
    v_mfma_f32_16x16x32_bf16 v[244:247], v[56:59], v[240:243], v[244:247]
    v_mfma_f32_16x16x32_bf16 v[248:251], v[68:71], v[240:243], v[248:251]
    ds_read_b64_tr_b16 v[194:195], v8
    v_mfma_f32_16x16x32_bf16 v[200:203], v[176:179], v[128:131], v[104:107]
    s_add_u32 s57, s57, s54
    v_exp_f32 v198, v198
    s_nop 2
    v_cvt_pk_bf16_f32 v244, v244, v245
    v_cvt_pk_bf16_f32 v245, v246, v247
    v_cvt_pk_bf16_f32 v247, v250, v251
    v_exp_f32 v197, v197
    v_mfma_f32_16x16x32_bf16 v[252:255], v[80:83], v[240:243], v[252:255]
    v_exp_f32 v196, v196
    v_cvt_pk_bf16_f32 v246, v248, v249
    buffer_store_dwordx4 v[244:247], v115, s[28:31], s57 offen sc0 sc1
    v_mfma_f32_16x16x32_bf16 v[248:251], v[24:27], v[220:223], 0
    v_cvt_pk_bf16_f32 v216, v204, v205
    v_cvt_pk_bf16_f32 v219, v210, 0
    ds_read_b128 v[236:239], v0 offset:36928
    s_waitcnt lgkmcnt(1)
    v_cvt_pk_bf16_f32 v252, v252, v253
    v_mfma_f32_16x16x32_bf16 v[204:207], v[172:175], v[132:135], v[92:95]
    v_exp_f32 v202, v202
    v_cvt_pk_bf16_f32 v213, v198, v199
    v_mfma_f32_16x16x32_bf16 v[248:251], v[28:31], v[224:227], v[248:251]
    v_subrev_u32 v11, s62, v11
    v_cvt_pk_bf16_f32 v253, v254, v255
    buffer_store_dwordx2 v[252:253], v11, s[28:31], s57 offen offset:64 sc0 sc1
    s_nop 1
    v_exp_f32 v205, v205
    v_exp_f32 v201, v201
    v_cvt_pk_bf16_f32 v218, v208, v209
    v_mfma_f32_16x16x32_bf16 v[208:211], v[176:179], v[132:135], v[96:99]
    ds_read_b128 v[240:243], v0 offset:36992
    v_mfma_f32_16x16x32_bf16 v[244:247], v[12:15], v[220:223], 0
    v_exp_f32 v200, v200
    v_cvt_pk_bf16_f32 v212, v196, v197
    v_mfma_f32_16x16x32_bf16 v[196:199], v[172:175], v[136:139], v[84:87]
    v_mfma_f32_16x16x32_bf16 v[164:167], v[188:191], v[216:219], v[164:167]
    v_exp_f32 v207, v207
    v_cvt_pk_bf16_f32 v214, v200, v201
    v_cvt_pk_bf16_f32 v215, v202, 0
    v_mfma_f32_16x16x32_bf16 v[252:255], v[36:39], v[220:223], 0
    s_setprio 1
    v_mfma_f32_16x16x32_bf16 v[168:171], v[192:195], v[216:219], v[168:171]
    v_mfma_f32_16x16x32_bf16 v[200:203], v[176:179], v[136:139], v[88:91]
    v_exp_f32 v196, v196
    v_mfma_f32_16x16x32_bf16 v[252:255], v[40:43], v[224:227], v[252:255]
    v_mfma_f32_16x16x32_bf16 v[244:247], v[16:19], v[224:227], v[244:247]
    ds_read_b128 v[184:187], v4 offset:640
    s_waitcnt lgkmcnt(1)
    v_mfma_f32_16x16x32_bf16 v[244:247], v[20:23], v[228:231], v[244:247]
    v_exp_f32 v206, v206
    v_mfma_f32_16x16x32_bf16 v[248:251], v[32:35], v[228:231], v[248:251]
    v_exp_f32 v210, v210
    s_mul_i32 s60, s39, 6
    s_mul_i32 s58, s39, 3
    v_exp_f32 v202, v202
    v_exp_f32 v198, v198
    s_nop 0
    v_cvt_pk_bf16_f32 v244, v244, v245
    v_exp_f32 v200, v200
    v_permlane32_swap_b32 v169, v171
    v_permlane32_swap_b32 v168, v170
    v_rcp_f32 v170, v170
    v_cvt_pk_bf16_f32 v245, v246, v247
    v_cvt_pk_bf16_f32 v217, v206, v207
    v_cvt_pk_bf16_f32 v219, v210, 0
    v_cvt_pk_bf16_f32 v247, v250, v251
    v_cvt_pk_bf16_f32 v246, v248, v249
    v_mfma_f32_16x16x32_bf16 v[248:251], v[24:27], v[232:235], 0
    v_exp_f32 v197, v197
    v_exp_f32 v208, v208
    v_exp_f32 v209, v209
    ds_write_b128 v1, v[244:247] offset:32400
    s_setprio 2
    s_setprio 0
    s_waitcnt lgkmcnt(1)
    v_mfma_f32_16x16x32_bf16 v[252:255], v[44:47], v[228:231], v[252:255]
    v_mfma_f32_16x16x32_bf16 v[244:247], v[12:15], v[232:235], 0
    v_mfma_f32_16x16x32_bf16 v[244:247], v[16:19], v[236:239], v[244:247]
    v_exp_f32 v199, v199
    v_mfma_f32_16x16x32_bf16 v[140:143], v[188:191], v[212:215], v[140:143]
    v_exp_f32 v201, v201
    v_mfma_f32_16x16x32_bf16 v[248:251], v[28:31], v[236:239], v[248:251]
    v_exp_f32 v204, v204
    v_mul_f32 v164, v170, v164
    v_cvt_pk_bf16_f32 v252, v252, v253
    v_mfma_f32_16x16x32_bf16 v[248:251], v[32:35], v[240:243], v[248:251]
    v_cvt_pk_bf16_f32 v216, v204, v205
    v_mul_f32 v165, v170, v165
    v_mfma_f32_16x16x32_bf16 v[144:147], v[192:195], v[212:215], v[144:147]
    v_mul_f32 v168, v170, v168
    v_mfma_f32_16x16x32_bf16 v[244:247], v[20:23], v[240:243], v[244:247]
    v_mul_f32 v166, v170, v166
    v_cvt_pk_bf16_f32 v253, v254, v255
    v_mfma_f32_16x16x32_bf16 v[204:207], v[180:183], v[128:131], v[108:111]
    ds_write_b64 v2, v[252:253] offset:37520
    v_cvt_pk_bf16_f32 v215, v202, 0
    v_cvt_pk_bf16_f32 v218, v208, v209
    s_setprio 0
    v_mul_f32 v167, v170, v167
    v_cvt_pk_bf16_f32 v212, v196, v197
    v_mfma_f32_16x16x32_bf16 v[148:151], v[188:191], v[216:219], v[148:151]
    v_cvt_pk_bf16_f32 v213, v198, v199
    v_mfma_f32_16x16x32_bf16 v[196:199], v[180:183], v[132:135], v[100:103]
    v_cvt_pk_bf16_f32 v214, v200, v201
    s_nop 6
    v_exp_f32 v199, v199
    v_mfma_f32_16x16x32_bf16 v[156:159], v[188:191], v[212:215], 0
    v_cvt_pk_bf16_f32 v164, v164, v165
    v_cvt_pk_bf16_f32 v165, v166, v167
    v_mfma_f32_16x16x32_bf16 v[152:155], v[192:195], v[216:219], v[152:155]
    ds_read_b64_tr_b16 v[190:191], v6 offset:5440
    v_mfma_f32_16x16x32_bf16 v[208:211], v[184:187], v[128:131], v[112:115]
    ds_write_b64 v99, v[164:165] offset:24576
    v_mfma_f32_16x16x32_bf16 v[160:163], v[192:195], v[212:215], 0
    ds_read_b64_tr_b16 v[192:193], v7 offset:640
    ds_read_b64_tr_b16 v[194:195], v8 offset:640
    v_mfma_f32_16x16x32_bf16 v[200:203], v[184:187], v[132:135], v[104:107]
    ds_read_b64_tr_b16 v[188:189], v5 offset:5440
    v_cvt_pk_bf16_f32 v244, v244, v245
    v_cvt_pk_bf16_f32 v245, v246, v247
    v_cvt_pk_bf16_f32 v247, v250, v251
    v_exp_f32 v209, v209
    s_nop 2
    v_exp_f32 v200, v200
    v_mfma_f32_16x16x32_bf16 v[252:255], v[36:39], v[232:235], 0
    v_exp_f32 v207, v207
    v_exp_f32 v196, v196
    v_mfma_f32_16x16x32_bf16 v[252:255], v[40:43], v[236:239], v[252:255]
    s_waitcnt lgkmcnt(0)
    v_exp_f32 v204, v204
    v_mfma_f32_16x16x32_bf16 v[252:255], v[44:47], v[240:243], v[252:255]
    v_cvt_pk_bf16_f32 v246, v248, v249
    v_exp_f32 v208, v208
    v_exp_f32 v206, v206
    v_mul_f32 v169, v170, v169
    v_cvt_pk_bf16_f32 v217, v206, v207
    s_add_u32 s58, s58, s54
    v_exp_f32 v205, v205
    v_exp_f32 v210, v210
    s_nop 0
    v_cvt_pk_bf16_f32 v219, v210, 0
    v_cvt_pk_bf16_f32 v252, v252, v253
    v_cvt_pk_bf16_f32 v216, v204, v205
    v_cvt_pk_bf16_f32 v253, v254, v255
    v_cvt_pk_bf16_f32 v218, v208, v209
    ds_write_b128 v1, v[244:247] offset:32912
    ds_write_b64 v2, v[252:253] offset:37776
    v_mfma_f32_16x16x32_bf16 v[144:147], v[192:195], v[216:219], v[144:147]
    v_exp_f32 v201, v201
    v_mfma_f32_16x16x32_bf16 v[140:143], v[188:191], v[216:219], v[140:143]
    v_exp_f32 v202, v202
    v_exp_f32 v197, v197
    v_cvt_pk_bf16_f32 v166, v168, v169
    v_cvt_pk_bf16_f32 v215, v202, 0
    v_mfma_f32_16x16x32_bf16 v[208:211], v[184:187], v[136:139], v[96:99]
    s_nop 0
    v_permlane32_swap_b32 v145, v147
    v_permlane32_swap_b32 v144, v146
    v_rcp_f32 v146, v146
    ds_write_b32 v107, v166 offset:26624
    v_mul_f32 v140, v146, v140
    v_mul_f32 v144, v146, v144
    v_mul_f32 v142, v146, v142
    v_mul_f32 v145, v146, v145
    v_mul_f32 v141, v146, v141
    v_cvt_pk_bf16_f32 v212, v196, v197
    v_mul_f32 v143, v146, v143
    v_cvt_pk_bf16_f32 v140, v140, v141
    v_cvt_pk_bf16_f32 v141, v142, v143
    ds_write_b64 v99, v[140:141] offset:30720
    v_exp_f32 v198, v198
    v_mfma_f32_16x16x32_bf16 v[204:207], v[180:183], v[136:139], v[92:95]
    v_cvt_pk_bf16_f32 v142, v144, v145
    v_cvt_pk_bf16_f32 v213, v198, v199
    ds_write_b32 v107, v142 offset:32768
    v_exp_f32 v210, v210
    v_cvt_pk_bf16_f32 v214, v200, v201
    v_cvt_pk_bf16_f32 v219, v210, 0
    s_nop 0
    v_mfma_f32_16x16x32_bf16 v[152:155], v[192:195], v[212:215], v[152:155]
    v_exp_f32 v205, v205
    s_setprio 3
    v_exp_f32 v207, v207
    v_exp_f32 v204, v204
    v_mfma_f32_16x16x32_bf16 v[148:151], v[188:191], v[212:215], v[148:151]
    s_waitcnt lgkmcnt(0)
    s_barrier
    ds_read_b128 v[220:223], v10 offset:24576
    ds_read_b128 v[224:227], v10 offset:25600
    v_exp_f32 v208, v208
    ds_read_b128 v[228:231], v10 offset:26624
    ds_read_b128 v[184:187], v4 offset:33040
    v_exp_f32 v206, v206
    s_waitcnt lgkmcnt(3)
    v_mfma_f32_16x16x32_bf16 v[248:251], v[60:63], v[220:223], 0
    ds_read_b128 v[172:175], v3 offset:32400
    v_mfma_f32_16x16x32_bf16 v[252:255], v[72:75], v[220:223], 0
    ds_read_b128 v[180:183], v3 offset:33040
    v_cvt_pk_bf16_f32 v217, v206, v207
    s_waitcnt lgkmcnt(4)
    ds_read_b128 v[176:179], v4 offset:32400
    v_mfma_f32_16x16x32_bf16 v[244:247], v[48:51], v[220:223], 0
    v_exp_f32 v209, v209
    v_mfma_f32_16x16x32_bf16 v[244:247], v[52:55], v[224:227], v[244:247]
    s_waitcnt lgkmcnt(4)
    v_mfma_f32_16x16x32_bf16 v[248:251], v[64:67], v[224:227], v[248:251]
    v_cvt_pk_bf16_f32 v216, v204, v205
    v_mfma_f32_16x16x32_bf16 v[244:247], v[56:59], v[228:231], v[244:247]
    s_waitcnt lgkmcnt(2)
    s_setprio 3
    v_mfma_f32_16x16x32_bf16 v[248:251], v[68:71], v[228:231], v[248:251]
    s_nop 4
    v_cvt_pk_bf16_f32 v244, v244, v245
    v_cvt_pk_bf16_f32 v245, v246, v247
    v_cvt_pk_bf16_f32 v218, v208, v209
    s_waitcnt lgkmcnt(0)
    v_mfma_f32_16x16x32_bf16 v[200:203], v[176:179], v[132:135], v[112:115]
    v_mov_b32 v13, 1
    v_cvt_pk_bf16_f32 v247, v250, v251
L_t0:
    s_cbranch_execz L_back0
    v_mfma_f32_16x16x32_bf16 v[252:255], v[76:79], v[224:227], v[252:255]
    v_cvt_pk_bf16_f32 v246, v248, v249
    v_mfma_f32_16x16x32_bf16 v[252:255], v[80:83], v[228:231], v[252:255]
    buffer_store_dwordx4 v[244:247], v115, s[28:31], s58 offen sc0 sc1
    s_nop 1
    v_exp_f32 v201, v201
    v_mfma_f32_16x16x32_bf16 v[196:199], v[172:175], v[132:135], v[108:111]
    v_exp_f32 v202, v202
    v_mfma_f32_16x16x32_bf16 v[160:163], v[192:195], v[216:219], v[160:163]
    ds_read_b64_tr_b16 v[192:193], v7 offset:32400
    v_cvt_pk_bf16_f32 v252, v252, v253
    v_exp_f32 v200, v200
    s_nop 0
    v_cvt_pk_bf16_f32 v214, v200, v201
    v_cvt_pk_bf16_f32 v253, v254, v255
    v_exp_f32 v198, v198
    v_exp_f32 v196, v196
    v_exp_f32 v199, v199
    v_mov_b32 v15, 160100
    v_exp_f32 v197, v197
    s_nop 0
    v_cvt_pk_bf16_f32 v212, v196, v197
    v_cvt_pk_bf16_f32 v215, v202, 0
    s_setprio 3
    v_mfma_f32_16x16x32_bf16 v[204:207], v[172:175], v[136:139], v[100:103]
    s_waitcnt lgkmcnt(0)
    ds_read_b64_tr_b16 v[194:195], v8 offset:32400
    buffer_store_dwordx2 v[252:253], v11, s[28:31], s58 offen offset:64 sc0 sc1
    s_setprio 2
    v_cvt_pk_bf16_f32 v213, v198, v199
    v_mfma_f32_16x16x32_bf16 v[156:159], v[188:191], v[216:219], v[156:159]
    ds_read_b64_tr_b16 v[188:189], v5 offset:37520
    v_mfma_f32_16x16x32_bf16 v[200:203], v[184:187], v[136:139], v[112:115]
    ds_read_b64_tr_b16 v[190:191], v6 offset:37520
    s_waitcnt lgkmcnt(2)
    v_mfma_f32_16x16x32_bf16 v[152:155], v[192:195], v[212:215], v[152:155]
    s_nop 7
    v_permlane32_swap_b32 v152, v154
    v_mfma_f32_16x16x32_bf16 v[208:211], v[176:179], v[136:139], v[104:107]
    s_waitcnt lgkmcnt(0)
    v_rcp_f32 v154, v154
    v_mfma_f32_16x16x32_bf16 v[148:151], v[188:191], v[212:215], v[148:151]
    s_nop 4
    v_exp_f32 v209, v209
    v_mul_f32 v152, v154, v152
    s_nop 0
    v_mul_f32 v148, v154, v148
    v_mul_f32 v150, v154, v150
    v_mul_f32 v151, v154, v151
    v_mul_f32 v149, v154, v149
    v_cvt_pk_bf16_f32 v148, v148, v149
    v_cvt_pk_bf16_f32 v149, v150, v151
    v_mfma_f32_16x16x32_bf16 v[196:199], v[180:183], v[136:139], v[108:111]
    ds_write_b64 v99, v[148:149] offset:36864
    v_permlane32_swap_b32 v153, v155
    v_exp_f32 v205, v205
    v_mul_f32 v153, v154, v153
    v_exp_f32 v201, v201
    v_cvt_pk_bf16_f32 v150, v152, v153
    v_exp_f32 v204, v204
    ds_write_b32 v107, v150 offset:38912
    v_exp_f32 v208, v208
    v_exp_f32 v202, v202
    v_cvt_pk_bf16_f32 v218, v208, v209
    v_exp_f32 v207, v207
    v_exp_f32 v206, v206
    v_exp_f32 v210, v210
    v_cvt_pk_bf16_f32 v217, v206, v207
    v_exp_f32 v199, v199
    v_cvt_pk_bf16_f32 v216, v204, v205
    v_cvt_pk_bf16_f32 v219, v210, 0
    s_nop 1
    v_mfma_f32_16x16x32_bf16 v[156:159], v[188:191], v[216:219], v[156:159]
    s_waitcnt lgkmcnt(0)
    s_barrier
    v_exp_f32 v198, v198
    v_exp_f32 v196, v196
    v_cvt_pk_bf16_f32 v213, v198, v199
    v_exp_f32 v200, v200
    v_mfma_f32_16x16x32_bf16 v[160:163], v[192:195], v[216:219], v[160:163]
    v_cvt_pk_bf16_f32 v214, v200, v201
    ds_read_b128 v[232:235], v10 offset:36864
    ds_read_b64_tr_b16 v[192:193], v7 offset:33040
    v_exp_f32 v197, v197
    s_nop 0
    v_cvt_pk_bf16_f32 v212, v196, v197
    s_add_u32 s59, s59, s54
    ds_read_b64_tr_b16 v[194:195], v8 offset:33040
    ds_read_b64_tr_b16 v[190:191], v6 offset:37840
    ds_read_b64_tr_b16 v[188:189], v5 offset:37840
    ds_read_b128 v[240:243], v10 offset:38912
    v_cvt_pk_bf16_f32 v215, v202, 0
    s_waitcnt lgkmcnt(2)
    ds_read_b128 v[236:239], v10 offset:37888
    v_mfma_f32_16x16x32_bf16 v[160:163], v[192:195], v[212:215], v[160:163]
    v_max3_f32 v9, v9, v170, v171
    s_waitcnt lgkmcnt(2)
    v_mfma_f32_16x16x32_bf16 v[156:159], v[188:191], v[212:215], v[156:159]
    s_nop 4
    v_permlane32_swap_b32 v160, v162
    v_rcp_f32 v162, v162
    v_permlane32_swap_b32 v161, v163
    v_mul_f32 v156, v162, v156
    v_mul_f32 v158, v162, v158
    v_mul_f32 v157, v162, v157
    v_mul_f32 v159, v162, v159
    v_cvt_pk_bf16_f32 v156, v156, v157
    v_cvt_pk_bf16_f32 v157, v158, v159
    s_setprio 2
    ds_write_b64 v99, v[156:157] offset:43008
    v_mul_f32 v161, v162, v161
    v_mul_f32 v160, v162, v160
    v_cvt_pk_bf16_f32 v158, v160, v161
    ds_write_b32 v107, v158 offset:45056
    v_mfma_f32_16x16x32_bf16 v[252:255], v[72:75], v[232:235], 0
    v_max3_f32 v9, v9, v146, v147
    v_max3_f32 v9, v9, v154, v155
    v_lshrrev_b32 v12, 29, v115
    v_max3_f32 v9, v9, v162, v163
    v_cmp_nge_f32 vcc, 0x5f800000, v9
    v_add_u32 v12, 160096, v12
    s_nop 0
    v_cndmask_b32 v15, v15, v12, vcc
    ds_write_b32 v15, v13
    s_waitcnt lgkmcnt(3)
    v_mfma_f32_16x16x32_bf16 v[252:255], v[76:79], v[236:239], v[252:255]
    v_mfma_f32_16x16x32_bf16 v[252:255], v[80:83], v[240:243], v[252:255]
    s_nop 7
    v_cvt_pk_bf16_f32 v252, v252, v253
    v_cvt_pk_bf16_f32 v253, v254, v255
    buffer_store_dwordx2 v[252:253], v11, s[28:31], s59 offen offset:64
    s_waitcnt lgkmcnt(0)
    s_barrier
    ds_read_b32 v14, v12
    ds_read_b128 v[220:223], v10 offset:43008
    ds_read_b128 v[224:227], v10 offset:44032
    ds_read_b128 v[228:231], v10 offset:45056
    s_setprio 0
    s_setprio 3
    s_waitcnt lgkmcnt(2)
    v_mfma_f32_16x16x32_bf16 v[248:251], v[60:63], v[220:223], 0
    v_mfma_f32_16x16x32_bf16 v[244:247], v[48:51], v[220:223], 0
    s_waitcnt lgkmcnt(1)
    v_mfma_f32_16x16x32_bf16 v[244:247], v[52:55], v[224:227], v[244:247]
    s_setprio 1
    v_mfma_f32_16x16x32_bf16 v[248:251], v[64:67], v[224:227], v[248:251]
    s_waitcnt lgkmcnt(0)
    v_mfma_f32_16x16x32_bf16 v[248:251], v[68:71], v[228:231], v[248:251]
    v_mfma_f32_16x16x32_bf16 v[244:247], v[56:59], v[228:231], v[244:247]
    s_add_u32 s60, s60, s54
    s_nop 6
    v_cvt_pk_bf16_f32 v244, v244, v245
    v_cvt_pk_bf16_f32 v245, v246, v247
    v_cvt_pk_bf16_f32 v247, v250, v251
    v_cvt_pk_bf16_f32 v246, v248, v249
    buffer_store_dwordx4 v[244:247], v115, s[28:31], s60 offen
    v_readfirstlane_b32 s63, v14
    s_nop 0
    s_cmp_eq_u32 s63, 0
    s_cbranch_scc0 L_safe
    s_endpgm
.p2align 12
L_t5:
    s_cbranch_execz L_back1
L_m1:
    s_barrier
    ds_read_b128 v[220:223], v0 offset:3072
    s_and_b32 s56, s36, 5
    s_waitcnt lgkmcnt(5)
    s_mul_i32 s4, s56, 9216
    v_mov_b32 v50, 0x1d1c1918
    s_setprio 3
    s_lshl_b32 s55, s56, 10
    v_and_b32 v58, 7, v155
    s_add_u32 m0, s55, 82816
    v_bfe_u32 v69, v152, 2, 1
    s_and_b32 s56, s36, 2
    s_lshl_b32 s57, s56, 5
    s_mul_i32 s56, s56, 3072
    v_add_u32 v56, 3, v155
    buffer_load_dwordx4 v139, s[20:23], s4 offen offset:128 lds
    v_mov_b32 v51, 0x1f1e1b1a
    s_add_u32 s4, s4, s57
    s_add_u32 s55, s55, s56
    s_add_u32 m0, s55, 70656
    ds_read_b64_tr_b16 v[14:15], v132 offset:18688
    v_mov_b32 v48, 0x01201514
    v_or_b32 v58, 0x0c0c0c00, v58
    v_and_b32 v54, 7, v153
    ds_read_b64_tr_b16 v[26:27], v133 offset:18688
    v_bfe_u32 v68, v152, 3, 1
    s_add_u32 s56, s49, 3952
    ds_read_b64_tr_b16 v[24:25], v133 offset:18432
    ds_read_b64_tr_b16 v[20:21], v132 offset:22528
    v_lshl_add_u32 v60, v156, 3, s56
    s_setprio 1
    ds_read_b64_tr_b16 v[28:29], v133 offset:20480
    ds_read_b64_tr_b16 v[30:31], v133 offset:20736
    v_or_b32 v54, 0x0c0c0c00, v54
    v_mov_b32 v49, 0x03021716
    v_perm_b32 v59, v49, v48, v58
    v_cmp_gt_u32 vcc, 7, v159
    v_cmp_gt_u32 s[66:67], 2, v156
    v_cmp_gt_u32 s[64:65], 8, v155
    v_mul_u32_u24 v68, 24, v68
    v_add3_u32 v68, v68, v69, 20
    v_perm_b32 v57, v51, v50, v58
    v_cndmask_b32 v57, v57, v59, s[64:65]
    s_mov_b32 s64, 0x0ff00ff0
    ds_read_b64_tr_b16 v[34:35], v133 offset:22784
    s_mov_b32 s65, 0x0ff00ff0
    v_mov_b32 v61, 127040
    ds_read_b64_tr_b16 v[36:37], v134 offset:18432
    ds_read_b64_tr_b16 v[44:45], v134 offset:22528
    v_perm_b32 v55, v49, v48, v54
    ds_read_b64_tr_b16 v[46:47], v134 offset:22784
    v_and_b32 v56, 16, v56
    v_perm_b32 v53, v51, v50, v54
    s_setprio 1
    s_cmp_eq_u32 s46, 0
    ds_read_b128 v[232:235], v0 offset:9216
    v_cndmask_b32 v84, v84, v91, s[64:65]
    ds_read_b128 v[224:227], v0 offset:3136
    v_add_u32 v56, v56, v155
    s_waitcnt lgkmcnt(3)
    s_cselect_b64 s[64:65], -1, 0
    ds_read_b64_tr_b16 v[42:43], v134 offset:20736
    v_cndmask_b32 v80, v84, v91, s[64:65]
    s_setprio 3
    v_lshl_add_u32 v7, v56, 4, v60
    v_cndmask_b32 v7, v61, v7, s[66:67]
    ds_read_b64_tr_b16 v[18:19], v132 offset:20736
    ds_read_b64_tr_b16 v[12:13], v132 offset:18432
    v_lshl_add_u32 v8, v57, 4, v60
    v_cndmask_b32 v8, v61, v8, s[66:67]
    s_mov_b32 s67, 0x00000ff0
    s_mov_b32 s68, 0x00000000
    ds_read_b64_tr_b16 v[16:17], v132 offset:20480
    s_mov_b32 s66, 0x0ff00ff0
    ds_read_b64_tr_b16 v[22:23], v132 offset:22784
    v_cmp_gt_u32 s[70:71], 8, v153
    v_cndmask_b32 v87, v87, v91, s[66:67]
    v_cndmask_b32 v86, v86, v91, s[66:67]
    s_setprio 2
    s_waitcnt lgkmcnt(5)
    v_mfma_f32_16x16x32_bf16 v[248:251], v[24:27], v[220:223], 0
    ds_read_b128 v[236:239], v0 offset:9280
    v_cndmask_b32 v53, v53, v55, s[70:71]
    v_cndmask_b32 v85, v85, v91, s[66:67]
    s_waitcnt lgkmcnt(2)
    ds_read_b128 v[228:231], v0 offset:3200
    s_mov_b32 s66, s64
    ds_read_b64_tr_b16 v[32:33], v133 offset:22528
    v_cndmask_b32 v164, v84, v164, s[64:65]
    s_mov_b32 s71, 0xf00ff00f
    v_cndmask_b32 v167, v87, v167, s[64:65]
    s_and_b32 s67, s64, 0xffff
    v_cndmask_b32 v83, v87, v91, s[66:67]
    v_mfma_f32_16x16x32_bf16 v[244:247], v[12:15], v[220:223], 0
    ds_read_b64_tr_b16 v[38:39], v134 offset:18688
    buffer_load_dwordx4 v139, s[20:23], s4 offen lds
    ds_read_b64_tr_b16 v[40:41], v134 offset:20480
    v_cndmask_b32 v79, v95, v91, s[66:67]
    v_mfma_f32_16x16x32_bf16 v[244:247], v[16:19], v[224:227], v[244:247]
    s_mov_b32 s70, 0xf00ff00f
    v_cndmask_b32 v82, v86, v91, s[66:67]
    v_cndmask_b32 v81, v85, v91, s[66:67]
    v_cndmask_b32 v77, v93, v91, s[66:67]
    s_mov_b32 s69, 0xf00f0000
    v_cndmask_b32 v78, v94, v91, s[66:67]
    v_cndmask_b32 v165, v85, v165, s[64:65]
    v_cndmask_b32 v169, v89, v169, s[64:65]
    v_mfma_f32_16x16x32_bf16 v[248:251], v[28:31], v[224:227], v[248:251]
    v_cndmask_b32 v168, v88, v168, s[64:65]
    s_waitcnt lgkmcnt(1)
    s_andn2_b64 s[66:67], s[68:69], s[64:65]
    v_cndmask_b32 v170, v90, v170, s[64:65]
    v_cndmask_b32 v76, v92, v91, s[64:65]
    v_cndmask_b32 v166, v86, v166, s[64:65]
    s_andn2_b64 s[64:65], s[70:71], s[64:65]
    s_lshr_b32 s56, s37, 1
    v_mfma_f32_16x16x32_bf16 v[252:255], v[36:39], v[220:223], 0
    ds_read_b128 v[240:243], v0 offset:9344
    v_cndmask_b32 v114, v114, v91, s[64:65]
    v_mad_u32_u24 v63, v157, 20, v158
    s_and_b32 s50, s37, 1
    s_lshl_b32 s59, s56, 10
    s_lshl3_add_u32 s59, s50, s59
    ds_read_b128 v[220:223], v0 offset:12288
    s_waitcnt lgkmcnt(2)
    v_lshl_add_u32 v99, v152, 4, s59
    v_mfma_f32_16x16x32_bf16 v[252:255], v[40:43], v[224:227], v[252:255]
    v_and_b32 v69, 2, v154
    s_mul_i32 s51, s56, 3072
    v_mfma_f32_16x16x32_bf16 v[244:247], v[20:23], v[228:231], v[244:247]
    s_lshl_b32 s59, s37, 2
    s_mul_i32 s56, s56, 7
    v_lshl_add_u32 v107, v152, 4, s59
    s_sub_u32 s51, s51, s59
    s_add_u32 s56, s56, s41
    s_mul_i32 s59, s50, 128
    s_add_u32 s56, s56, 3
    s_add_u32 s59, s59, s47
    v_lshl_add_u32 v67, v154, 4, s59
    s_mul_i32 s59, s45, 12
    v_mfma_f32_16x16x32_bf16 v[252:255], v[44:47], v[228:231], v[252:255]
    s_add_u32 s59, s59, s40
    v_add_u32 v63, 70, v63
    s_add_u32 s59, s59, 3
    v_mfma_f32_16x16x32_bf16 v[248:251], v[32:35], v[228:231], v[248:251]
    ds_read_b128 v[228:231], v0 offset:12416
    s_and_b32 s52, s37, 1
    s_add_u32 s48, s48, s39
    ds_read_b128 v[224:227], v0 offset:12352
    s_add_u32 m0, s42, 30720
    s_nop 0
    buffer_load_dwordx4 v136, s[16:19], s48 offen lds
    v_cvt_pk_bf16_f32 v244, v244, v245
    v_cvt_pk_bf16_f32 v245, v246, v247
    v_cvt_pk_bf16_f32 v247, v250, v251
    v_cvt_pk_bf16_f32 v246, v248, v249
    v_mfma_f32_16x16x32_bf16 v[248:251], v[24:27], v[232:235], 0
    s_mul_i32 s53, s52, 9216
    v_mfma_f32_16x16x32_bf16 v[248:251], v[28:31], v[236:239], v[248:251]
    s_waitcnt lgkmcnt(3)
    s_movk_i32 s61, -18432
    v_cvt_pk_bf16_f32 v252, v252, v253
    v_cvt_pk_bf16_f32 v253, v254, v255
    v_mfma_f32_16x16x32_bf16 v[248:251], v[32:35], v[240:243], v[248:251]
    ds_write_b64 v2, v[252:253] offset:37648
    v_add_u32 v52, 3, v153
    v_mfma_f32_16x16x32_bf16 v[252:255], v[36:39], v[232:235], 0
    v_sub_u32 v10, v159, v158
    v_mov_b32 v9, 0
    v_mfma_f32_16x16x32_bf16 v[252:255], v[40:43], v[236:239], v[252:255]
    s_add_u32 s48, s48, s39
    ds_write_b128 v1, v[244:247] offset:32656
    v_mfma_f32_16x16x32_bf16 v[244:247], v[12:15], v[232:235], 0
    s_setprio 0
    v_mfma_f32_16x16x32_bf16 v[244:247], v[16:19], v[236:239], v[244:247]
    v_mfma_f32_16x16x32_bf16 v[244:247], v[20:23], v[240:243], v[244:247]
    s_waitcnt lgkmcnt(2)
    v_mad_i32_i24 v135, v162, s61, v132
    s_add_u32 m0, s42, 38400
    v_xor_b32 v137, 8, v135
    buffer_load_dwordx4 v136, s[16:19], s48 offen lds
    v_mfma_f32_16x16x32_bf16 v[252:255], v[44:47], v[240:243], v[252:255]
    s_nop 1
    v_cvt_pk_bf16_f32 v244, v244, v245
    v_cvt_pk_bf16_f32 v245, v246, v247
    v_cvt_pk_bf16_f32 v246, v248, v249
    v_cvt_pk_bf16_f32 v247, v250, v251
    s_nop 1
    v_cvt_pk_bf16_f32 v252, v252, v253
    v_cvt_pk_bf16_f32 v253, v254, v255
    ds_write_b64 v2, v[252:253] offset:37904
    v_mfma_f32_16x16x32_bf16 v[252:255], v[36:39], v[220:223], 0
    ds_write_b32 v61, v9 offset:33056
    v_mfma_f32_16x16x32_bf16 v[252:255], v[40:43], v[224:227], v[252:255]
    ds_write_b128 v1, v[244:247] offset:33168
    v_mfma_f32_16x16x32_bf16 v[244:247], v[12:15], v[220:223], 0
    s_add_u32 s48, s48, s39
    v_mfma_f32_16x16x32_bf16 v[244:247], v[16:19], v[224:227], v[244:247]
    v_mfma_f32_16x16x32_bf16 v[244:247], v[20:23], v[228:231], v[244:247]
    v_mfma_f32_16x16x32_bf16 v[248:251], v[24:27], v[220:223], 0
    v_mfma_f32_16x16x32_bf16 v[252:255], v[44:47], v[228:231], v[252:255]
    v_mul_u32_u24 v65, 192, v63
    v_mfma_f32_16x16x32_bf16 v[248:251], v[28:31], v[224:227], v[248:251]
    v_mul_u32_u24 v62, 704, v156
    v_mad_i32_i24 v68, v161, -2, v68
    v_mfma_f32_16x16x32_bf16 v[248:251], v[32:35], v[228:231], v[248:251]
    s_nop 0
    v_cvt_pk_bf16_f32 v244, v244, v245
    v_lshrrev_b32 v64, 1, v63
    v_cndmask_b32 v109, v109, v91, s[66:67]
    v_add_u32 v68, v69, v68
    v_and_b32 v52, 16, v52
    v_cvt_pk_bf16_f32 v245, v246, v247
    v_cvt_pk_bf16_f32 v252, v252, v253
    v_cvt_pk_bf16_f32 v246, v248, v249
    v_cvt_pk_bf16_f32 v247, v250, v251
    v_cvt_pk_bf16_f32 v253, v254, v255
    ds_write_b128 v1, v[244:247] offset:33424
    ds_write_b64 v2, v[252:253] offset:38032
    s_waitcnt vmcnt(2) lgkmcnt(0)
    s_barrier
    s_add_u32 m0, s42, 46080
    s_nop 0
    buffer_load_dwordx4 v136, s[16:19], s48 offen lds
    s_add_u32 s48, s48, s39
    s_add_u32 m0, s42, 53760
    ds_read_b64_tr_b16 v[50:51], v135 offset:256
    v_lshl_add_u32 v4, v53, 4, v163
    s_setprio 1
    ds_read_b128 v[232:235], v0 offset:18432
    v_add_u32 v66, s56, v158
    v_mad_u32_u24 v66, v66, s43, v67
    ds_read_b64_tr_b16 v[70:71], v137 offset:4352
    v_add_u32 v52, v52, v153
    v_and_b32 v64, 2, v64
    ds_read_b64_tr_b16 v[192:193], v7 offset:32400
    v_xor_b32 v64, v64, v154
    v_lshl_add_u32 v11, v64, 4, v65
    v_add_u32 v67, s59, v157
    ds_read_b64_tr_b16 v[64:65], v137 offset:2048
    ds_read_b128 v[240:243], v0 offset:18560
    v_add_u32 v62, s49, v62
    v_lshl_add_u32 v6, v57, 3, v62
    s_waitcnt lgkmcnt(4)
    v_mad_i32_i24 v66, v67, s38, v66
    ds_read_b128 v[224:227], v11 offset:64
    v_mov_b32 v67, 0x80000000
    v_mfma_f32_16x16x32_bf16 v[248:251], v[24:27], v[232:235], 0
    v_mfma_f32_16x16x32_bf16 v[252:255], v[36:39], v[232:235], 0
    v_cndmask_b32 v115, v67, v66, vcc
    ds_read_b64_tr_b16 v[66:67], v137 offset:2304
    ds_read_b64_tr_b16 v[190:191], v6 offset:37576
    v_cndmask_b32 v112, v112, v91, s[64:65]
    ds_read_b128 v[236:239], v0 offset:18496
    v_cndmask_b32 v110, v110, v91, s[66:67]
    v_lshl_add_u32 v5, v56, 3, v62
    ds_read_b64_tr_b16 v[56:57], v135 offset:4096
    s_waitcnt lgkmcnt(5)
    v_or_b32 v10, v10, v160
    v_lshl_add_u32 v3, v52, 4, v163
    ds_read_b64_tr_b16 v[188:189], v5 offset:37576
    v_mfma_f32_16x16x32_bf16 v[244:247], v[12:15], v[232:235], 0
    ds_read_b64_tr_b16 v[58:59], v135 offset:4352
    ds_read_b64_tr_b16 v[52:53], v135 offset:2048
    s_waitcnt lgkmcnt(3)
    ds_read_b128 v[220:223], v11
    v_mfma_f32_16x16x32_bf16 v[244:247], v[16:19], v[236:239], v[244:247]
    v_add_u32 v10, -1, v10
    v_and_b32 v10, 0x3e96c740, v10
    v_mfma_f32_16x16x32_bf16 v[244:247], v[20:23], v[240:243], v[244:247]
    v_cndmask_b32 v113, v113, v91, s[64:65]
    v_cndmask_b32 v111, v111, v91, s[66:67]
    v_mfma_f32_16x16x32_bf16 v[252:255], v[40:43], v[236:239], v[252:255]
    s_nop 4
    v_cvt_pk_bf16_f32 v244, v244, v245
    s_waitcnt lgkmcnt(1)
    v_mul_u32_u24 v68, 192, v68
    v_lshl_add_u32 v138, v156, 4, v68
    v_cvt_pk_bf16_f32 v245, v246, v247
    ds_read_b64_tr_b16 v[60:61], v137
    v_mfma_f32_16x16x32_bf16 v[248:251], v[28:31], v[236:239], v[248:251]
    v_mfma_f32_16x16x32_bf16 v[252:255], v[44:47], v[240:243], v[252:255]
    ds_read_b128 v[236:239], v11 offset:7744
    s_mul_i32 s52, s52, 3072
    s_waitcnt lgkmcnt(2)
    ds_read_b64_tr_b16 v[68:69], v137 offset:4096
    v_mfma_f32_16x16x32_bf16 v[248:251], v[32:35], v[240:243], v[248:251]
    s_setprio 2
    ds_read_b64_tr_b16 v[62:63], v137 offset:256
    ds_read_b64_tr_b16 v[54:55], v135 offset:2304
    ds_read_b128 v[180:183], v3 offset:33152
    ds_read_b64_tr_b16 v[48:49], v135
    buffer_load_dwordx4 v136, s[16:19], s48 offen lds
    ds_read_b64_tr_b16 v[194:195], v8 offset:32400
    s_nop 0
    v_cvt_pk_bf16_f32 v247, v250, v251
    v_cvt_pk_bf16_f32 v252, v252, v253
    v_cvt_pk_bf16_f32 v253, v254, v255
    s_waitcnt lgkmcnt(1)
    v_cvt_pk_bf16_f32 v246, v248, v249
    ds_read_b128 v[228:231], v11 offset:128
    ds_write_b64 v2, v[252:253] offset:5248
    ds_write_b128 v1, v[244:247] offset:256
    v_mfma_f32_16x16x32_bf16 v[248:251], v[60:63], v[220:223], 0
    ds_read_b128 v[184:187], v4 offset:33152
    v_mfma_f32_16x16x32_bf16 v[244:247], v[48:51], v[220:223], 0
    s_add_u32 s48, s48, s39
    ds_read_b128 v[220:223], v0 offset:24576
    v_mfma_f32_16x16x32_bf16 v[244:247], v[52:55], v[224:227], v[244:247]
    s_waitcnt lgkmcnt(4)
    ds_read_b128 v[232:235], v11 offset:7680
    v_mfma_f32_16x16x32_bf16 v[244:247], v[56:59], v[228:231], v[244:247]
    ds_read_b128 v[172:175], v3 offset:32512
    ds_read_b128 v[240:243], v11 offset:7808
    v_mfma_f32_16x16x32_bf16 v[248:251], v[64:67], v[224:227], v[248:251]
    s_add_u32 m0, s42, 61440
    s_nop 0
    buffer_load_dwordx4 v136, s[16:19], s48 offen lds
    v_mfma_f32_16x16x32_bf16 v[248:251], v[68:71], v[228:231], v[248:251]
    ds_read_b128 v[228:231], v0 offset:24704
    v_mul_f32 v245, v10, v245
    ds_read_b128 v[176:179], v4 offset:32512
    ds_read_b128 v[224:227], v0 offset:24640
    v_mul_f32 v247, v10, v247
    s_waitcnt lgkmcnt(5)
    v_mul_f32 v244, v10, v244
    v_mul_f32 v246, v10, v246
    v_cvt_pk_bf16_f32 v73, v246, v247
    v_cvt_pk_bf16_f32 v72, v244, v245
    v_mfma_f32_16x16x32_bf16 v[244:247], v[48:51], v[232:235], 0
    v_mul_f32 v249, v10, v249
    s_waitcnt lgkmcnt(3)
    v_mfma_f32_16x16x32_bf16 v[244:247], v[52:55], v[236:239], v[244:247]
    v_mul_f32 v248, v10, v248
    v_mfma_f32_16x16x32_bf16 v[244:247], v[56:59], v[240:243], v[244:247]
    v_mul_f32 v250, v10, v250
    s_waitcnt lgkmcnt(1)
    v_mul_f32 v251, v10, v251
    v_mfma_f32_16x16x32_bf16 v[252:255], v[36:39], v[220:223], 0
    v_cvt_pk_bf16_f32 v74, v248, v249
    v_cvt_pk_bf16_f32 v75, v250, v251
    v_mfma_f32_16x16x32_bf16 v[248:251], v[60:63], v[232:235], 0
    s_waitcnt lgkmcnt(0)
    v_mul_f32 v245, v10, v245
    v_mfma_f32_16x16x32_bf16 v[248:251], v[64:67], v[236:239], v[248:251]
    s_add_u32 m0, s52, 89152
    v_mfma_f32_16x16x32_bf16 v[248:251], v[68:71], v[240:243], v[248:251]
    v_mul_f32 v244, v10, v244
    v_mul_f32 v246, v10, v246
    v_mul_f32 v247, v10, v247
    v_mfma_f32_16x16x32_bf16 v[204:207], v[172:175], v[72:75], v[164:167]
    v_cvt_pk_bf16_f32 v117, v246, v247
    v_cvt_pk_bf16_f32 v116, v244, v245
    v_mfma_f32_16x16x32_bf16 v[244:247], v[12:15], v[220:223], 0
    s_nop 0
    v_mul_f32 v250, v10, v250
    v_mul_f32 v251, v10, v251
    v_mfma_f32_16x16x32_bf16 v[244:247], v[16:19], v[224:227], v[244:247]
    v_cvt_pk_bf16_f32 v119, v250, v251
    v_mul_f32 v249, v10, v249
    v_mfma_f32_16x16x32_bf16 v[208:211], v[176:179], v[72:75], v[168:171]
    v_mul_f32 v248, v10, v248
    v_cvt_pk_bf16_f32 v118, v248, v249
    v_exp_f32 v205, v205
    v_mfma_f32_16x16x32_bf16 v[248:251], v[24:27], v[220:223], 0
    v_exp_f32 v206, v206
    v_mfma_f32_16x16x32_bf16 v[248:251], v[28:31], v[224:227], v[248:251]
    v_exp_f32 v204, v204
    v_mfma_f32_16x16x32_bf16 v[244:247], v[20:23], v[228:231], v[244:247]
    v_cvt_pk_bf16_f32 v216, v204, v205
    v_exp_f32 v208, v208
    v_mfma_f32_16x16x32_bf16 v[248:251], v[32:35], v[228:231], v[248:251]
    s_setprio 2
    v_exp_f32 v207, v207
    v_exp_f32 v209, v209
    s_nop 1
    v_cvt_pk_bf16_f32 v244, v244, v245
    v_cvt_pk_bf16_f32 v218, v208, v209
    v_exp_f32 v210, v210
    v_cvt_pk_bf16_f32 v217, v206, v207
    v_cvt_pk_bf16_f32 v245, v246, v247
    v_cvt_pk_bf16_f32 v247, v250, v251
    v_cvt_pk_bf16_f32 v219, v210, 0
    s_setprio 2
    s_nop 0
    v_mfma_f32_16x16x32_bf16 v[144:147], v[192:195], v[216:219], 0
    ds_read_b64_tr_b16 v[194:195], v8 offset:33040
    v_mfma_f32_16x16x32_bf16 v[196:199], v[180:183], v[72:75], v[76:79]
    ds_read_b64_tr_b16 v[192:193], v7 offset:33040
    v_cvt_pk_bf16_f32 v246, v248, v249
    ds_write_b128 v1, v[244:247] offset:768
    v_mfma_f32_16x16x32_bf16 v[140:143], v[188:191], v[216:219], 0
    v_mfma_f32_16x16x32_bf16 v[252:255], v[40:43], v[224:227], v[252:255]
    ds_read_b64_tr_b16 v[188:189], v5 offset:37896
    v_mfma_f32_16x16x32_bf16 v[252:255], v[44:47], v[228:231], v[252:255]
    ds_read_b64_tr_b16 v[190:191], v6 offset:37896
    v_mfma_f32_16x16x32_bf16 v[200:203], v[184:187], v[72:75], v[96:99]
    v_exp_f32 v197, v197
    v_exp_f32 v196, v196
    v_exp_f32 v198, v198
    v_exp_f32 v199, v199
    v_cvt_pk_bf16_f32 v212, v196, v197
    v_cvt_pk_bf16_f32 v213, v198, v199
    v_cvt_pk_bf16_f32 v252, v252, v253
    v_cvt_pk_bf16_f32 v253, v254, v255
    s_waitcnt lgkmcnt(0)
    v_exp_f32 v202, v202
    v_exp_f32 v200, v200
    ds_write_b64 v2, v[252:253] offset:5504
    v_exp_f32 v201, v201
    s_nop 0
    v_cvt_pk_bf16_f32 v214, v200, v201
    v_cvt_pk_bf16_f32 v215, v202, 0
    s_nop 1
    v_mfma_f32_16x16x32_bf16 v[140:143], v[188:191], v[212:215], v[140:143]
    v_add_u32 v0, 30720, v0
    v_mfma_f32_16x16x32_bf16 v[144:147], v[192:195], v[212:215], v[144:147]
    s_waitcnt vmcnt(3) lgkmcnt(0)
    s_barrier
    buffer_load_dwordx4 v138, s[32:35], s53 offen lds
    ds_read_b128 v[236:239], v11 offset:15424
    ds_read_b128 v[232:235], v11 offset:15360
    v_mfma_f32_16x16x32_bf16 v[204:207], v[180:183], v[116:119], v[80:83]
    ds_read_b128 v[240:243], v11 offset:15488
    s_add_u32 m0, s52, 90112
    s_nop 0
    buffer_load_dwordx4 v138, s[32:35], s53 offen offset:64 lds
    ds_read_b128 v[172:175], v3 offset:112
    v_mfma_f32_16x16x32_bf16 v[208:211], v[184:187], v[116:119], v[88:91]
    ds_read_b128 v[184:187], v4 offset:752
    s_add_u32 m0, s52, 91072
    s_setprio 2
    ds_read_b128 v[220:223], v0 offset:3072
    v_exp_f32 v206, v206
    s_waitcnt lgkmcnt(3)
    v_exp_f32 v204, v204
    v_mfma_f32_16x16x32_bf16 v[244:247], v[48:51], v[232:235], 0
    v_exp_f32 v205, v205
    s_waitcnt lgkmcnt(2)
    v_mfma_f32_16x16x32_bf16 v[248:251], v[60:63], v[232:235], 0
    ds_read_b128 v[176:179], v4 offset:112
    v_mfma_f32_16x16x32_bf16 v[244:247], v[52:55], v[236:239], v[244:247]
    v_exp_f32 v208, v208
    v_mfma_f32_16x16x32_bf16 v[248:251], v[64:67], v[236:239], v[248:251]
    s_waitcnt lgkmcnt(1)
    v_exp_f32 v207, v207
    v_mfma_f32_16x16x32_bf16 v[252:255], v[36:39], v[220:223], 0
    s_add_u32 s48, s48, s39
    buffer_load_dwordx4 v138, s[32:35], s53 offen offset:128 lds
    s_add_u32 m0, s42, 69120
    v_mfma_f32_16x16x32_bf16 v[248:251], v[68:71], v[240:243], v[248:251]
    v_exp_f32 v209, v209
    v_mfma_f32_16x16x32_bf16 v[196:199], v[172:175], v[72:75], v[100:103]
    v_cvt_pk_bf16_f32 v217, v206, v207
    v_cvt_pk_bf16_f32 v216, v204, v205
    v_mfma_f32_16x16x32_bf16 v[204:207], v[172:175], v[116:119], v[92:95]
    ds_read_b128 v[224:227], v0 offset:3136
    ds_read_b128 v[228:231], v0 offset:3200
    v_mfma_f32_16x16x32_bf16 v[244:247], v[56:59], v[240:243], v[244:247]
    s_waitcnt lgkmcnt(2)
    buffer_load_dwordx4 v136, s[16:19], s48 offen lds
    v_exp_f32 v197, v197
    v_mfma_f32_16x16x32_bf16 v[200:203], v[176:179], v[72:75], v[104:107]
    s_nop 0
    v_exp_f32 v206, v206
    ds_read_b128 v[180:183], v3 offset:752
    v_exp_f32 v207, v207
    v_exp_f32 v210, v210
    v_mul_f32 v245, v10, v245
    v_exp_f32 v204, v204
    v_mul_f32 v246, v10, v246
    s_waitcnt lgkmcnt(1)
    v_cvt_pk_bf16_f32 v219, v210, 0
    v_mul_f32 v244, v10, v244
    v_exp_f32 v199, v199
    v_cvt_pk_bf16_f32 v218, v208, v209
    s_nop 1
    v_mfma_f32_16x16x32_bf16 v[148:151], v[188:191], v[216:219], 0
    v_cvt_pk_bf16_f32 v120, v244, v245
    v_mul_f32 v247, v10, v247
    s_mul_i32 s56, s39, 0
    v_mul_f32 v249, v10, v249
    v_exp_f32 v201, v201
    v_exp_f32 v198, v198
    v_mul_f32 v248, v10, v248
    v_cvt_pk_bf16_f32 v121, v246, v247
    v_cvt_pk_bf16_f32 v213, v198, v199
    v_mfma_f32_16x16x32_bf16 v[152:155], v[192:195], v[216:219], 0
    ds_read_b64_tr_b16 v[192:193], v7
    ds_read_b128 v[240:243], v11 offset:23168
    v_mfma_f32_16x16x32_bf16 v[252:255], v[40:43], v[224:227], v[252:255]
    v_exp_f32 v205, v205
    v_mfma_f32_16x16x32_bf16 v[244:247], v[12:15], v[220:223], 0
    ds_read_b128 v[236:239], v11 offset:23104
    v_mul_f32 v251, v10, v251
    v_mfma_f32_16x16x32_bf16 v[252:255], v[44:47], v[228:231], v[252:255]
    v_exp_f32 v196, v196
    s_waitcnt lgkmcnt(3)
    v_mfma_f32_16x16x32_bf16 v[244:247], v[16:19], v[224:227], v[244:247]
    v_cvt_pk_bf16_f32 v122, v248, v249
    v_exp_f32 v202, v202
    v_cvt_pk_bf16_f32 v217, v206, v207
    v_mfma_f32_16x16x32_bf16 v[244:247], v[20:23], v[228:231], v[244:247]
    v_exp_f32 v200, v200
    s_nop 0
    v_cvt_pk_bf16_f32 v214, v200, v201
    v_mul_f32 v250, v10, v250
    v_cvt_pk_bf16_f32 v123, v250, v251
    v_mfma_f32_16x16x32_bf16 v[248:251], v[24:27], v[220:223], 0
    v_cvt_pk_bf16_f32 v215, v202, 0
    v_cvt_pk_bf16_f32 v252, v252, v253
    v_cvt_pk_bf16_f32 v212, v196, v197
    v_mfma_f32_16x16x32_bf16 v[248:251], v[28:31], v[224:227], v[248:251]
    s_waitcnt lgkmcnt(0)
    v_cvt_pk_bf16_f32 v244, v244, v245
    v_mfma_f32_16x16x32_bf16 v[196:199], v[172:175], v[120:123], v[84:87]
    ds_read_b128 v[232:235], v11 offset:23040
    s_setprio 3
    v_mfma_f32_16x16x32_bf16 v[208:211], v[176:179], v[116:119], v[96:99]
    v_mfma_f32_16x16x32_bf16 v[248:251], v[32:35], v[228:231], v[248:251]
    ds_read_b64_tr_b16 v[194:195], v8
    v_cvt_pk_bf16_f32 v245, v246, v247
    s_setprio 1
    ds_read_b128 v[220:223], v0 offset:9216
    v_exp_f32 v198, v198
    s_waitcnt lgkmcnt(2)
    v_mfma_f32_16x16x32_bf16 v[200:203], v[176:179], v[120:123], v[88:91]
    v_cvt_pk_bf16_f32 v253, v254, v255
    v_cvt_pk_bf16_f32 v216, v204, v205
    v_mfma_f32_16x16x32_bf16 v[204:207], v[180:183], v[72:75], v[108:111]
    s_waitcnt lgkmcnt(1)
    v_cvt_pk_bf16_f32 v246, v248, v249
    v_cvt_pk_bf16_f32 v247, v250, v251
    v_mfma_f32_16x16x32_bf16 v[248:251], v[60:63], v[232:235], 0
    v_mfma_f32_16x16x32_bf16 v[248:251], v[64:67], v[236:239], v[248:251]
    s_waitcnt lgkmcnt(0)
    ds_write_b128 v1, v[244:247] offset:32656
    v_mfma_f32_16x16x32_bf16 v[244:247], v[48:51], v[232:235], 0
    v_exp_f32 v205, v205
    v_exp_f32 v208, v208
    v_exp_f32 v202, v202
    v_exp_f32 v210, v210
    v_exp_f32 v209, v209
    v_cvt_pk_bf16_f32 v219, v210, 0
    v_mfma_f32_16x16x32_bf16 v[244:247], v[52:55], v[236:239], v[244:247]
    v_cvt_pk_bf16_f32 v218, v208, v209
    v_exp_f32 v197, v197
    v_mfma_f32_16x16x32_bf16 v[208:211], v[184:187], v[72:75], v[112:115]
    v_mfma_f32_16x16x32_bf16 v[244:247], v[56:59], v[240:243], v[244:247]
    v_mfma_f32_16x16x32_bf16 v[248:251], v[68:71], v[240:243], v[248:251]
    ds_read_b128 v[240:243], v0 offset:12416
    ds_read_b128 v[232:235], v0 offset:12288
    ds_read_b64_tr_b16 v[190:191], v6 offset:5176
    v_exp_f32 v201, v201
    ds_read_b64_tr_b16 v[188:189], v5 offset:5176
    s_nop 0
    v_exp_f32 v210, v210
    v_exp_f32 v199, v199
    s_waitcnt lgkmcnt(1)
    v_mul_f32 v250, v10, v250
    ds_read_b128 v[236:239], v0 offset:12352
    v_mfma_f32_16x16x32_bf16 v[152:155], v[192:195], v[216:219], v[152:155]
    v_mfma_f32_16x16x32_bf16 v[144:147], v[192:195], v[212:215], v[144:147]
    ds_read_b128 v[224:227], v0 offset:9280
    ds_read_b128 v[228:231], v0 offset:9344
    s_waitcnt lgkmcnt(3)
    v_mfma_f32_16x16x32_bf16 v[140:143], v[188:191], v[212:215], v[140:143]
    ds_write_b64 v2, v[252:253] offset:37648
    v_exp_f32 v200, v200
    v_mfma_f32_16x16x32_bf16 v[148:151], v[188:191], v[216:219], v[148:151]
    v_cvt_pk_bf16_f32 v215, v202, 0
    v_exp_f32 v206, v206
    v_cvt_pk_bf16_f32 v219, v210, 0
    v_mfma_f32_16x16x32_bf16 v[252:255], v[36:39], v[220:223], 0
    v_exp_f32 v196, v196
    v_mul_f32 v249, v10, v249
    v_cvt_pk_bf16_f32 v213, v198, v199
    v_exp_f32 v209, v209
    v_cvt_pk_bf16_f32 v212, v196, v197
    v_exp_f32 v204, v204
    v_cvt_pk_bf16_f32 v214, v200, v201
    v_exp_f32 v207, v207
    v_mul_f32 v248, v10, v248
    v_cvt_pk_bf16_f32 v126, v248, v249
    v_cvt_pk_bf16_f32 v216, v204, v205
    v_mfma_f32_16x16x32_bf16 v[156:159], v[188:191], v[212:215], 0
    s_waitcnt lgkmcnt(1)
    v_mul_f32 v245, v10, v245
    v_mfma_f32_16x16x32_bf16 v[160:163], v[192:195], v[212:215], 0
    ds_read_b64_tr_b16 v[190:191], v6 offset:5496
    v_mfma_f32_16x16x32_bf16 v[196:199], v[180:183], v[116:119], v[100:103]
    v_mfma_f32_16x16x32_bf16 v[200:203], v[184:187], v[116:119], v[104:107]
    v_mul_f32 v247, v10, v247
    v_mul_f32 v244, v10, v244
    v_mul_f32 v251, v10, v251
    v_mfma_f32_16x16x32_bf16 v[252:255], v[40:43], v[224:227], v[252:255]
    v_mul_f32 v246, v10, v246
    v_cvt_pk_bf16_f32 v127, v250, v251
    v_mfma_f32_16x16x32_bf16 v[248:251], v[24:27], v[220:223], 0
    ds_read_b64_tr_b16 v[194:195], v8 offset:640
    v_mfma_f32_16x16x32_bf16 v[252:255], v[44:47], v[228:231], v[252:255]
    ds_read_b64_tr_b16 v[192:193], v7 offset:640
    v_mfma_f32_16x16x32_bf16 v[248:251], v[28:31], v[224:227], v[248:251]
    v_cvt_pk_bf16_f32 v124, v244, v245
    v_exp_f32 v208, v208
    v_cvt_pk_bf16_f32 v217, v206, v207
    v_cvt_pk_bf16_f32 v218, v208, v209
    v_mfma_f32_16x16x32_bf16 v[204:207], v[180:183], v[120:123], v[92:95]
    v_exp_f32 v200, v200
    v_cvt_pk_bf16_f32 v125, v246, v247
    s_setprio 3
    v_exp_f32 v201, v201
    v_mfma_f32_16x16x32_bf16 v[244:247], v[12:15], v[220:223], 0
    v_exp_f32 v198, v198
    v_mfma_f32_16x16x32_bf16 v[244:247], v[16:19], v[224:227], v[244:247]
    v_mfma_f32_16x16x32_bf16 v[244:247], v[20:23], v[228:231], v[244:247]
    v_exp_f32 v206, v206
    v_mfma_f32_16x16x32_bf16 v[248:251], v[32:35], v[228:231], v[248:251]
L_t7:
    s_cbranch_execz L_back1
    ds_read_b64_tr_b16 v[188:189], v5 offset:5496
    s_waitcnt lgkmcnt(1)
    v_cvt_pk_bf16_f32 v252, v252, v253
    v_cvt_pk_bf16_f32 v253, v254, v255
    v_exp_f32 v199, v199
    s_nop 0
    v_cvt_pk_bf16_f32 v244, v244, v245
    v_cvt_pk_bf16_f32 v245, v246, v247
    v_cvt_pk_bf16_f32 v214, v200, v201
    v_cvt_pk_bf16_f32 v246, v248, v249
    v_cvt_pk_bf16_f32 v247, v250, v251
    v_exp_f32 v202, v202
    s_waitcnt lgkmcnt(0)
    ds_write_b128 v1, v[244:247] offset:33168
    v_mfma_f32_16x16x32_bf16 v[144:147], v[192:195], v[216:219], v[144:147]
    s_setprio 3
    ds_write_b64 v2, v[252:253] offset:37904
    v_mfma_f32_16x16x32_bf16 v[244:247], v[12:15], v[232:235], 0
    v_exp_f32 v196, v196
    v_mfma_f32_16x16x32_bf16 v[140:143], v[188:191], v[216:219], v[140:143]
    v_exp_f32 v207, v207
    v_mfma_f32_16x16x32_bf16 v[208:211], v[184:187], v[120:123], v[96:99]
    s_nop 0
    v_permlane32_swap_b32 v144, v146
    v_rcp_f32 v146, v146
    s_nop 0
    v_mul_f32 v144, v146, v144
    s_nop 0
    v_mul_f32 v141, v146, v141
    v_mfma_f32_16x16x32_bf16 v[252:255], v[36:39], v[232:235], 0
    v_mfma_f32_16x16x32_bf16 v[252:255], v[40:43], v[236:239], v[252:255]
    v_mul_f32 v143, v146, v143
    v_mul_f32 v142, v146, v142
    v_permlane32_swap_b32 v145, v147
    v_mfma_f32_16x16x32_bf16 v[244:247], v[16:19], v[236:239], v[244:247]
    v_cvt_pk_bf16_f32 v215, v202, 0
    v_mul_f32 v140, v146, v140
    v_mfma_f32_16x16x32_bf16 v[248:251], v[24:27], v[232:235], 0
    v_cvt_pk_bf16_f32 v213, v198, v199
    v_mul_f32 v145, v146, v145
    v_exp_f32 v197, v197
    v_cvt_pk_bf16_f32 v140, v140, v141
    v_mfma_f32_16x16x32_bf16 v[244:247], v[20:23], v[240:243], v[244:247]
    v_cvt_pk_bf16_f32 v141, v142, v143
    v_cvt_pk_bf16_f32 v142, v144, v145
    v_exp_f32 v210, v210
    v_mfma_f32_16x16x32_bf16 v[252:255], v[44:47], v[240:243], v[252:255]
    v_exp_f32 v205, v205
    v_mfma_f32_16x16x32_bf16 v[248:251], v[28:31], v[236:239], v[248:251]
    s_mul_i32 s54, s45, 1032192
    ds_write_b64 v99, v[140:141] offset:9216
    v_mfma_f32_16x16x32_bf16 v[248:251], v[32:35], v[240:243], v[248:251]
    v_exp_f32 v204, v204
    v_max3_f32 v9, v9, v146, v147
    ds_write_b32 v107, v142 offset:11264
    v_exp_f32 v208, v208
    v_cvt_pk_bf16_f32 v244, v244, v245
    v_cvt_pk_bf16_f32 v252, v252, v253
    v_cvt_pk_bf16_f32 v212, v196, v197
    v_cvt_pk_bf16_f32 v253, v254, v255
    v_cvt_pk_bf16_f32 v245, v246, v247
    v_cvt_pk_bf16_f32 v246, v248, v249
    v_mfma_f32_16x16x32_bf16 v[152:155], v[192:195], v[212:215], v[152:155]
    ds_write_b64 v2, v[252:253] offset:38032
    v_cvt_pk_bf16_f32 v247, v250, v251
    v_mfma_f32_16x16x32_bf16 v[148:151], v[188:191], v[212:215], v[148:151]
    s_setprio 2
    ds_write_b128 v1, v[244:247] offset:33424
    v_cvt_pk_bf16_f32 v217, v206, v207
    v_exp_f32 v209, v209
    v_cvt_pk_bf16_f32 v216, v204, v205
    v_cvt_pk_bf16_f32 v219, v210, 0
    v_cvt_pk_bf16_f32 v218, v208, v209
    s_nop 1
    v_mfma_f32_16x16x32_bf16 v[160:163], v[192:195], v[216:219], v[160:163]
    v_mfma_f32_16x16x32_bf16 v[156:159], v[188:191], v[216:219], v[156:159]
    s_waitcnt vmcnt(1) lgkmcnt(0)
    s_barrier
    v_mfma_f32_16x16x32_bf16 v[200:203], v[184:187], v[124:127], v[88:91]
    s_nop 7
    v_exp_f32 v201, v201
    ds_read_b128 v[172:175], v3 offset:32512
    v_mfma_f32_16x16x32_bf16 v[196:199], v[180:183], v[124:127], v[84:87]
    ds_read_b128 v[240:243], v11 offset:38528
    s_nop 6
    v_exp_f32 v196, v196
    ds_read_b128 v[220:223], v11 offset:30720
    ds_read_b128 v[224:227], v11 offset:30784
    s_waitcnt lgkmcnt(3)
    v_exp_f32 v197, v197
    s_lshl_b32 s61, s37, 2
    ds_read_b128 v[228:231], v11 offset:30848
    v_exp_f32 v199, v199
    v_exp_f32 v198, v198
    s_waitcnt lgkmcnt(1)
    v_cvt_pk_bf16_f32 v213, v198, v199
    v_mfma_f32_16x16x32_bf16 v[248:251], v[60:63], v[220:223], 0
    s_setprio 2
    ds_read_b128 v[184:187], v4 offset:33152
    v_mfma_f32_16x16x32_bf16 v[248:251], v[64:67], v[224:227], v[248:251]
    v_mfma_f32_16x16x32_bf16 v[244:247], v[48:51], v[220:223], 0
    v_mfma_f32_16x16x32_bf16 v[244:247], v[52:55], v[224:227], v[244:247]
    ds_read_b128 v[176:179], v4 offset:32512
    s_waitcnt lgkmcnt(2)
    v_mfma_f32_16x16x32_bf16 v[244:247], v[56:59], v[228:231], v[244:247]
    s_nop 7
    v_mul_f32 v246, v10, v246
    ds_read_b128 v[224:227], v11 offset:46144
    ds_read_b128 v[232:235], v11 offset:38400
    v_mul_f32 v247, v10, v247
    ds_read_b128 v[236:239], v11 offset:38464
    s_waitcnt lgkmcnt(3)
    v_mul_f32 v245, v10, v245
    v_exp_f32 v202, v202
    v_mfma_f32_16x16x32_bf16 v[248:251], v[68:71], v[228:231], v[248:251]
    v_mul_f32 v244, v10, v244
    s_waitcnt lgkmcnt(1)
    v_mfma_f32_16x16x32_bf16 v[204:207], v[172:175], v[116:119], v[108:111]
    s_sub_u32 s61, 76864, s61
    s_nop 1
    v_cndmask_b32 v109, v109, v91, s[68:69]
    v_cvt_pk_bf16_f32 v215, v202, 0
    ds_read_b128 v[180:183], v3 offset:33152
    s_lshl_b32 s63, s50, 11
    v_cvt_pk_bf16_f32 v129, v246, v247
    v_cvt_pk_bf16_f32 v128, v244, v245
    v_mul_f32 v248, v10, v248
    v_mfma_f32_16x16x32_bf16 v[244:247], v[48:51], v[232:235], 0
    s_waitcnt lgkmcnt(1)
    v_exp_f32 v200, v200
    v_mul_f32 v249, v10, v249
    v_mfma_f32_16x16x32_bf16 v[244:247], v[52:55], v[236:239], v[244:247]
    ds_read_b128 v[228:231], v11 offset:46208
    v_cvt_pk_bf16_f32 v212, v196, v197
    v_mul_f32 v251, v10, v251
    v_mfma_f32_16x16x32_bf16 v[244:247], v[56:59], v[240:243], v[244:247]
    v_cvt_pk_bf16_f32 v130, v248, v249
    v_mul_f32 v250, v10, v250
    v_cvt_pk_bf16_f32 v131, v250, v251
    v_mfma_f32_16x16x32_bf16 v[248:251], v[60:63], v[232:235], 0
    ds_read_b128 v[232:235], v0 offset:18432
    ds_read_b128 v[220:223], v11 offset:46080
    v_mfma_f32_16x16x32_bf16 v[248:251], v[64:67], v[236:239], v[248:251]
    ds_read_b128 v[236:239], v0 offset:18496
    v_mul_f32 v245, v10, v245
    v_mul_f32 v246, v10, v246
    v_mul_f32 v244, v10, v244
    v_mfma_f32_16x16x32_bf16 v[248:251], v[68:71], v[240:243], v[248:251]
    v_cvt_pk_bf16_f32 v132, v244, v245
    s_waitcnt lgkmcnt(1)
    v_mul_f32 v247, v10, v247
    v_cvt_pk_bf16_f32 v133, v246, v247
    v_mfma_f32_16x16x32_bf16 v[244:247], v[48:51], v[220:223], 0
    s_mul_i32 s57, s39, 2
    s_nop 1
    v_mul_f32 v249, v10, v249
    ds_read_b128 v[240:243], v0 offset:18560
    v_mfma_f32_16x16x32_bf16 v[196:199], v[172:175], v[120:123], v[100:103]
    v_mfma_f32_16x16x32_bf16 v[252:255], v[36:39], v[232:235], 0
    v_mul_f32 v251, v10, v251
    v_mul_f32 v250, v10, v250
    v_mfma_f32_16x16x32_bf16 v[244:247], v[52:55], v[224:227], v[244:247]
    v_mul_f32 v248, v10, v248
    s_waitcnt lgkmcnt(0)
    v_mfma_f32_16x16x32_bf16 v[244:247], v[56:59], v[228:231], v[244:247]
    v_mfma_f32_16x16x32_bf16 v[208:211], v[176:179], v[116:119], v[112:115]
    s_mul_i32 s62, s50, 96
    v_exp_f32 v197, v197
    v_exp_f32 v207, v207
    v_cvt_pk_bf16_f32 v134, v248, v249
    s_nop 2
    v_mul_f32 v245, v10, v245
    v_mfma_f32_16x16x32_bf16 v[252:255], v[40:43], v[236:239], v[252:255]
    v_cvt_pk_bf16_f32 v135, v250, v251
    v_mfma_f32_16x16x32_bf16 v[248:251], v[60:63], v[220:223], 0
    v_mul_f32 v244, v10, v244
    v_mfma_f32_16x16x32_bf16 v[248:251], v[64:67], v[224:227], v[248:251]
    ds_read_b128 v[224:227], v0 offset:24640
    v_mul_f32 v246, v10, v246
    v_mfma_f32_16x16x32_bf16 v[248:251], v[68:71], v[228:231], v[248:251]
    v_mfma_f32_16x16x32_bf16 v[252:255], v[44:47], v[240:243], v[252:255]
    v_exp_f32 v196, v196
    v_cvt_pk_bf16_f32 v136, v244, v245
    v_exp_f32 v210, v210
    s_nop 3
    v_mul_f32 v248, v10, v248
    v_mul_f32 v249, v10, v249
    v_exp_f32 v208, v208
    v_cvt_pk_bf16_f32 v138, v248, v249
    v_exp_f32 v198, v198
    v_mul_f32 v247, v10, v247
    v_exp_f32 v209, v209
    v_bfe_u32 v244, v107, 8, 2
    v_cvt_pk_bf16_f32 v137, v246, v247
    v_mad_i32_i24 v11, v244, -8, v115
    v_exp_f32 v205, v205
    v_bfe_u32 v245, v107, 4, 2
    v_mul_f32 v250, v10, v250
    s_add_u32 s63, s63, s61
    v_add_u32 v247, s63, v107
    v_mul_f32 v251, v10, v251
    v_cvt_pk_bf16_f32 v214, v200, v201
    s_nop 1
    v_mfma_f32_16x16x32_bf16 v[168:171], v[192:195], v[212:215], 0
    ds_read_b64_tr_b16 v[192:193], v7 offset:32400
    v_mfma_f32_16x16x32_bf16 v[200:203], v[176:179], v[120:123], v[104:107]
    ds_read_b64_tr_b16 v[60:61], v247 offset:8
    v_exp_f32 v204, v204
    ds_read_b64_tr_b16 v[66:67], v247 offset:9224
    v_cvt_pk_bf16_f32 v219, v210, 0
    ds_read_b64_tr_b16 v[48:49], v247
    s_lshl_b32 s60, s50, 5
    v_cvt_pk_bf16_f32 v139, v250, v251
    v_exp_f32 v206, v206
    v_mfma_f32_16x16x32_bf16 v[248:251], v[24:27], v[232:235], 0
    ds_read_b128 v[220:223], v0 offset:24576
    ds_read_b64_tr_b16 v[54:55], v247 offset:9216
    v_cvt_pk_bf16_f32 v217, v206, v207
    v_mfma_f32_16x16x32_bf16 v[164:167], v[188:191], v[212:215], 0
    ds_read_b64_tr_b16 v[190:191], v6 offset:37576
    ds_read_b128 v[228:231], v0 offset:24704
    v_cvt_pk_bf16_f32 v216, v204, v205
    v_mad_i32_i24 v246, v245, -8, v107
    s_add_u32 s60, s60, s61
    v_add_u32 v246, s60, v246
    v_exp_f32 v199, v199
    ds_read_b64_tr_b16 v[194:195], v8 offset:32400
    ds_read_b64_tr_b16 v[188:189], v5 offset:37576
    ds_read_b64_tr_b16 v[80:81], v246 offset:13312
    v_cvt_pk_bf16_f32 v213, v198, v199
    v_cvt_pk_bf16_f32 v212, v196, v197
    ds_read_b64_tr_b16 v[52:53], v247 offset:6144
    ds_read_b64_tr_b16 v[74:75], v246 offset:4096
    ds_read_b64_tr_b16 v[78:79], v246 offset:10240
    s_waitcnt lgkmcnt(4)
    v_mfma_f32_16x16x32_bf16 v[248:251], v[28:31], v[236:239], v[248:251]
    v_cvt_pk_bf16_f32 v218, v208, v209
    s_nop 1
    v_mfma_f32_16x16x32_bf16 v[148:151], v[188:191], v[216:219], v[148:151]
    ds_read_b64_tr_b16 v[72:73], v246 offset:1024
    v_cvt_pk_bf16_f32 v252, v252, v253
    v_exp_f32 v201, v201
    v_mfma_f32_16x16x32_bf16 v[248:251], v[32:35], v[240:243], v[248:251]
    ds_read_b64_tr_b16 v[56:57], v247 offset:12288
    ds_read_b64_tr_b16 v[70:71], v247 offset:15368
    v_exp_f32 v202, v202
    v_mfma_f32_16x16x32_bf16 v[152:155], v[192:195], v[216:219], v[152:155]
    v_exp_f32 v200, v200
    s_nop 0
    v_cvt_pk_bf16_f32 v214, v200, v201
    v_mfma_f32_16x16x32_bf16 v[204:207], v[172:175], v[124:127], v[92:95]
    ds_read_b64_tr_b16 v[68:69], v247 offset:12296
    v_cvt_pk_bf16_f32 v215, v202, 0
    v_add_u32 v10, s51, v107
    s_nop 0
    v_permlane32_swap_b32 v152, v154
    v_rcp_f32 v154, v154
    s_nop 1
    v_exp_f32 v204, v204
    v_cndmask_b32 v111, v111, v91, s[68:69]
    v_mul_f32 v149, v154, v149
    v_mul_f32 v148, v154, v148
    v_permlane32_swap_b32 v153, v155
    v_mul_f32 v152, v154, v152
    v_cvt_pk_bf16_f32 v148, v148, v149
    v_mfma_f32_16x16x32_bf16 v[200:203], v[176:179], v[128:131], v[88:91]
    ds_read_b64_tr_b16 v[64:65], v247 offset:6152
    v_mul_f32 v151, v154, v151
    v_mul_f32 v153, v154, v153
    v_mfma_f32_16x16x32_bf16 v[160:163], v[192:195], v[212:215], v[160:163]
    ds_read_b64_tr_b16 v[76:77], v246 offset:7168
    v_mul_f32 v150, v154, v150
    v_cvt_pk_bf16_f32 v149, v150, v151
    v_cvt_pk_bf16_f32 v150, v152, v153
    v_mfma_f32_16x16x32_bf16 v[208:211], v[176:179], v[124:127], v[96:99]
    ds_write_b64 v99, v[148:149] offset:15360
    s_setprio 0
    ds_read_b64_tr_b16 v[62:63], v247 offset:3080
    v_exp_f32 v200, v200
    ds_write_b32 v107, v150 offset:17408
    v_exp_f32 v202, v202
    ds_read_b64_tr_b16 v[58:59], v247 offset:15360
    v_mfma_f32_16x16x32_bf16 v[196:199], v[172:175], v[128:131], v[84:87]
    s_setprio 1
    v_mfma_f32_16x16x32_bf16 v[156:159], v[188:191], v[212:215], v[156:159]
    ds_read_b64_tr_b16 v[50:51], v247 offset:3072
    v_cndmask_b32 v114, v114, v91, s[70:71]
    v_max3_f32 v9, v9, v154, v155
    v_cndmask_b32 v110, v110, v91, s[68:69]
    ds_read_b64_tr_b16 v[82:83], v246 offset:16384
    v_mfma_f32_16x16x32_bf16 v[244:247], v[12:15], v[232:235], 0
    v_cvt_pk_bf16_f32 v253, v254, v255
    v_exp_f32 v196, v196
    ds_read_b128 v[232:235], v10 offset:6144
    s_setprio 2
    v_mfma_f32_16x16x32_bf16 v[244:247], v[16:19], v[236:239], v[244:247]
    v_cvt_pk_bf16_f32 v215, v202, 0
    s_waitcnt lgkmcnt(7)
    v_exp_f32 v206, v206
    v_mfma_f32_16x16x32_bf16 v[244:247], v[20:23], v[240:243], v[244:247]
    ds_write_b64 v2, v[252:253] offset:5248
    v_mfma_f32_16x16x32_bf16 v[252:255], v[36:39], v[220:223], 0
    s_waitcnt lgkmcnt(6)
    v_exp_f32 v205, v205
    s_nop 0
    v_cvt_pk_bf16_f32 v216, v204, v205
    v_cndmask_b32 v112, v112, v91, s[70:71]
    v_exp_f32 v207, v207
    v_exp_f32 v210, v210
    v_exp_f32 v201, v201
    v_mfma_f32_16x16x32_bf16 v[252:255], v[40:43], v[224:227], v[252:255]
    ds_read_b128 v[240:243], v10 offset:8192
    s_waitcnt lgkmcnt(4)
    v_mfma_f32_16x16x32_bf16 v[252:255], v[44:47], v[228:231], v[252:255]
    v_exp_f32 v197, v197
    v_cvt_pk_bf16_f32 v217, v206, v207
    v_mfma_f32_16x16x32_bf16 v[204:207], v[180:183], v[120:123], v[108:111]
    v_exp_f32 v199, v199
    v_cvt_pk_bf16_f32 v244, v244, v245
    v_cvt_pk_bf16_f32 v245, v246, v247
    v_cvt_pk_bf16_f32 v247, v250, v251
    v_cvt_pk_bf16_f32 v246, v248, v249
    v_cvt_pk_bf16_f32 v252, v252, v253
    s_nop 1
    v_exp_f32 v205, v205
    v_exp_f32 v209, v209
    v_exp_f32 v207, v207
    s_setprio 1
    v_exp_f32 v204, v204
    v_mfma_f32_16x16x32_bf16 v[248:251], v[24:27], v[220:223], 0
    ds_write_b128 v1, v[244:247] offset:256
    v_mfma_f32_16x16x32_bf16 v[244:247], v[12:15], v[220:223], 0
    v_cndmask_b32 v113, v113, v91, s[70:71]
    v_cvt_pk_bf16_f32 v253, v254, v255
    v_mfma_f32_16x16x32_bf16 v[248:251], v[28:31], v[224:227], v[248:251]
    ds_read_b128 v[236:239], v10 offset:7168
    v_mfma_f32_16x16x32_bf16 v[244:247], v[16:19], v[224:227], v[244:247]
    v_exp_f32 v208, v208
    v_mfma_f32_16x16x32_bf16 v[244:247], v[20:23], v[228:231], v[244:247]
    s_waitcnt lgkmcnt(5)
    ds_write_b64 v2, v[252:253] offset:5504
    v_mfma_f32_16x16x32_bf16 v[248:251], v[32:35], v[228:231], v[248:251]
    v_exp_f32 v198, v198
    v_cvt_pk_bf16_f32 v219, v210, 0
    v_cvt_pk_bf16_f32 v214, v200, v201
    v_mfma_f32_16x16x32_bf16 v[200:203], v[184:187], v[124:127], v[104:107]
    s_nop 0
    v_cvt_pk_bf16_f32 v244, v244, v245
    v_cvt_pk_bf16_f32 v218, v208, v209
    v_mfma_f32_16x16x32_bf16 v[208:211], v[184:187], v[120:123], v[112:115]
    v_cvt_pk_bf16_f32 v245, v246, v247
    v_mfma_f32_16x16x32_bf16 v[168:171], v[192:195], v[216:219], v[168:171]
    v_cvt_pk_bf16_f32 v213, v198, v199
    v_cvt_pk_bf16_f32 v212, v196, v197
    v_mfma_f32_16x16x32_bf16 v[164:167], v[188:191], v[216:219], v[164:167]
    s_nop 0
    v_mfma_f32_16x16x32_bf16 v[140:143], v[188:191], v[212:215], 0
    v_exp_f32 v206, v206
    s_setprio 2
    ds_read_b64_tr_b16 v[188:189], v5 offset:37896
    v_exp_f32 v208, v208
    s_waitcnt lgkmcnt(6)
    v_exp_f32 v210, v210
    s_setprio 1
    v_cvt_pk_bf16_f32 v247, v250, v251
    v_cvt_pk_bf16_f32 v219, v210, 0
    ds_read_b64_tr_b16 v[190:191], v6 offset:37896
    v_cvt_pk_bf16_f32 v216, v204, v205
    v_mfma_f32_16x16x32_bf16 v[196:199], v[180:183], v[124:127], v[100:103]
    v_cvt_pk_bf16_f32 v246, v248, v249
    v_mfma_f32_16x16x32_bf16 v[144:147], v[192:195], v[212:215], 0
    ds_read_b64_tr_b16 v[192:193], v7 offset:33040
    v_mfma_f32_16x16x32_bf16 v[252:255], v[72:75], v[232:235], 0
    s_waitcnt lgkmcnt(2)
    ds_read_b64_tr_b16 v[194:195], v8 offset:33040
    v_cvt_pk_bf16_f32 v217, v206, v207
    ds_write_b128 v1, v[244:247] offset:768
    v_mfma_f32_16x16x32_bf16 v[244:247], v[48:51], v[232:235], 0
    s_waitcnt lgkmcnt(3)
    v_exp_f32 v209, v209
    s_waitcnt lgkmcnt(1)
    v_mfma_f32_16x16x32_bf16 v[204:207], v[180:183], v[128:131], v[92:95]
    s_add_u32 s56, s56, s54
    v_exp_f32 v201, v201
    v_mfma_f32_16x16x32_bf16 v[248:251], v[60:63], v[232:235], 0
    v_exp_f32 v197, v197
    v_mfma_f32_16x16x32_bf16 v[248:251], v[64:67], v[236:239], v[248:251]
    v_exp_f32 v196, v196
    v_cvt_pk_bf16_f32 v218, v208, v209
    s_nop 1
    v_mfma_f32_16x16x32_bf16 v[160:163], v[192:195], v[216:219], v[160:163]
    v_subrev_u32 v11, s62, v11
    v_exp_f32 v200, v200
    v_mfma_f32_16x16x32_bf16 v[244:247], v[52:55], v[236:239], v[244:247]
    ds_read_b128 v[232:235], v0 offset:33792
    v_mfma_f32_16x16x32_bf16 v[156:159], v[188:191], v[216:219], v[156:159]
    v_exp_f32 v204, v204
    v_mfma_f32_16x16x32_bf16 v[252:255], v[76:79], v[236:239], v[252:255]
    s_nop 0
    v_permlane32_swap_b32 v160, v162
    v_mfma_f32_16x16x32_bf16 v[252:255], v[80:83], v[240:243], v[252:255]
    v_rcp_f32 v162, v162
    v_exp_f32 v198, v198
    v_mul_f32 v160, v162, v160
    v_mfma_f32_16x16x32_bf16 v[208:211], v[184:187], v[128:131], v[96:99]
    v_mul_f32 v157, v162, v157
    v_exp_f32 v205, v205
    ds_read_b128 v[236:239], v0 offset:33856
    v_mul_f32 v156, v162, v156
    v_cvt_pk_bf16_f32 v156, v156, v157
    v_cvt_pk_bf16_f32 v252, v252, v253
    v_mul_f32 v159, v162, v159
    v_mul_f32 v158, v162, v158
    v_exp_f32 v210, v210
    v_mfma_f32_16x16x32_bf16 v[244:247], v[56:59], v[240:243], v[244:247]
    v_exp_f32 v202, v202
    v_permlane32_swap_b32 v161, v163
    v_exp_f32 v207, v207
    s_waitcnt lgkmcnt(0)
    v_cvt_pk_bf16_f32 v219, v210, 0
    v_mul_f32 v161, v162, v161
    v_cvt_pk_bf16_f32 v157, v158, v159
    v_exp_f32 v208, v208
    v_cvt_pk_bf16_f32 v158, v160, v161
    v_mfma_f32_16x16x32_bf16 v[248:251], v[68:71], v[240:243], v[248:251]
    ds_write_b64 v99, v[156:157] offset:21504
    s_setprio 0
    v_cvt_pk_bf16_f32 v215, v202, 0
    v_cvt_pk_bf16_f32 v244, v244, v245
    v_exp_f32 v199, v199
    v_cvt_pk_bf16_f32 v212, v196, v197
    v_cvt_pk_bf16_f32 v245, v246, v247
    v_cvt_pk_bf16_f32 v216, v204, v205
    v_cvt_pk_bf16_f32 v247, v250, v251
    v_cvt_pk_bf16_f32 v253, v254, v255
    v_cvt_pk_bf16_f32 v246, v248, v249
    v_cvt_pk_bf16_f32 v213, v198, v199
    v_mfma_f32_16x16x32_bf16 v[196:199], v[180:183], v[132:135], v[84:87]
    buffer_store_dwordx4 v[244:247], v115, s[28:31], s56 offen sc0 sc1
    ds_write_b32 v107, v158 offset:23552
    buffer_store_dwordx2 v[252:253], v11, s[28:31], s56 offen offset:64 sc0 sc1
    v_cvt_pk_bf16_f32 v214, v200, v201
    v_exp_f32 v206, v206
    v_exp_f32 v209, v209
    v_mfma_f32_16x16x32_bf16 v[168:171], v[192:195], v[212:215], v[168:171]
    v_cvt_pk_bf16_f32 v218, v208, v209
    v_cvt_pk_bf16_f32 v217, v206, v207
    v_mfma_f32_16x16x32_bf16 v[164:167], v[188:191], v[212:215], v[164:167]
    v_exp_f32 v198, v198
    v_mfma_f32_16x16x32_bf16 v[140:143], v[188:191], v[216:219], v[140:143]
    s_waitcnt vmcnt(2) lgkmcnt(0)
    s_barrier
    v_exp_f32 v196, v196
    ds_read_b128 v[224:227], v10 offset:19456
    v_mfma_f32_16x16x32_bf16 v[144:147], v[192:195], v[216:219], v[144:147]
    v_exp_f32 v197, v197
    ds_read_b128 v[220:223], v10 offset:18432
    v_mfma_f32_16x16x32_bf16 v[200:203], v[184:187], v[132:135], v[88:91]
    ds_read_b128 v[172:175], v3 offset:112
    v_max3_f32 v9, v9, v162, v163
    v_exp_f32 v199, v199
    ds_read_b128 v[228:231], v10 offset:20480
    s_waitcnt lgkmcnt(2)
    v_mfma_f32_16x16x32_bf16 v[248:251], v[60:63], v[220:223], 0
    v_cvt_pk_bf16_f32 v213, v198, v199
    v_mfma_f32_16x16x32_bf16 v[252:255], v[72:75], v[220:223], 0
    ds_read_b128 v[240:243], v0 offset:33920
    s_setprio 2
    s_waitcnt lgkmcnt(2)
    v_mfma_f32_16x16x32_bf16 v[204:207], v[172:175], v[124:127], v[108:111]
    v_mfma_f32_16x16x32_bf16 v[252:255], v[76:79], v[224:227], v[252:255]
    s_waitcnt lgkmcnt(1)
    ds_read_b128 v[184:187], v4 offset:752
    v_mfma_f32_16x16x32_bf16 v[244:247], v[48:51], v[220:223], 0
    ds_read_b128 v[176:179], v4 offset:112
    ds_read_b128 v[220:223], v0 offset:39936
    v_mfma_f32_16x16x32_bf16 v[244:247], v[52:55], v[224:227], v[244:247]
    v_exp_f32 v201, v201
    v_exp_f32 v200, v200
    s_waitcnt lgkmcnt(1)
    v_exp_f32 v207, v207
    v_cvt_pk_bf16_f32 v214, v200, v201
    v_exp_f32 v202, v202
    v_mfma_f32_16x16x32_bf16 v[244:247], v[56:59], v[228:231], v[244:247]
    v_cvt_pk_bf16_f32 v215, v202, 0
    v_exp_f32 v206, v206
    v_mfma_f32_16x16x32_bf16 v[252:255], v[80:83], v[228:231], v[252:255]
    s_add_u32 s57, s57, s54
    ds_read_b128 v[180:183], v3 offset:752
    v_exp_f32 v204, v204
    v_mfma_f32_16x16x32_bf16 v[248:251], v[64:67], v[224:227], v[248:251]
    v_mfma_f32_16x16x32_bf16 v[248:251], v[68:71], v[228:231], v[248:251]
    s_mul_i32 s58, s39, 4
    v_mfma_f32_16x16x32_bf16 v[208:211], v[176:179], v[124:127], v[112:115]
    s_setprio 2
    ds_read_b128 v[228:231], v0 offset:40064
    v_exp_f32 v205, v205
    v_cvt_pk_bf16_f32 v212, v196, v197
    v_cvt_pk_bf16_f32 v244, v244, v245
    v_cvt_pk_bf16_f32 v245, v246, v247
    v_cvt_pk_bf16_f32 v246, v248, v249
    v_cvt_pk_bf16_f32 v247, v250, v251
    buffer_store_dwordx4 v[244:247], v115, s[28:31], s57 offen sc0 sc1
    v_mfma_f32_16x16x32_bf16 v[152:155], v[192:195], v[212:215], 0
    v_mfma_f32_16x16x32_bf16 v[148:151], v[188:191], v[212:215], 0
    v_mfma_f32_16x16x32_bf16 v[200:203], v[176:179], v[128:131], v[104:107]
    ds_read_b64_tr_b16 v[194:195], v8
    v_mfma_f32_16x16x32_bf16 v[196:199], v[172:175], v[128:131], v[100:103]
    v_exp_f32 v208, v208
    ds_read_b64_tr_b16 v[190:191], v6 offset:5176
    v_exp_f32 v210, v210
    v_exp_f32 v209, v209
    v_cvt_pk_bf16_f32 v219, v210, 0
    v_cvt_pk_bf16_f32 v218, v208, v209
    v_mfma_f32_16x16x32_bf16 v[208:211], v[176:179], v[132:135], v[96:99]
    s_waitcnt lgkmcnt(0)
    v_cvt_pk_bf16_f32 v217, v206, v207
    v_exp_f32 v199, v199
    v_mfma_f32_16x16x32_bf16 v[244:247], v[12:15], v[232:235], 0
    v_exp_f32 v202, v202
    v_exp_f32 v196, v196
    v_mfma_f32_16x16x32_bf16 v[244:247], v[16:19], v[236:239], v[244:247]
    v_exp_f32 v197, v197
    v_exp_f32 v201, v201
    v_exp_f32 v210, v210
    v_cvt_pk_bf16_f32 v252, v252, v253
    v_mfma_f32_16x16x32_bf16 v[248:251], v[24:27], v[232:235], 0
    v_exp_f32 v200, v200
    v_cvt_pk_bf16_f32 v215, v202, 0
    ds_read_b64_tr_b16 v[188:189], v5 offset:5176
    v_cvt_pk_bf16_f32 v216, v204, v205
    v_cvt_pk_bf16_f32 v253, v254, v255
    v_exp_f32 v198, v198
    buffer_store_dwordx2 v[252:253], v11, s[28:31], s57 offen offset:64 sc0 sc1
    v_cvt_pk_bf16_f32 v213, v198, v199
    v_cvt_pk_bf16_f32 v212, v196, v197
    v_mfma_f32_16x16x32_bf16 v[196:199], v[172:175], v[136:139], v[84:87]
    v_mfma_f32_16x16x32_bf16 v[252:255], v[36:39], v[232:235], 0
    ds_read_b64_tr_b16 v[192:193], v7
    v_cvt_pk_bf16_f32 v214, v200, v201
    v_mfma_f32_16x16x32_bf16 v[244:247], v[20:23], v[240:243], v[244:247]
    ds_read_b128 v[224:227], v0 offset:40000
    v_mfma_f32_16x16x32_bf16 v[204:207], v[172:175], v[132:135], v[92:95]
    v_exp_f32 v208, v208
    v_mfma_f32_16x16x32_bf16 v[248:251], v[28:31], v[236:239], v[248:251]
    v_mfma_f32_16x16x32_bf16 v[248:251], v[32:35], v[240:243], v[248:251]
    ds_read_b128 v[232:235], v0 offset:43008
    v_mfma_f32_16x16x32_bf16 v[252:255], v[40:43], v[236:239], v[252:255]
    s_waitcnt lgkmcnt(2)
    v_mfma_f32_16x16x32_bf16 v[252:255], v[44:47], v[240:243], v[252:255]
    v_exp_f32 v209, v209
    v_mfma_f32_16x16x32_bf16 v[200:203], v[176:179], v[136:139], v[88:91]
    v_mfma_f32_16x16x32_bf16 v[168:171], v[192:195], v[216:219], v[168:171]
    v_cvt_pk_bf16_f32 v244, v244, v245
    v_mfma_f32_16x16x32_bf16 v[140:143], v[188:191], v[212:215], v[140:143]
    ds_read_b128 v[240:243], v0 offset:43136
    v_cvt_pk_bf16_f32 v245, v246, v247
    v_cvt_pk_bf16_f32 v247, v250, v251
    v_mfma_f32_16x16x32_bf16 v[164:167], v[188:191], v[216:219], v[164:167]
    v_cvt_pk_bf16_f32 v246, v248, v249
    s_waitcnt lgkmcnt(2)
    ds_write_b128 v1, v[244:247] offset:32656
    v_mfma_f32_16x16x32_bf16 v[244:247], v[12:15], v[220:223], 0
    v_exp_f32 v205, v205
    v_exp_f32 v206, v206
    v_cvt_pk_bf16_f32 v252, v252, v253
    v_cvt_pk_bf16_f32 v219, v210, 0
    v_exp_f32 v198, v198
    v_permlane32_swap_b32 v168, v170
    v_mfma_f32_16x16x32_bf16 v[244:247], v[16:19], v[224:227], v[244:247]
    v_rcp_f32 v170, v170
    v_mfma_f32_16x16x32_bf16 v[248:251], v[24:27], v[220:223], 0
    s_waitcnt lgkmcnt(1)
    v_exp_f32 v199, v199
    v_mfma_f32_16x16x32_bf16 v[244:247], v[20:23], v[228:231], v[244:247]
    v_exp_f32 v204, v204
    v_cvt_pk_bf16_f32 v253, v254, v255
    v_exp_f32 v207, v207
    s_nop 0
    v_cvt_pk_bf16_f32 v217, v206, v207
    v_cvt_pk_bf16_f32 v216, v204, v205
    ds_write_b64 v2, v[252:253] offset:37648
    v_mfma_f32_16x16x32_bf16 v[248:251], v[28:31], v[224:227], v[248:251]
    v_mul_f32 v165, v170, v165
    v_cvt_pk_bf16_f32 v218, v208, v209
    s_mul_i32 s59, s39, 5
    v_exp_f32 v201, v201
    v_mfma_f32_16x16x32_bf16 v[204:207], v[180:183], v[128:131], v[108:111]
    ds_read_b128 v[236:239], v0 offset:43072
    v_mul_f32 v167, v170, v167
    v_mul_f32 v166, v170, v166
    v_exp_f32 v197, v197
    v_mul_f32 v164, v170, v164
    v_cvt_pk_bf16_f32 v164, v164, v165
    v_mfma_f32_16x16x32_bf16 v[144:147], v[192:195], v[212:215], v[144:147]
    v_cvt_pk_bf16_f32 v244, v244, v245
    s_setprio 0
    v_cvt_pk_bf16_f32 v245, v246, v247
    v_permlane32_swap_b32 v169, v171
    v_mfma_f32_16x16x32_bf16 v[252:255], v[36:39], v[220:223], 0
    v_exp_f32 v202, v202
    v_mfma_f32_16x16x32_bf16 v[248:251], v[32:35], v[228:231], v[248:251]
    v_mfma_f32_16x16x32_bf16 v[208:211], v[184:187], v[128:131], v[112:115]
    v_mul_f32 v168, v170, v168
    v_exp_f32 v200, v200
    v_mul_f32 v169, v170, v169
    v_mfma_f32_16x16x32_bf16 v[252:255], v[40:43], v[224:227], v[252:255]
    v_cvt_pk_bf16_f32 v165, v166, v167
    v_cvt_pk_bf16_f32 v166, v168, v169
    v_mfma_f32_16x16x32_bf16 v[252:255], v[44:47], v[228:231], v[252:255]
    ds_write_b32 v107, v166 offset:29696
    v_cvt_pk_bf16_f32 v246, v248, v249
    v_cvt_pk_bf16_f32 v215, v202, 0
    s_setprio 1
    v_cvt_pk_bf16_f32 v214, v200, v201
    v_cvt_pk_bf16_f32 v247, v250, v251
    v_cvt_pk_bf16_f32 v213, v198, v199
    v_exp_f32 v196, v196
    v_mfma_f32_16x16x32_bf16 v[152:155], v[192:195], v[216:219], v[152:155]
    v_cvt_pk_bf16_f32 v212, v196, v197
    v_cvt_pk_bf16_f32 v252, v252, v253
    v_exp_f32 v209, v209
    v_mfma_f32_16x16x32_bf16 v[156:159], v[188:191], v[212:215], 0
    v_exp_f32 v210, v210
    v_exp_f32 v207, v207
    v_mfma_f32_16x16x32_bf16 v[248:251], v[24:27], v[232:235], 0
    v_exp_f32 v206, v206
    v_cvt_pk_bf16_f32 v253, v254, v255
    v_mfma_f32_16x16x32_bf16 v[148:151], v[188:191], v[216:219], v[148:151]
    s_waitcnt lgkmcnt(1)
    ds_write_b64 v2, v[252:253] offset:37904
    v_cvt_pk_bf16_f32 v217, v206, v207
    v_mfma_f32_16x16x32_bf16 v[160:163], v[192:195], v[212:215], 0
    v_exp_f32 v208, v208
    v_mfma_f32_16x16x32_bf16 v[252:255], v[36:39], v[232:235], 0
    ds_read_b64_tr_b16 v[192:193], v7 offset:640
    s_setprio 0
    ds_write_b128 v1, v[244:247] offset:33168
L_t1:
    s_cbranch_execz L_back0
    v_mfma_f32_16x16x32_bf16 v[244:247], v[12:15], v[232:235], 0
    ds_read_b64_tr_b16 v[190:191], v6 offset:5496
    v_mfma_f32_16x16x32_bf16 v[244:247], v[16:19], v[236:239], v[244:247]
    v_mfma_f32_16x16x32_bf16 v[244:247], v[20:23], v[240:243], v[244:247]
    ds_read_b64_tr_b16 v[194:195], v8 offset:640
    v_mfma_f32_16x16x32_bf16 v[252:255], v[40:43], v[236:239], v[252:255]
    ds_read_b64_tr_b16 v[188:189], v5 offset:5496
    v_mfma_f32_16x16x32_bf16 v[252:255], v[44:47], v[240:243], v[252:255]
    ds_write_b64 v99, v[164:165] offset:27648
    v_mfma_f32_16x16x32_bf16 v[200:203], v[184:187], v[132:135], v[104:107]
    s_waitcnt lgkmcnt(5)
    v_exp_f32 v205, v205
    v_mfma_f32_16x16x32_bf16 v[248:251], v[28:31], v[236:239], v[248:251]
    v_exp_f32 v204, v204
    v_cvt_pk_bf16_f32 v218, v208, v209
    v_mfma_f32_16x16x32_bf16 v[248:251], v[32:35], v[240:243], v[248:251]
    s_waitcnt lgkmcnt(1)
    v_cvt_pk_bf16_f32 v216, v204, v205
    v_cvt_pk_bf16_f32 v219, v210, 0
    v_cvt_pk_bf16_f32 v252, v252, v253
    v_cvt_pk_bf16_f32 v253, v254, v255
    v_mfma_f32_16x16x32_bf16 v[144:147], v[192:195], v[216:219], v[144:147]
    s_setprio 2
    v_cvt_pk_bf16_f32 v244, v244, v245
    v_cvt_pk_bf16_f32 v245, v246, v247
    v_mfma_f32_16x16x32_bf16 v[140:143], v[188:191], v[216:219], v[140:143]
    s_setprio 3
    v_cvt_pk_bf16_f32 v247, v250, v251
    v_cvt_pk_bf16_f32 v246, v248, v249
    v_mfma_f32_16x16x32_bf16 v[208:211], v[184:187], v[136:139], v[96:99]
    v_permlane32_swap_b32 v144, v146
    ds_write_b128 v1, v[244:247] offset:33424
    ds_write_b64 v2, v[252:253] offset:38032
    v_rcp_f32 v146, v146
    v_permlane32_swap_b32 v145, v147
    v_mul_f32 v140, v146, v140
    v_mul_f32 v141, v146, v141
    v_cvt_pk_bf16_f32 v140, v140, v141
    v_mul_f32 v142, v146, v142
    v_mul_f32 v145, v146, v145
    v_mul_f32 v143, v146, v143
    v_cvt_pk_bf16_f32 v141, v142, v143
    v_mfma_f32_16x16x32_bf16 v[196:199], v[180:183], v[132:135], v[100:103]
    ds_write_b64 v99, v[140:141] offset:33792
    v_exp_f32 v210, v210
    v_exp_f32 v202, v202
    v_exp_f32 v200, v200
    v_mul_f32 v144, v146, v144
    v_cvt_pk_bf16_f32 v142, v144, v145
    v_mfma_f32_16x16x32_bf16 v[204:207], v[180:183], v[136:139], v[92:95]
    s_setprio 0
    ds_write_b32 v107, v142 offset:35840
    v_exp_f32 v199, v199
    v_cvt_pk_bf16_f32 v215, v202, 0
    v_exp_f32 v196, v196
    v_exp_f32 v201, v201
    v_exp_f32 v198, v198
    v_exp_f32 v197, v197
    v_cvt_pk_bf16_f32 v214, v200, v201
    v_cvt_pk_bf16_f32 v212, v196, v197
    v_cvt_pk_bf16_f32 v213, v198, v199
    v_max3_f32 v9, v9, v170, v171
    s_nop 0
    v_mfma_f32_16x16x32_bf16 v[148:151], v[188:191], v[212:215], v[148:151]
    s_waitcnt lgkmcnt(0)
    s_barrier
    v_exp_f32 v209, v209
    ds_read_b128 v[172:175], v3 offset:32512
    v_exp_f32 v206, v206
    v_exp_f32 v207, v207
    v_mfma_f32_16x16x32_bf16 v[152:155], v[192:195], v[212:215], v[152:155]
    ds_read_b128 v[176:179], v4 offset:32512
    v_exp_f32 v208, v208
    s_setprio 3
    v_exp_f32 v205, v205
    v_cvt_pk_bf16_f32 v218, v208, v209
    s_waitcnt lgkmcnt(1)
    v_mfma_f32_16x16x32_bf16 v[196:199], v[172:175], v[132:135], v[108:111]
    s_mul_i32 s60, s39, 6
    v_cvt_pk_bf16_f32 v219, v210, 0
    v_cvt_pk_bf16_f32 v217, v206, v207
    ds_read_b128 v[228:231], v10 offset:32768
    v_exp_f32 v204, v204
    s_nop 0
    v_cvt_pk_bf16_f32 v216, v204, v205
    s_waitcnt lgkmcnt(1)
    v_exp_f32 v196, v196
    v_exp_f32 v197, v197
    v_mfma_f32_16x16x32_bf16 v[204:207], v[172:175], v[136:139], v[100:103]
    ds_read_b128 v[224:227], v10 offset:31744
    v_mfma_f32_16x16x32_bf16 v[156:159], v[188:191], v[216:219], v[156:159]
    ds_read_b64_tr_b16 v[188:189], v5 offset:37576
    v_exp_f32 v199, v199
    ds_read_b128 v[220:223], v10 offset:30720
    v_cvt_pk_bf16_f32 v212, v196, v197
    v_exp_f32 v198, v198
    v_mfma_f32_16x16x32_bf16 v[160:163], v[192:195], v[216:219], v[160:163]
    v_exp_f32 v207, v207
    v_mfma_f32_16x16x32_bf16 v[208:211], v[176:179], v[136:139], v[104:107]
    s_add_u32 s58, s58, s54
    s_setprio 0
    ds_read_b64_tr_b16 v[194:195], v8 offset:32400
    v_mfma_f32_16x16x32_bf16 v[200:203], v[176:179], v[132:135], v[112:115]
    s_waitcnt lgkmcnt(1)
    v_mfma_f32_16x16x32_bf16 v[244:247], v[48:51], v[220:223], 0
    ds_read_b64_tr_b16 v[192:193], v7 offset:32400
    v_mfma_f32_16x16x32_bf16 v[248:251], v[60:63], v[220:223], 0
    ds_read_b128 v[184:187], v4 offset:33152
    v_mfma_f32_16x16x32_bf16 v[244:247], v[52:55], v[224:227], v[244:247]
    v_mfma_f32_16x16x32_bf16 v[244:247], v[56:59], v[228:231], v[244:247]
    ds_read_b64_tr_b16 v[190:191], v6 offset:37576
    s_setprio 3
    v_exp_f32 v202, v202
    v_mfma_f32_16x16x32_bf16 v[248:251], v[64:67], v[224:227], v[248:251]
    v_exp_f32 v201, v201
    v_exp_f32 v200, v200
    v_exp_f32 v209, v209
    v_mfma_f32_16x16x32_bf16 v[248:251], v[68:71], v[228:231], v[248:251]
    ds_read_b128 v[180:183], v3 offset:33152
    v_cvt_pk_bf16_f32 v244, v244, v245
    s_waitcnt lgkmcnt(1)
    v_cvt_pk_bf16_f32 v214, v200, v201
    v_cvt_pk_bf16_f32 v215, v202, 0
    v_exp_f32 v206, v206
    v_exp_f32 v205, v205
    v_cvt_pk_bf16_f32 v217, v206, v207
    v_cvt_pk_bf16_f32 v213, v198, v199
    v_exp_f32 v210, v210
    v_cvt_pk_bf16_f32 v245, v246, v247
    v_mfma_f32_16x16x32_bf16 v[152:155], v[192:195], v[212:215], v[152:155]
    s_nop 7
    v_permlane32_swap_b32 v153, v155
    v_mfma_f32_16x16x32_bf16 v[148:151], v[188:191], v[212:215], v[148:151]
    v_cvt_pk_bf16_f32 v219, v210, 0
    v_cvt_pk_bf16_f32 v247, v250, v251
    v_exp_f32 v208, v208
    v_permlane32_swap_b32 v152, v154
    v_cvt_pk_bf16_f32 v218, v208, v209
    v_rcp_f32 v154, v154
    s_nop 0
    v_mul_f32 v152, v154, v152
    v_mul_f32 v150, v154, v150
    v_mul_f32 v148, v154, v148
    v_mul_f32 v149, v154, v149
    v_mul_f32 v151, v154, v151
    v_cvt_pk_bf16_f32 v246, v248, v249
    v_cvt_pk_bf16_f32 v148, v148, v149
    v_cvt_pk_bf16_f32 v149, v150, v151
    v_mul_f32 v153, v154, v153
    buffer_store_dwordx4 v[244:247], v115, s[28:31], s58 offen
    ds_write_b64 v99, v[148:149] offset:39936
    v_mfma_f32_16x16x32_bf16 v[252:255], v[72:75], v[220:223], 0
    v_mfma_f32_16x16x32_bf16 v[252:255], v[76:79], v[224:227], v[252:255]
    v_exp_f32 v204, v204
    v_mfma_f32_16x16x32_bf16 v[252:255], v[80:83], v[228:231], v[252:255]
    v_cvt_pk_bf16_f32 v150, v152, v153
    s_waitcnt lgkmcnt(1)
    v_mfma_f32_16x16x32_bf16 v[200:203], v[184:187], v[136:139], v[112:115]
    ds_write_b32 v107, v150 offset:41984
    v_mfma_f32_16x16x32_bf16 v[196:199], v[180:183], v[136:139], v[108:111]
    v_cvt_pk_bf16_f32 v216, v204, v205
    s_nop 1
    v_mfma_f32_16x16x32_bf16 v[160:163], v[192:195], v[216:219], v[160:163]
    s_setprio 2
    ds_read_b64_tr_b16 v[194:195], v8 offset:33040
    v_mfma_f32_16x16x32_bf16 v[156:159], v[188:191], v[216:219], v[156:159]
    ds_read_b64_tr_b16 v[190:191], v6 offset:37896
    ds_read_b64_tr_b16 v[188:189], v5 offset:37896
    ds_read_b64_tr_b16 v[192:193], v7 offset:33040
    v_cvt_pk_bf16_f32 v252, v252, v253
    v_cvt_pk_bf16_f32 v253, v254, v255
    s_waitcnt lgkmcnt(4)
    s_barrier
    ds_read_b128 v[236:239], v10 offset:37888
    ds_read_b128 v[232:235], v10 offset:36864
    s_waitcnt lgkmcnt(2)
    buffer_store_dwordx2 v[252:253], v11, s[28:31], s58 offen offset:64
    ds_read_b128 v[240:243], v10 offset:38912
    v_exp_f32 v202, v202
    v_exp_f32 v197, v197
    v_cvt_pk_bf16_f32 v215, v202, 0
    v_exp_f32 v201, v201
    s_waitcnt lgkmcnt(1)
    v_mfma_f32_16x16x32_bf16 v[248:251], v[60:63], v[232:235], 0
    v_exp_f32 v199, v199
    v_mfma_f32_16x16x32_bf16 v[248:251], v[64:67], v[236:239], v[248:251]
    s_setprio 3
    v_exp_f32 v198, v198
    v_mfma_f32_16x16x32_bf16 v[244:247], v[48:51], v[232:235], 0
    v_exp_f32 v200, v200
    v_mfma_f32_16x16x32_bf16 v[244:247], v[52:55], v[236:239], v[244:247]
    s_waitcnt lgkmcnt(0)
    v_exp_f32 v196, v196
    v_mfma_f32_16x16x32_bf16 v[244:247], v[56:59], v[240:243], v[244:247]
    v_cvt_pk_bf16_f32 v213, v198, v199
    v_mfma_f32_16x16x32_bf16 v[248:251], v[68:71], v[240:243], v[248:251]
    s_add_u32 s59, s59, s54
    v_cvt_pk_bf16_f32 v212, v196, v197
    v_cvt_pk_bf16_f32 v214, v200, v201
    s_nop 2
    v_cvt_pk_bf16_f32 v244, v244, v245
    v_cvt_pk_bf16_f32 v245, v246, v247
    v_cvt_pk_bf16_f32 v246, v248, v249
    v_mfma_f32_16x16x32_bf16 v[160:163], v[192:195], v[212:215], v[160:163]
    v_cvt_pk_bf16_f32 v247, v250, v251
    s_setprio 0
    v_mfma_f32_16x16x32_bf16 v[156:159], v[188:191], v[212:215], v[156:159]
    s_setprio 0
    s_setprio 0
    buffer_store_dwordx4 v[244:247], v115, s[28:31], s59 offen
    s_setprio 1
    s_setprio 0
    v_permlane32_swap_b32 v160, v162
    v_rcp_f32 v162, v162
    v_permlane32_swap_b32 v161, v163
    v_mul_f32 v156, v162, v156
    v_mul_f32 v157, v162, v157
    v_mul_f32 v158, v162, v158
    v_mul_f32 v159, v162, v159
    v_cvt_pk_bf16_f32 v156, v156, v157
    v_cvt_pk_bf16_f32 v157, v158, v159
    ds_write_b64 v99, v[156:157] offset:46080
    v_mul_f32 v161, v162, v161
    v_mul_f32 v160, v162, v160
    v_cvt_pk_bf16_f32 v158, v160, v161
    v_mov_b32 v13, 1
    v_max3_f32 v9, v9, v146, v147
    v_max3_f32 v9, v9, v154, v155
    v_max3_f32 v9, v9, v162, v163
    ds_write_b32 v107, v158 offset:48128
    v_cmp_nge_f32 vcc, 0x5f800000, v9
    v_mov_b32 v15, 160100
    v_lshrrev_b32 v12, 29, v115
    v_add_u32 v12, 160096, v12
    v_cndmask_b32 v15, v15, v12, vcc
    ds_write_b32 v15, v13
    s_add_u32 s60, s60, s54
    s_waitcnt lgkmcnt(0)
    s_barrier
    s_setprio 0
    ds_read_b128 v[228:231], v10 offset:45056
    ds_read_b128 v[224:227], v10 offset:44032
    ds_read_b32 v14, v12
    ds_read_b128 v[220:223], v10 offset:43008
    s_waitcnt lgkmcnt(0)
    v_mfma_f32_16x16x32_bf16 v[252:255], v[72:75], v[220:223], 0
    v_mfma_f32_16x16x32_bf16 v[252:255], v[76:79], v[224:227], v[252:255]
    s_setprio 3
    v_mfma_f32_16x16x32_bf16 v[252:255], v[80:83], v[228:231], v[252:255]
    s_nop 7
    v_cvt_pk_bf16_f32 v252, v252, v253
    v_cvt_pk_bf16_f32 v253, v254, v255
    buffer_store_dwordx2 v[252:253], v11, s[28:31], s60 offen offset:64
    v_readfirstlane_b32 s63, v14
    s_nop 0
    s_cmp_eq_u32 s63, 0
    s_cbranch_scc0 L_safe
    s_endpgm
L_safe:
    s_waitcnt vmcnt(0) lgkmcnt(0)
    s_barrier
    v_mbcnt_lo_u32_b32 v152, -1, 0
    v_mbcnt_hi_u32_b32 v152, -1, v152
    s_mov_b32 s39, s47
    v_mul_u32_u24 v244, 43, v152
    s_mul_i32 s56, s37, 5
    s_lshr_b32 s57, s36, 2
    v_lshrrev_b32 v244, 9, v244
    v_mad_i32_i24 v245, v244, -12, v152
    v_add_u32 v244, s56, v244
    v_xor_b32 v246, s36, v244
    v_add_u32 v244, s41, v244
    v_lshrrev_b32 v246, 1, v246
    v_med3_i32 v244, v244, 0, s44
    v_and_b32 v246, 2, v246
    v_mul_u32_u24 v244, s43, v244
    v_xor_b32 v245, v245, v246
    v_lshl_add_u32 v136, v245, 4, v244
    s_mul_i32 s42, s36, 960
    s_add_u32 s57, s57, s40
    s_and_b32 s58, s57, 7
    s_max_i32 s58, s58, s57
    s_mul_i32 s58, s58, s38
    s_add_u32 s58, s58, s39
    s_add_u32 s57, s57, 2
    s_and_b32 s59, s57, 7
    s_max_i32 s59, s59, s57
    s_mul_i32 s59, s59, s38
    s_add_u32 s59, s59, s39
    v_and_b32 v153, 15, v152
    v_lshrrev_b32 v154, 4, v152
    s_mul_i32 s60, s37, 338
    s_cmp_eq_u32 s45, 1
    s_cselect_b32 s61, -26, 26
    s_cselect_b32 s62, 312, 0
    s_add_u32 s60, s60, s62
    s_movk_i32 s26, 1352
    s_mov_b32 s27, s19
    v_lshl_add_u32 v244, v153, 1, s60
    v_mad_i32_i24 v208, v154, s61, v244
    s_lshl_b32 s61, s61, 2
    v_add_u32 v209, s61, v208
    v_add_u32 v210, s61, v209
    v_add_u32 v211, s61, v210
    buffer_load_ushort v208, v208, s[24:27], 0 offen
    buffer_load_ushort v209, v209, s[24:27], 0 offen
    buffer_load_ushort v210, v210, s[24:27], 0 offen
    buffer_load_ushort v211, v211, s[24:27], 0 offen
    s_mov_b32 m0, s42
    s_mov_b32 exec_hi, 0x0fffffff
    buffer_load_dwordx4 v136, s[16:19], s58 offen lds
    s_add_u32 m0, s42, 7680
    s_nop 0
    buffer_load_dwordx4 v136, s[16:19], s59 offen lds
    s_mov_b32 exec_hi, -1
    v_lshrrev_b32 v155, 2, v152
    v_and_b32 v156, 3, v152
    s_mov_b32 s22, 55296
    s_mov_b32 s23, s19
    v_and_b32 v245, 2, v154
    v_mul_u32_u24 v244, 576, v155
    v_xor_b32 v245, v245, v156
    v_lshl_add_u32 v139, v245, 4, v244
    s_mul_i32 s48, s57, s38
    s_add_u32 s48, s48, s39
    s_mov_b32 s47, s39
    s_lshl_b32 s39, s38, 1
    s_cmp_ge_u32 s36, 4
    s_cbranch_scc1 L_s1
    s_lshl_b32 s55, s37, 10
    s_mul_i32 s4, s37, 9216
    v_xor_b32 v12, 16, v139
    s_add_u32 m0, s55, 88896
    s_nop 0
    buffer_load_dwordx4 v139, s[20:23], s4 offen offset:192 lds
    s_add_u32 m0, s55, 94976
    s_nop 0
    buffer_load_dwordx4 v139, s[20:23], s4 offen offset:256 lds
    s_add_u32 m0, s55, 101056
    s_nop 0
    buffer_load_dwordx4 v139, s[20:23], s4 offen offset:320 lds
    s_add_u32 m0, s55, 107136
    s_nop 0
    buffer_load_dwordx4 v12, s[20:23], s4 offen offset:384 lds
    s_add_u32 m0, s55, 113216
    s_nop 0
    buffer_load_dwordx4 v12, s[20:23], s4 offen offset:448 lds
    s_add_u32 m0, s55, 119296
    s_nop 0
    buffer_load_dwordx4 v12, s[20:23], s4 offen offset:512 lds
    s_mov_b32 s61, 52224
    s_movk_i32 s62, 6144
    s_mul_i32 s63, s37, 3
    v_lshl_add_u32 v15, v154, 9, s61
    v_and_b32 v17, 12, v152
    v_lshl_add_u32 v15, v17, 4, v15
    v_lshrrev_b32 v161, 3, v152
    v_and_b32 v161, 2, v161
    v_lshrrev_b32 v16, 1, v156
    v_and_b32 v162, v16, v156
    v_add3_u32 v17, s63, v156, 12
    v_mad_u32_u24 v17, v162, 11, v17
    v_lshrrev_b32 v18, 2, v17
    v_mad_u32_u24 v132, v18, s62, v15
    v_xor_b32 v17, v17, v161
    v_xor_b32 v17, v17, v162
    v_and_b32 v17, 3, v17
    v_lshl_add_u32 v132, v17, 4, v132
    v_lshl_add_u32 v132, v16, 3, v132
    v_xor_b32 v133, 8, v132
    v_add3_u32 v20, s63, v16, 24
    v_lshrrev_b32 v21, 2, v20
    v_mad_u32_u24 v134, v21, s62, v15
    v_xor_b32 v20, v20, v161
    v_xor_b32 v20, 1, v20
    v_and_b32 v20, 3, v20
    v_lshl_add_u32 v134, v20, 4, v134
    v_and_b32 v19, 1, v156
    v_lshl_add_u32 v134, v19, 3, v134
    v_lshrrev_b32 v22, 1, v153
    v_and_b32 v22, 2, v22
    v_xor_b32 v22, v22, v154
    v_mul_u32_u24 v23, 192, v153
    v_lshl_add_u32 v0, v22, 4, v23
    s_mul_i32 s49, s37, 7936
    s_add_u32 s49, s49, 95296
    v_mul_u32_u24 v163, 1280, v154
    v_add_u32 v163, s49, v163
    v_lshl_add_u32 v1, v153, 4, v163
    v_mul_u32_u24 v23, 704, v154
    v_lshl_add_u32 v22, v153, 3, s49
    v_add_u32 v2, v22, v23
    s_mul_i32 s56, s45, 86016
    s_sub_u32 s48, s48, s56
    s_max_i32 s57, s41, 0
    s_add_u32 s58, s41, 20
    s_min_i32 s58, s58, s44
    s_sub_u32 s57, s57, s58
    s_mul_i32 s57, s57, s43
    s_add_u32 s57, s57, s38
    s_cmp_eq_u32 s37, 3
    s_cselect_b32 s57, s57, 0
    v_cmp_lt_u32 vcc, 59, v152
    v_mov_b32 v24, s57
    v_add_u32 v159, 4, v152
    v_cndmask_b32 v24, 0, v24, vcc
    v_add3_u32 v136, v136, v24, s56
    v_bfe_u32 v157, v159, 3, 1
    v_and_b32 v159, 7, v159
    v_min_u32 v158, 6, v159
    v_lshrrev_b32 v160, 1, v154
    v_and_b32 v160, v160, v154
    s_lshr_b32 s56, s36, 2
    s_mul_i32 s56, s56, 7
    s_add_u32 s56, s56, s41
    v_add_u32 v36, s56, v158
    v_max_i32 v36, 0, v36
    v_min_i32 v36, 105, v36
    v_subrev_u32 v33, s56, v36
    v_sub_u32 v36, v159, v158
    v_lshl_add_u32 v33, v36, 6, v33
    s_lshl_b32 s5, s36, 10
    s_add_u32 s5, s5, 56320
    s_add_u32 s59, s5, 192
    v_lshlrev_b32 v36, 6, v157
    v_sub_u32 v34, s59, v36
    v_sub_u32 v35, 3, v158
    v_mov_b32 v91, 0xff800000
    v_mov_b32 v37, 0x6408640c
    v_sub_u32 v38, v154, v160
    v_lshl_add_u32 v39, v160, 6, v34
    v_lshlrev_b32 v25, 2, v154
    v_sub_u32 v40, v25, v33
    v_add_u32 v25, v25, v35
    v_cmp_gt_u32 s[64:65], 7, v40
    v_lshl_add_u32 v26, v38, 2, 1
    v_sub_u32 v41, v26, v33
    v_cndmask_b32 v25, 13, v25, s[64:65]
    v_lshl_add_u32 v25, v25, 2, v34
    v_add_u32 v26, v26, v35
    v_cmp_gt_u32 s[66:67], 7, v41
    v_lshl_add_u32 v27, v38, 2, 2
    v_sub_u32 v42, v27, v33
    v_cndmask_b32 v26, 13, v26, s[66:67]
    v_lshl_add_u32 v26, v26, 2, v39
    v_add_u32 v27, v27, v35
    v_cmp_gt_u32 s[68:69], 7, v42
    v_lshl_add_u32 v28, v38, 2, 3
    v_sub_u32 v43, v28, v33
    v_cndmask_b32 v27, 13, v27, s[68:69]
    v_lshl_add_u32 v27, v27, 2, v39
    v_add_u32 v28, v28, v35
    v_cmp_gt_u32 s[70:71], 7, v43
    v_lshl_add_u32 v29, v154, 1, 0
    v_sub_u32 v44, v29, v33
    v_cndmask_b32 v28, 13, v28, s[70:71]
    v_lshl_add_u32 v28, v28, 2, v39
    v_add_u32 v29, v29, v35
    v_cmp_gt_u32 s[64:65], 7, v44
    v_lshl_add_u32 v30, v154, 1, 1
    v_sub_u32 v45, v30, v33
    v_cndmask_b32 v29, 13, v29, s[64:65]
    v_lshl_add_u32 v29, v29, 2, v34
    v_add_u32 v30, v30, v35
    v_cmp_gt_u32 s[66:67], 7, v45
    v_lshlrev_b32 v46, 3, v154
    v_bfe_u32 v31, v37, v46, 8
    v_cndmask_b32 v30, 13, v30, s[66:67]
    v_lshl_add_u32 v30, v30, 2, v34
    v_sub_u32 v46, v31, v33
    v_add_u32 v31, v31, v35
    v_cmp_gt_u32 s[68:69], 7, v46
    v_mov_b32 v47, 0x01201514
    v_mov_b32 v220, 0x03021716
    v_cndmask_b32 v31, 13, v31, s[68:69]
    v_lshl_add_u32 v31, v31, 2, v34
    v_mov_b32 v221, 0x1d1c1918
    v_mov_b32 v222, 0x1f1e1b1a
    v_add_u32 v223, 3, v153
    v_and_b32 v223, 16, v223
    v_add_u32 v223, v223, v153
    v_and_b32 v225, 7, v153
    v_or_b32 v225, 0x0c0c0c00, v225
    v_cmp_gt_u32 s[70:71], 8, v153
    v_perm_b32 v226, v220, v47, v225
    v_perm_b32 v224, v222, v221, v225
    v_cndmask_b32 v224, v224, v226, s[70:71]
    v_lshl_add_u32 v3, v223, 4, v163
    v_lshl_add_u32 v4, v224, 4, v163
    v_add_u32 v227, 3, v155
    v_and_b32 v227, 16, v227
    v_add_u32 v227, v227, v155
    v_and_b32 v229, 7, v155
    v_or_b32 v229, 0x0c0c0c00, v229
    v_cmp_gt_u32 s[64:65], 8, v155
    v_perm_b32 v230, v220, v47, v229
    v_perm_b32 v228, v222, v221, v229
    v_cndmask_b32 v228, v228, v230, s[64:65]
    v_mul_u32_u24 v233, 704, v156
    v_add_u32 v233, s49, v233
    v_lshl_add_u32 v5, v227, 3, v233
    v_lshl_add_u32 v6, v228, 3, v233
    s_add_u32 s56, s49, 3840
    v_lshl_add_u32 v231, v156, 3, s56
    v_cmp_gt_u32 s[66:67], 2, v156
    v_lshl_add_u32 v7, v227, 4, v231
    v_lshl_add_u32 v8, v228, 4, v231
    v_mov_b32 v232, 127040
    v_cndmask_b32 v7, v232, v7, s[66:67]
    v_cndmask_b32 v8, v232, v8, s[66:67]
    v_mov_b32 v220, 0x3f803f80
    v_mov_b32 v221, 0x3f803f80
    v_mov_b32 v9, 0
    s_movk_i32 s61, -18432
    v_mad_i32_i24 v135, v162, s61, v132
    v_xor_b32 v137, 8, v135
    v_mad_u32_u24 v234, v157, 20, v158
    v_add_u32 v234, 63, v234
    v_lshrrev_b32 v235, 1, v234
    v_and_b32 v235, 2, v235
    v_xor_b32 v235, v235, v154
    v_mul_u32_u24 v236, 192, v234
    v_lshl_add_u32 v11, v235, 4, v236
    v_sub_u32 v10, v159, v158
    v_or_b32 v10, v10, v160
    v_add_u32 v10, -1, v10
    v_and_b32 v10, 0x3e96c740, v10
    v_lshl_add_u32 v32, v152, 2, s5
    v_cmp_gt_u32 vcc, 13, v153
    s_waitcnt vmcnt(11)
    v_lshlrev_b32 v208, 16, v208
    v_mul_f32 v208, 0x3fb8aa3b, v208
    v_cndmask_b32 v208, v91, v208, vcc
    s_waitcnt vmcnt(10)
    v_lshlrev_b32 v209, 16, v209
    v_mul_f32 v209, 0x3fb8aa3b, v209
    v_cndmask_b32 v209, v91, v209, vcc
    s_waitcnt vmcnt(9)
    v_lshlrev_b32 v210, 16, v210
    v_mul_f32 v210, 0x3fb8aa3b, v210
    v_cndmask_b32 v210, v91, v210, vcc
    s_waitcnt vmcnt(8)
    v_lshlrev_b32 v211, 16, v211
    v_mul_f32 v211, 0x3fb8aa3b, v211
    v_cndmask_b32 v211, v91, v211, vcc
    ds_write_b64 v232, v[220:221]
    ds_write_b64 v232, v[220:221] offset:640
    ds_write_b64 v232, v[220:221] offset:32400
    ds_write_b64 v232, v[220:221] offset:33040
    ds_write_b32 v32, v208
    ds_write_b32 v32, v209 offset:256
    ds_write_b32 v32, v210 offset:512
    ds_write_b32 v32, v211 offset:768
    ds_read_b32 v164, v25 offset:512
    ds_read_b32 v165, v26 offset:512
    ds_read_b32 v166, v27 offset:512
    ds_read_b32 v167, v28 offset:512
    ds_read_b32 v168, v29 offset:576
    ds_read_b32 v169, v30 offset:576
    ds_read_b32 v170, v31 offset:576
    ds_read_b32 v84, v25
    ds_read_b32 v85, v26
    ds_read_b32 v86, v27
    ds_read_b32 v87, v28
    ds_read_b32 v88, v29 offset:64
    ds_read_b32 v89, v30 offset:64
    ds_read_b32 v90, v31 offset:64
    ds_read_b32 v92, v25 offset:128
    ds_read_b32 v93, v26 offset:128
    ds_read_b32 v94, v27 offset:128
    ds_read_b32 v95, v28 offset:128
    ds_read_b32 v96, v29 offset:192
    ds_read_b32 v97, v30 offset:192
    ds_read_b32 v98, v31 offset:192
    ds_read_b32 v100, v25 offset:256
    ds_read_b32 v101, v26 offset:256
    ds_read_b32 v102, v27 offset:256
    ds_read_b32 v103, v28 offset:256
    ds_read_b32 v104, v29 offset:320
    ds_read_b32 v105, v30 offset:320
    ds_read_b32 v106, v31 offset:320
    ds_read_b32 v108, v25 offset:384
    ds_read_b32 v109, v26 offset:384
    ds_read_b32 v110, v27 offset:384
    ds_read_b32 v111, v28 offset:384
    ds_read_b32 v112, v29 offset:448
    ds_read_b32 v113, v30 offset:448
    ds_read_b32 v114, v31 offset:448
    s_add_u32 s48, s48, s39
    s_add_u32 m0, s42, 15360
    s_nop 0
    buffer_load_dwordx4 v136, s[16:19], s48 offen lds
    s_add_u32 s48, s48, s39
    s_add_u32 m0, s42, 23040
    s_nop 0
    buffer_load_dwordx4 v136, s[16:19], s48 offen lds
    s_waitcnt vmcnt(2) lgkmcnt(5)
    s_barrier
    ds_read_b128 v[220:223], v0
    ds_read_b128 v[224:227], v0 offset:64
    ds_read_b128 v[228:231], v0 offset:128
    ds_read_b64_tr_b16 v[12:13], v132 offset:18432
    ds_read_b64_tr_b16 v[14:15], v132 offset:18688
    ds_read_b64_tr_b16 v[16:17], v132 offset:20480
    ds_read_b64_tr_b16 v[18:19], v132 offset:20736
    ds_read_b64_tr_b16 v[20:21], v132 offset:22528
    ds_read_b64_tr_b16 v[22:23], v132 offset:22784
    ds_read_b64_tr_b16 v[24:25], v133 offset:18432
    ds_read_b64_tr_b16 v[26:27], v133 offset:18688
    s_add_u32 m0, s55, 70656
    ds_read_b64_tr_b16 v[28:29], v133 offset:20480
    buffer_load_dwordx4 v139, s[20:23], s4 offen lds
    s_add_u32 m0, s55, 76736
    ds_read_b64_tr_b16 v[30:31], v133 offset:20736
    buffer_load_dwordx4 v139, s[20:23], s4 offen offset:64 lds
    s_add_u32 m0, s55, 82816
    ds_read_b64_tr_b16 v[32:33], v133 offset:22528
    buffer_load_dwordx4 v139, s[20:23], s4 offen offset:128 lds
    ds_read_b64_tr_b16 v[34:35], v133 offset:22784
    ds_read_b64_tr_b16 v[36:37], v134 offset:18432
    ds_read_b64_tr_b16 v[38:39], v134 offset:18688
    s_waitcnt lgkmcnt(12)
    v_mfma_f32_16x16x32_bf16 v[244:247], v[12:15], v[220:223], 0
    s_mov_b32 s64, 0x0ff00ff0
    s_waitcnt lgkmcnt(10)
    v_mfma_f32_16x16x32_bf16 v[244:247], v[16:19], v[224:227], v[244:247]
    s_mov_b32 s65, 0x0ff00ff0
    s_waitcnt lgkmcnt(8)
    v_mfma_f32_16x16x32_bf16 v[244:247], v[20:23], v[228:231], v[244:247]
    s_mov_b32 s66, 0x0ff00ff0
    s_waitcnt lgkmcnt(6)
    v_mfma_f32_16x16x32_bf16 v[248:251], v[24:27], v[220:223], 0
    s_mov_b32 s67, 0x00000ff0
    v_cndmask_b32 v84, v84, v91, s[64:65]
    v_cndmask_b32 v85, v85, v91, s[66:67]
    v_cndmask_b32 v86, v86, v91, s[66:67]
    v_cndmask_b32 v87, v87, v91, s[66:67]
    s_cmp_eq_u32 s46, 0
    s_cselect_b64 s[64:65], -1, 0
    ds_read_b64_tr_b16 v[40:41], v134 offset:20480
    ds_read_b64_tr_b16 v[42:43], v134 offset:20736
    s_waitcnt lgkmcnt(6)
    v_mfma_f32_16x16x32_bf16 v[248:251], v[28:31], v[224:227], v[248:251]
    s_mov_b32 s66, s64
    s_and_b32 s67, s64, 0xffff
    ds_read_b64_tr_b16 v[44:45], v134 offset:22528
    ds_read_b64_tr_b16 v[46:47], v134 offset:22784
    v_cndmask_b32 v164, v84, v164, s[64:65]
    v_cndmask_b32 v165, v85, v165, s[64:65]
    s_mov_b32 s68, 0x00000000
    s_mov_b32 s69, 0xf00f0000
    v_cndmask_b32 v166, v86, v166, s[64:65]
    v_cndmask_b32 v167, v87, v167, s[64:65]
    v_cndmask_b32 v168, v88, v168, s[64:65]
    v_cndmask_b32 v169, v89, v169, s[64:65]
    s_mov_b32 s70, 0xf00ff00f
    s_mov_b32 s71, 0xf00ff00f
    v_cndmask_b32 v170, v90, v170, s[64:65]
    s_waitcnt lgkmcnt(5)
    v_mfma_f32_16x16x32_bf16 v[248:251], v[32:35], v[228:231], v[248:251]
    v_cndmask_b32 v76, v92, v91, s[64:65]
    s_waitcnt lgkmcnt(4)
    v_mfma_f32_16x16x32_bf16 v[252:255], v[36:39], v[220:223], 0
    v_cndmask_b32 v77, v93, v91, s[66:67]
    v_cndmask_b32 v78, v94, v91, s[66:67]
    s_mul_i32 s54, s45, 1032192
    s_mul_i32 s53, s37, 4608
    v_cndmask_b32 v79, v95, v91, s[66:67]
    v_cndmask_b32 v80, v84, v91, s[64:65]
    s_mul_i32 s52, s37, 3072
    v_cndmask_b32 v81, v85, v91, s[66:67]
    s_waitcnt lgkmcnt(2)
    v_mfma_f32_16x16x32_bf16 v[252:255], v[40:43], v[224:227], v[252:255]
    v_cndmask_b32 v82, v86, v91, s[66:67]
    s_waitcnt lgkmcnt(0)
    v_mfma_f32_16x16x32_bf16 v[252:255], v[44:47], v[228:231], v[252:255]
    v_cndmask_b32 v83, v87, v91, s[66:67]
    s_andn2_b64 s[66:67], s[68:69], s[64:65]
    s_andn2_b64 s[64:65], s[70:71], s[64:65]
    ds_read_b128 v[220:223], v0 offset:6144
    ds_read_b128 v[224:227], v0 offset:6208
    ds_read_b128 v[228:231], v0 offset:6272
    v_cndmask_b32 v109, v109, v91, s[66:67]
    s_lshr_b32 s56, s37, 1
    s_and_b32 s50, s37, 1
    v_cndmask_b32 v110, v110, v91, s[66:67]
    v_cndmask_b32 v111, v111, v91, s[66:67]
    s_lshl_b32 s59, s56, 10
    s_lshl3_add_u32 s59, s50, s59
    v_cndmask_b32 v112, v112, v91, s[64:65]
    v_cndmask_b32 v113, v113, v91, s[64:65]
    s_mul_i32 s51, s56, 3072
    s_mul_i32 s56, s56, 7
    v_cndmask_b32 v114, v114, v91, s[64:65]
    v_lshl_add_u32 v99, v152, 4, s59
    s_lshl_b32 s59, s37, 2
    s_sub_u32 s51, s51, s59
    v_lshl_add_u32 v107, v152, 4, s59
    s_add_u32 s56, s56, s41
    s_add_u32 s56, s56, 3
    v_add_u32 v48, s56, v158
    s_mul_i32 s59, s50, 128
    s_add_u32 s59, s59, s47
    v_lshl_add_u32 v49, v154, 4, s59
    v_mad_u32_u24 v48, v48, s43, v49
    s_mul_i32 s59, s45, 12
    s_add_u32 s59, s59, s40
    s_add_u32 s59, s59, 3
    v_add_u32 v49, s59, v157
    v_mad_i32_i24 v48, v49, s38, v48
    v_cmp_gt_u32 vcc, 7, v159
    v_mov_b32 v49, 0x80000000
    v_mul_u32_u24 v50, 192, v155
    v_cndmask_b32 v115, v49, v48, vcc
    v_lshl_add_u32 v138, v156, 4, v50
    v_cvt_pk_bf16_f32 v244, v244, v245
    v_cvt_pk_bf16_f32 v245, v246, v247
    v_cvt_pk_bf16_f32 v246, v248, v249
    v_cvt_pk_bf16_f32 v247, v250, v251
    s_waitcnt lgkmcnt(0)
    v_mfma_f32_16x16x32_bf16 v[248:251], v[24:27], v[220:223], 0
    v_cvt_pk_bf16_f32 v252, v252, v253
    v_cvt_pk_bf16_f32 v253, v254, v255
    v_mfma_f32_16x16x32_bf16 v[248:251], v[28:31], v[224:227], v[248:251]
    ds_write_b128 v1, v[244:247] offset:32400
    v_mfma_f32_16x16x32_bf16 v[244:247], v[12:15], v[220:223], 0
    ds_write_b64 v2, v[252:253] offset:37520
    v_mfma_f32_16x16x32_bf16 v[244:247], v[16:19], v[224:227], v[244:247]
    s_add_u32 s48, s48, s39
    s_add_u32 m0, s42, 30720
    v_mfma_f32_16x16x32_bf16 v[244:247], v[20:23], v[228:231], v[244:247]
    buffer_load_dwordx4 v136, s[16:19], s48 offen lds
    v_mfma_f32_16x16x32_bf16 v[248:251], v[32:35], v[228:231], v[248:251]
    s_add_u32 s48, s48, s39
    s_add_u32 m0, s42, 38400
    v_mfma_f32_16x16x32_bf16 v[252:255], v[36:39], v[220:223], 0
    buffer_load_dwordx4 v136, s[16:19], s48 offen lds
    v_mfma_f32_16x16x32_bf16 v[252:255], v[40:43], v[224:227], v[252:255]
    s_add_u32 s48, s48, s39
    v_cvt_pk_bf16_f32 v244, v244, v245
    v_cvt_pk_bf16_f32 v245, v246, v247
    v_mfma_f32_16x16x32_bf16 v[252:255], v[44:47], v[228:231], v[252:255]
    v_cvt_pk_bf16_f32 v246, v248, v249
    v_cvt_pk_bf16_f32 v247, v250, v251
    s_add_u32 m0, s42, 46080
    ds_write_b128 v1, v[244:247] offset:32912
    buffer_load_dwordx4 v136, s[16:19], s48 offen lds
    s_add_u32 s48, s48, s39
    s_add_u32 m0, s42, 53760
    s_nop 0
    v_cvt_pk_bf16_f32 v252, v252, v253
    v_cvt_pk_bf16_f32 v253, v254, v255
    ds_write_b64 v2, v[252:253] offset:37776
    s_waitcnt vmcnt(3) lgkmcnt(0)
    s_barrier
    ds_read_b128 v[220:223], v0 offset:15360
    ds_read_b128 v[224:227], v0 offset:15424
    ds_read_b128 v[228:231], v0 offset:15488
    ds_read_b64_tr_b16 v[48:49], v135
    ds_read_b64_tr_b16 v[50:51], v135 offset:256
    ds_read_b64_tr_b16 v[52:53], v135 offset:2048
    ds_read_b64_tr_b16 v[54:55], v135 offset:2304
    ds_read_b64_tr_b16 v[56:57], v135 offset:4096
    ds_read_b64_tr_b16 v[58:59], v135 offset:4352
    ds_read_b64_tr_b16 v[60:61], v137
    ds_read_b64_tr_b16 v[62:63], v137 offset:256
    buffer_load_dwordx4 v136, s[16:19], s48 offen lds
    ds_read_b64_tr_b16 v[64:65], v137 offset:2048
    ds_read_b64_tr_b16 v[66:67], v137 offset:2304
    ds_read_b64_tr_b16 v[68:69], v137 offset:4096
    s_add_u32 s48, s48, s39
    s_add_u32 m0, s42, 61440
    s_waitcnt lgkmcnt(13)
    v_mfma_f32_16x16x32_bf16 v[244:247], v[12:15], v[220:223], 0
    buffer_load_dwordx4 v136, s[16:19], s48 offen lds
    v_mfma_f32_16x16x32_bf16 v[248:251], v[24:27], v[220:223], 0
    s_add_u32 m0, s52, 76864
    ds_read_b64_tr_b16 v[70:71], v137 offset:4352
    v_mfma_f32_16x16x32_bf16 v[252:255], v[36:39], v[220:223], 0
    s_waitcnt lgkmcnt(8)
    ds_read_b128 v[172:175], v3 offset:32400
    v_mfma_f32_16x16x32_bf16 v[244:247], v[16:19], v[224:227], v[244:247]
    ds_read_b128 v[176:179], v4 offset:32400
    v_mfma_f32_16x16x32_bf16 v[244:247], v[20:23], v[228:231], v[244:247]
    ds_read_b128 v[220:223], v11
    v_mfma_f32_16x16x32_bf16 v[248:251], v[28:31], v[224:227], v[248:251]
    ds_read_b64_tr_b16 v[188:189], v5 offset:37520
    v_mfma_f32_16x16x32_bf16 v[248:251], v[32:35], v[228:231], v[248:251]
    ds_read_b64_tr_b16 v[190:191], v6 offset:37520
    v_mfma_f32_16x16x32_bf16 v[252:255], v[40:43], v[224:227], v[252:255]
    ds_read_b128 v[224:227], v11 offset:64
    v_mfma_f32_16x16x32_bf16 v[252:255], v[44:47], v[228:231], v[252:255]
    v_cvt_pk_bf16_f32 v244, v244, v245
    v_cvt_pk_bf16_f32 v245, v246, v247
    ds_read_b128 v[228:231], v11 offset:128
    ds_read_b64_tr_b16 v[192:193], v7 offset:32400
    v_cvt_pk_bf16_f32 v246, v248, v249
    v_cvt_pk_bf16_f32 v247, v250, v251
    ds_write_b128 v1, v[244:247]
    ds_read_b64_tr_b16 v[194:195], v8 offset:32400
    v_cvt_pk_bf16_f32 v252, v252, v253
    v_cvt_pk_bf16_f32 v253, v254, v255
    ds_write_b64 v2, v[252:253] offset:5120
    s_waitcnt lgkmcnt(8)
    ds_read_b128 v[180:183], v3 offset:33040
    v_mfma_f32_16x16x32_bf16 v[244:247], v[48:51], v[220:223], 0
    ds_read_b128 v[184:187], v4 offset:33040
    v_mfma_f32_16x16x32_bf16 v[248:251], v[60:63], v[220:223], 0
    ds_read_b128 v[220:223], v11 offset:7680
    s_waitcnt lgkmcnt(8)
    v_mfma_f32_16x16x32_bf16 v[244:247], v[52:55], v[224:227], v[244:247]
    s_waitcnt lgkmcnt(7)
    v_mfma_f32_16x16x32_bf16 v[244:247], v[56:59], v[228:231], v[244:247]
    v_mfma_f32_16x16x32_bf16 v[248:251], v[64:67], v[224:227], v[248:251]
    ds_read_b128 v[224:227], v11 offset:7744
    v_mfma_f32_16x16x32_bf16 v[248:251], v[68:71], v[228:231], v[248:251]
    ds_read_b128 v[228:231], v11 offset:7808
    s_nop 3
    v_mul_f32 v244, v10, v244
    v_mul_f32 v245, v10, v245
    v_cvt_pk_bf16_f32 v72, v244, v245
    v_mul_f32 v246, v10, v246
    v_mul_f32 v247, v10, v247
    v_cvt_pk_bf16_f32 v73, v246, v247
    v_mul_f32 v248, v10, v248
    v_mul_f32 v249, v10, v249
    v_cvt_pk_bf16_f32 v74, v248, v249
    v_mul_f32 v250, v10, v250
    v_mul_f32 v251, v10, v251
    v_cvt_pk_bf16_f32 v75, v250, v251
    s_nop 1
    v_mfma_f32_16x16x32_bf16 v[204:207], v[172:175], v[72:75], v[164:167]
    v_mfma_f32_16x16x32_bf16 v[208:211], v[176:179], v[72:75], v[168:171]
    s_waitcnt lgkmcnt(3)
    v_mfma_f32_16x16x32_bf16 v[196:199], v[180:183], v[72:75], v[76:79]
    s_waitcnt lgkmcnt(2)
    v_mfma_f32_16x16x32_bf16 v[244:247], v[48:51], v[220:223], 0
    v_mfma_f32_16x16x32_bf16 v[248:251], v[60:63], v[220:223], 0
    ds_read_b128 v[220:223], v0 offset:21504
    v_mfma_f32_16x16x32_bf16 v[200:203], v[184:187], v[72:75], v[96:99]
    v_max3_f32 v236, v204, v205, v206
    v_max3_f32 v236, v236, v207, v208
    s_waitcnt lgkmcnt(2)
    v_max3_f32 v236, v236, v209, v210
    v_mov_b32 v237, v236
    v_mfma_f32_16x16x32_bf16 v[244:247], v[52:55], v[224:227], v[244:247]
    s_waitcnt lgkmcnt(1)
    v_permlane32_swap_b32 v236, v237
    v_mfma_f32_16x16x32_bf16 v[244:247], v[56:59], v[228:231], v[244:247]
    v_max_f32 v236, v236, v237
    v_mov_b32 v237, v236
    v_mfma_f32_16x16x32_bf16 v[248:251], v[64:67], v[224:227], v[248:251]
    ds_read_b128 v[224:227], v0 offset:21568
    v_permlane16_swap_b32 v236, v237
    v_mfma_f32_16x16x32_bf16 v[248:251], v[68:71], v[228:231], v[248:251]
    v_max_f32 v232, v236, v237
    v_sub_f32 v204, v204, v232
    v_mul_f32 v244, v10, v244
    v_mul_f32 v245, v10, v245
    v_cvt_pk_bf16_f32 v116, v244, v245
    v_mul_f32 v246, v10, v246
    v_mul_f32 v247, v10, v247
    v_cvt_pk_bf16_f32 v117, v246, v247
    v_mul_f32 v248, v10, v248
    v_mul_f32 v249, v10, v249
    v_cvt_pk_bf16_f32 v118, v248, v249
    v_mul_f32 v250, v10, v250
    s_waitcnt lgkmcnt(1)
    v_mfma_f32_16x16x32_bf16 v[244:247], v[12:15], v[220:223], 0
    v_mul_f32 v251, v10, v251
    v_cvt_pk_bf16_f32 v119, v250, v251
    v_mfma_f32_16x16x32_bf16 v[248:251], v[24:27], v[220:223], 0
    v_sub_f32 v205, v205, v232
    v_sub_f32 v206, v206, v232
    v_mfma_f32_16x16x32_bf16 v[252:255], v[36:39], v[220:223], 0
    v_sub_f32 v207, v207, v232
    s_waitcnt lgkmcnt(0)
    v_mfma_f32_16x16x32_bf16 v[244:247], v[16:19], v[224:227], v[244:247]
    v_sub_f32 v208, v208, v232
    v_sub_f32 v209, v209, v232
    v_mfma_f32_16x16x32_bf16 v[248:251], v[28:31], v[224:227], v[248:251]
    v_sub_f32 v210, v210, v232
    v_exp_f32 v204, v204
    v_mfma_f32_16x16x32_bf16 v[252:255], v[40:43], v[224:227], v[252:255]
    v_exp_f32 v205, v205
    v_exp_f32 v206, v206
    v_cvt_pk_bf16_f32 v216, v204, v205
    v_exp_f32 v207, v207
    v_exp_f32 v208, v208
    v_cvt_pk_bf16_f32 v217, v206, v207
    v_exp_f32 v209, v209
    v_exp_f32 v210, v210
    v_cvt_pk_bf16_f32 v218, v208, v209
    v_cvt_pk_bf16_f32 v219, v210, 0
    v_max3_f32 v236, v196, v197, v198
    v_max3_f32 v236, v236, v199, v200
    v_mfma_f32_16x16x32_bf16 v[140:143], v[188:191], v[216:219], 0
    v_max3_f32 v236, v236, v201, v202
    v_mov_b32 v237, v236
    v_mfma_f32_16x16x32_bf16 v[144:147], v[192:195], v[216:219], 0
    ds_read_b64_tr_b16 v[188:189], v5 offset:37840
    ds_read_b64_tr_b16 v[190:191], v6 offset:37840
    ds_read_b64_tr_b16 v[192:193], v7 offset:33040
    ds_read_b64_tr_b16 v[194:195], v8 offset:33040
    ds_read_b128 v[228:231], v0 offset:21632
    ds_read_b128 v[220:223], v0 offset:27648
    ds_read_b128 v[224:227], v0 offset:27712
    v_permlane32_swap_b32 v236, v237
    v_max_f32 v236, v236, v237
    v_mov_b32 v237, v236
    s_nop 1
    v_permlane16_swap_b32 v236, v237
    v_max3_f32 v236, v236, v237, v232
    v_sub_f32 v237, v232, v236
    v_exp_f32 v237, v237
    v_mov_b32 v232, v236
    v_mul_f32 v140, v237, v140
    v_mul_f32 v141, v237, v141
    v_mul_f32 v142, v237, v142
    v_mul_f32 v143, v237, v143
    v_mul_f32 v144, v237, v144
    v_mul_f32 v145, v237, v145
    v_mul_f32 v146, v237, v146
    v_mul_f32 v147, v237, v147
    v_sub_f32 v196, v196, v232
    v_sub_f32 v197, v197, v232
    v_sub_f32 v198, v198, v232
    v_sub_f32 v199, v199, v232
    v_sub_f32 v200, v200, v232
    v_sub_f32 v201, v201, v232
    v_sub_f32 v202, v202, v232
    v_exp_f32 v196, v196
    v_exp_f32 v197, v197
    s_waitcnt lgkmcnt(2)
    v_mfma_f32_16x16x32_bf16 v[244:247], v[20:23], v[228:231], v[244:247]
    v_cvt_pk_bf16_f32 v212, v196, v197
    v_exp_f32 v198, v198
    v_mfma_f32_16x16x32_bf16 v[248:251], v[32:35], v[228:231], v[248:251]
    v_exp_f32 v199, v199
    v_mfma_f32_16x16x32_bf16 v[252:255], v[44:47], v[228:231], v[252:255]
    v_cvt_pk_bf16_f32 v213, v198, v199
    v_exp_f32 v200, v200
    v_exp_f32 v201, v201
    v_cvt_pk_bf16_f32 v244, v244, v245
    v_cvt_pk_bf16_f32 v245, v246, v247
    v_cvt_pk_bf16_f32 v214, v200, v201
    v_cvt_pk_bf16_f32 v246, v248, v249
    v_cvt_pk_bf16_f32 v247, v250, v251
    s_waitcnt lgkmcnt(0)
    v_mfma_f32_16x16x32_bf16 v[248:251], v[24:27], v[220:223], 0
    v_cvt_pk_bf16_f32 v252, v252, v253
    v_cvt_pk_bf16_f32 v253, v254, v255
    v_mfma_f32_16x16x32_bf16 v[248:251], v[28:31], v[224:227], v[248:251]
    v_exp_f32 v202, v202
    ds_write_b128 v1, v[244:247] offset:512
    v_mfma_f32_16x16x32_bf16 v[244:247], v[12:15], v[220:223], 0
    v_cvt_pk_bf16_f32 v215, v202, 0
    v_mfma_f32_16x16x32_bf16 v[244:247], v[16:19], v[224:227], v[244:247]
    ds_write_b64 v2, v[252:253] offset:5376
    v_mfma_f32_16x16x32_bf16 v[140:143], v[188:191], v[212:215], v[140:143]
    ds_read_b128 v[228:231], v0 offset:27776
    v_add_u32 v0, 30720, v0
    v_mfma_f32_16x16x32_bf16 v[144:147], v[192:195], v[212:215], v[144:147]
    v_mfma_f32_16x16x32_bf16 v[252:255], v[36:39], v[220:223], 0
    v_mfma_f32_16x16x32_bf16 v[252:255], v[40:43], v[224:227], v[252:255]
    s_waitcnt lgkmcnt(0)
    v_mfma_f32_16x16x32_bf16 v[244:247], v[20:23], v[228:231], v[244:247]
    v_mfma_f32_16x16x32_bf16 v[248:251], v[32:35], v[228:231], v[248:251]
    v_mfma_f32_16x16x32_bf16 v[252:255], v[44:47], v[228:231], v[252:255]
    s_nop 5
    v_cvt_pk_bf16_f32 v244, v244, v245
    v_cvt_pk_bf16_f32 v245, v246, v247
    v_cvt_pk_bf16_f32 v246, v248, v249
    v_cvt_pk_bf16_f32 v247, v250, v251
    v_cvt_pk_bf16_f32 v252, v252, v253
    v_cvt_pk_bf16_f32 v253, v254, v255
    ds_write_b128 v1, v[244:247] offset:1024
    ds_write_b64 v2, v[252:253] offset:5632
    s_waitcnt vmcnt(3) lgkmcnt(0)
    s_barrier
    v_mfma_f32_16x16x32_bf16 v[204:207], v[180:183], v[116:119], v[80:83]
    ds_read_b128 v[172:175], v3
    ds_read_b128 v[176:179], v4
    v_mfma_f32_16x16x32_bf16 v[208:211], v[184:187], v[116:119], v[88:91]
    ds_read_b128 v[220:223], v11 offset:15360
    buffer_load_dwordx4 v138, s[32:35], s53 offen lds
    ds_read_b128 v[224:227], v11 offset:15424
    ds_read_b128 v[228:231], v11 offset:15488
    ds_read_b128 v[180:183], v3 offset:640
    s_add_u32 m0, s52, 77824
    v_max3_f32 v236, v204, v205, v206
    buffer_load_dwordx4 v138, s[32:35], s53 offen offset:64 lds
    v_max3_f32 v236, v236, v207, v208
    v_max3_f32 v236, v236, v209, v210
    s_add_u32 m0, s52, 78784
    s_add_u32 s48, s48, s39
    v_mov_b32 v237, v236
    ds_read_b128 v[184:187], v4 offset:640
    buffer_load_dwordx4 v138, s[32:35], s53 offen offset:128 lds
    s_waitcnt lgkmcnt(5)
    v_mfma_f32_16x16x32_bf16 v[196:199], v[172:175], v[72:75], v[100:103]
    v_permlane32_swap_b32 v236, v237
    v_mfma_f32_16x16x32_bf16 v[200:203], v[176:179], v[72:75], v[104:107]
    v_max_f32 v236, v236, v237
    s_waitcnt lgkmcnt(4)
    v_mfma_f32_16x16x32_bf16 v[244:247], v[48:51], v[220:223], 0
    v_mov_b32 v237, v236
    s_add_u32 m0, s42, 69120
    s_waitcnt lgkmcnt(2)
    v_mfma_f32_16x16x32_bf16 v[244:247], v[52:55], v[224:227], v[244:247]
    v_permlane16_swap_b32 v236, v237
    v_mfma_f32_16x16x32_bf16 v[244:247], v[56:59], v[228:231], v[244:247]
    v_max_f32 v233, v236, v237
    v_sub_f32 v204, v204, v233
    v_mfma_f32_16x16x32_bf16 v[248:251], v[60:63], v[220:223], 0
    v_sub_f32 v205, v205, v233
    v_sub_f32 v206, v206, v233
    v_mfma_f32_16x16x32_bf16 v[248:251], v[64:67], v[224:227], v[248:251]
    v_sub_f32 v207, v207, v233
    v_sub_f32 v208, v208, v233
    v_mfma_f32_16x16x32_bf16 v[248:251], v[68:71], v[228:231], v[248:251]
    v_mul_f32 v244, v10, v244
    v_mul_f32 v245, v10, v245
    v_cvt_pk_bf16_f32 v120, v244, v245
    v_mul_f32 v246, v10, v246
    v_mul_f32 v247, v10, v247
    v_cvt_pk_bf16_f32 v121, v246, v247
    v_sub_f32 v209, v209, v233
    v_sub_f32 v210, v210, v233
    v_mul_f32 v248, v10, v248
    v_mul_f32 v249, v10, v249
    v_cvt_pk_bf16_f32 v122, v248, v249
    v_mul_f32 v250, v10, v250
    v_mul_f32 v251, v10, v251
    v_cvt_pk_bf16_f32 v123, v250, v251
    v_exp_f32 v204, v204
    v_exp_f32 v205, v205
    v_exp_f32 v206, v206
    v_cvt_pk_bf16_f32 v216, v204, v205
    v_exp_f32 v207, v207
    v_exp_f32 v208, v208
    v_cvt_pk_bf16_f32 v217, v206, v207
    v_mfma_f32_16x16x32_bf16 v[204:207], v[172:175], v[116:119], v[92:95]
    v_exp_f32 v209, v209
    v_exp_f32 v210, v210
    v_cvt_pk_bf16_f32 v218, v208, v209
    v_cvt_pk_bf16_f32 v219, v210, 0
    v_mfma_f32_16x16x32_bf16 v[208:211], v[176:179], v[116:119], v[96:99]
    buffer_load_dwordx4 v136, s[16:19], s48 offen lds
    v_max3_f32 v236, v196, v197, v198
    v_max3_f32 v236, v236, v199, v200
    v_mfma_f32_16x16x32_bf16 v[148:151], v[188:191], v[216:219], 0
    v_max3_f32 v236, v236, v201, v202
    v_mov_b32 v237, v236
    v_mfma_f32_16x16x32_bf16 v[152:155], v[192:195], v[216:219], 0
    ds_read_b64_tr_b16 v[188:189], v5 offset:5120
    ds_read_b64_tr_b16 v[190:191], v6 offset:5120
    ds_read_b64_tr_b16 v[192:193], v7
    ds_read_b64_tr_b16 v[194:195], v8
    ds_read_b128 v[220:223], v0
    ds_read_b128 v[224:227], v0 offset:64
    ds_read_b128 v[228:231], v0 offset:128
    v_permlane32_swap_b32 v236, v237
    v_max_f32 v236, v236, v237
    v_mov_b32 v237, v236
    s_nop 1
    v_permlane16_swap_b32 v236, v237
    v_max3_f32 v236, v236, v237, v232
    v_sub_f32 v237, v232, v236
    v_exp_f32 v237, v237
    v_mov_b32 v232, v236
    v_mul_f32 v140, v237, v140
    v_mul_f32 v141, v237, v141
    v_mul_f32 v142, v237, v142
    v_mul_f32 v143, v237, v143
    v_mul_f32 v144, v237, v144
    v_mul_f32 v145, v237, v145
    v_mul_f32 v146, v237, v146
    v_mul_f32 v147, v237, v147
    v_sub_f32 v196, v196, v232
    v_sub_f32 v197, v197, v232
    v_sub_f32 v198, v198, v232
    v_sub_f32 v199, v199, v232
    v_sub_f32 v200, v200, v232
    v_sub_f32 v201, v201, v232
    v_sub_f32 v202, v202, v232
    v_exp_f32 v196, v196
    v_exp_f32 v197, v197
    s_waitcnt lgkmcnt(2)
    v_mfma_f32_16x16x32_bf16 v[244:247], v[12:15], v[220:223], 0
    v_cvt_pk_bf16_f32 v212, v196, v197
    v_exp_f32 v198, v198
    v_mfma_f32_16x16x32_bf16 v[248:251], v[24:27], v[220:223], 0
    v_exp_f32 v199, v199
    v_mfma_f32_16x16x32_bf16 v[252:255], v[36:39], v[220:223], 0
    v_cvt_pk_bf16_f32 v213, v198, v199
    v_exp_f32 v200, v200
    v_mfma_f32_16x16x32_bf16 v[196:199], v[172:175], v[120:123], v[84:87]
    v_exp_f32 v201, v201
    s_waitcnt lgkmcnt(0)
    v_mfma_f32_16x16x32_bf16 v[244:247], v[16:19], v[224:227], v[244:247]
    v_cvt_pk_bf16_f32 v214, v200, v201
    v_exp_f32 v202, v202
    v_mfma_f32_16x16x32_bf16 v[244:247], v[20:23], v[228:231], v[244:247]
    v_cvt_pk_bf16_f32 v215, v202, 0
    v_max3_f32 v236, v204, v205, v206
    v_mfma_f32_16x16x32_bf16 v[248:251], v[28:31], v[224:227], v[248:251]
    v_max3_f32 v236, v236, v207, v208
    v_max3_f32 v236, v236, v209, v210
    v_mfma_f32_16x16x32_bf16 v[140:143], v[188:191], v[212:215], v[140:143]
    v_mov_b32 v237, v236
    v_mfma_f32_16x16x32_bf16 v[144:147], v[192:195], v[212:215], v[144:147]
    v_cvt_pk_bf16_f32 v244, v244, v245
    v_cvt_pk_bf16_f32 v245, v246, v247
    v_mfma_f32_16x16x32_bf16 v[248:251], v[32:35], v[228:231], v[248:251]
    v_permlane32_swap_b32 v236, v237
    v_mfma_f32_16x16x32_bf16 v[252:255], v[40:43], v[224:227], v[252:255]
    v_max_f32 v236, v236, v237
    v_mov_b32 v237, v236
    v_mfma_f32_16x16x32_bf16 v[252:255], v[44:47], v[228:231], v[252:255]
    ds_read_b128 v[220:223], v11 offset:23040
    ds_read_b128 v[224:227], v11 offset:23104
    v_mfma_f32_16x16x32_bf16 v[200:203], v[176:179], v[120:123], v[88:91]
    v_cvt_pk_bf16_f32 v246, v248, v249
    v_cvt_pk_bf16_f32 v247, v250, v251
    v_permlane16_swap_b32 v236, v237
    v_max3_f32 v236, v236, v237, v233
    v_sub_f32 v237, v233, v236
    v_cvt_pk_bf16_f32 v252, v252, v253
    v_cvt_pk_bf16_f32 v253, v254, v255
    v_exp_f32 v237, v237
    v_mov_b32 v233, v236
    v_mul_f32 v148, v237, v148
    v_mul_f32 v149, v237, v149
    v_mul_f32 v150, v237, v150
    v_mul_f32 v151, v237, v151
    v_mul_f32 v152, v237, v152
    v_mul_f32 v153, v237, v153
    v_mul_f32 v154, v237, v154
    v_mul_f32 v155, v237, v155
    v_sub_f32 v204, v204, v233
    v_sub_f32 v205, v205, v233
    v_sub_f32 v206, v206, v233
    v_sub_f32 v207, v207, v233
    v_sub_f32 v208, v208, v233
    v_sub_f32 v209, v209, v233
    v_sub_f32 v210, v210, v233
    v_exp_f32 v204, v204
    s_waitcnt lgkmcnt(1)
    v_mfma_f32_16x16x32_bf16 v[248:251], v[60:63], v[220:223], 0
    v_exp_f32 v205, v205
    s_waitcnt lgkmcnt(0)
    ds_write_b128 v1, v[244:247] offset:32400
    v_mfma_f32_16x16x32_bf16 v[244:247], v[48:51], v[220:223], 0
    v_cvt_pk_bf16_f32 v216, v204, v205
    v_exp_f32 v206, v206
    v_mfma_f32_16x16x32_bf16 v[244:247], v[52:55], v[224:227], v[244:247]
    v_exp_f32 v207, v207
    v_mfma_f32_16x16x32_bf16 v[248:251], v[64:67], v[224:227], v[248:251]
    v_cvt_pk_bf16_f32 v217, v206, v207
    v_exp_f32 v208, v208
    v_mfma_f32_16x16x32_bf16 v[204:207], v[180:183], v[72:75], v[108:111]
    v_exp_f32 v209, v209
    v_exp_f32 v210, v210
    v_cvt_pk_bf16_f32 v218, v208, v209
    v_cvt_pk_bf16_f32 v219, v210, 0
    v_mfma_f32_16x16x32_bf16 v[208:211], v[184:187], v[72:75], v[112:115]
    v_max3_f32 v236, v196, v197, v198
    v_mfma_f32_16x16x32_bf16 v[148:151], v[188:191], v[216:219], v[148:151]
    v_max3_f32 v236, v236, v199, v200
    v_mfma_f32_16x16x32_bf16 v[152:155], v[192:195], v[216:219], v[152:155]
    v_max3_f32 v236, v236, v201, v202
    ds_write_b64 v2, v[252:253] offset:37520
    ds_read_b128 v[228:231], v11 offset:23168
    ds_read_b128 v[220:223], v0 offset:6144
    ds_read_b128 v[224:227], v0 offset:6208
    v_mov_b32 v237, v236
    s_nop 1
    v_permlane32_swap_b32 v236, v237
    v_max_f32 v236, v236, v237
    v_mov_b32 v237, v236
    s_nop 1
    v_permlane16_swap_b32 v236, v237
    v_max_f32 v234, v236, v237
    v_sub_f32 v196, v196, v234
    v_sub_f32 v197, v197, v234
    v_sub_f32 v198, v198, v234
    v_sub_f32 v199, v199, v234
    v_sub_f32 v200, v200, v234
    v_sub_f32 v201, v201, v234
    v_sub_f32 v202, v202, v234
    v_exp_f32 v196, v196
    v_exp_f32 v197, v197
    v_exp_f32 v198, v198
    v_cvt_pk_bf16_f32 v212, v196, v197
    v_exp_f32 v199, v199
    v_exp_f32 v200, v200
    v_cvt_pk_bf16_f32 v213, v198, v199
    v_mfma_f32_16x16x32_bf16 v[196:199], v[180:183], v[116:119], v[100:103]
    v_exp_f32 v201, v201
    s_waitcnt lgkmcnt(2)
    v_mfma_f32_16x16x32_bf16 v[244:247], v[56:59], v[228:231], v[244:247]
    v_cvt_pk_bf16_f32 v214, v200, v201
    v_exp_f32 v202, v202
    v_mfma_f32_16x16x32_bf16 v[248:251], v[68:71], v[228:231], v[248:251]
    v_cvt_pk_bf16_f32 v215, v202, 0
    v_max3_f32 v236, v204, v205, v206
    v_mfma_f32_16x16x32_bf16 v[200:203], v[184:187], v[116:119], v[104:107]
    v_max3_f32 v236, v236, v207, v208
    v_max3_f32 v236, v236, v209, v210
    v_mfma_f32_16x16x32_bf16 v[156:159], v[188:191], v[212:215], 0
    v_mul_f32 v244, v10, v244
    v_mul_f32 v245, v10, v245
    v_mfma_f32_16x16x32_bf16 v[160:163], v[192:195], v[212:215], 0
    v_cvt_pk_bf16_f32 v124, v244, v245
    s_waitcnt lgkmcnt(0)
    v_mfma_f32_16x16x32_bf16 v[252:255], v[36:39], v[220:223], 0
    v_mul_f32 v246, v10, v246
    v_mul_f32 v247, v10, v247
    v_mfma_f32_16x16x32_bf16 v[252:255], v[40:43], v[224:227], v[252:255]
    v_cvt_pk_bf16_f32 v125, v246, v247
    v_mul_f32 v248, v10, v248
    v_mfma_f32_16x16x32_bf16 v[244:247], v[12:15], v[220:223], 0
    v_mul_f32 v249, v10, v249
    v_cvt_pk_bf16_f32 v126, v248, v249
    v_mfma_f32_16x16x32_bf16 v[244:247], v[16:19], v[224:227], v[244:247]
    v_mul_f32 v250, v10, v250
    v_mul_f32 v251, v10, v251
    v_cvt_pk_bf16_f32 v127, v250, v251
    v_mfma_f32_16x16x32_bf16 v[248:251], v[24:27], v[220:223], 0
    v_mov_b32 v237, v236
    v_mfma_f32_16x16x32_bf16 v[248:251], v[28:31], v[224:227], v[248:251]
    ds_read_b64_tr_b16 v[188:189], v5 offset:5440
    ds_read_b64_tr_b16 v[190:191], v6 offset:5440
    ds_read_b64_tr_b16 v[192:193], v7 offset:640
    ds_read_b64_tr_b16 v[194:195], v8 offset:640
    ds_read_b128 v[228:231], v0 offset:6272
    v_permlane32_swap_b32 v236, v237
    v_max_f32 v236, v236, v237
    v_mov_b32 v237, v236
    s_nop 1
    v_permlane16_swap_b32 v236, v237
    v_max3_f32 v236, v236, v237, v232
    v_sub_f32 v237, v232, v236
    v_exp_f32 v237, v237
    v_mov_b32 v232, v236
    v_mul_f32 v140, v237, v140
    v_mul_f32 v141, v237, v141
    v_mul_f32 v142, v237, v142
    v_mul_f32 v143, v237, v143
    v_mul_f32 v144, v237, v144
    v_mul_f32 v145, v237, v145
    v_mul_f32 v146, v237, v146
    v_mul_f32 v147, v237, v147
    v_sub_f32 v204, v204, v232
    v_sub_f32 v205, v205, v232
    v_sub_f32 v206, v206, v232
    v_sub_f32 v207, v207, v232
    v_sub_f32 v208, v208, v232
    v_sub_f32 v209, v209, v232
    v_sub_f32 v210, v210, v232
    v_exp_f32 v204, v204
    v_exp_f32 v205, v205
    v_exp_f32 v206, v206
    v_cvt_pk_bf16_f32 v216, v204, v205
    v_exp_f32 v207, v207
    s_waitcnt lgkmcnt(0)
    v_mfma_f32_16x16x32_bf16 v[244:247], v[20:23], v[228:231], v[244:247]
    v_cvt_pk_bf16_f32 v217, v206, v207
    v_exp_f32 v208, v208
    v_mfma_f32_16x16x32_bf16 v[248:251], v[32:35], v[228:231], v[248:251]
    v_exp_f32 v209, v209
    v_mfma_f32_16x16x32_bf16 v[252:255], v[44:47], v[228:231], v[252:255]
    v_cvt_pk_bf16_f32 v218, v208, v209
    v_exp_f32 v210, v210
    v_mfma_f32_16x16x32_bf16 v[204:207], v[180:183], v[120:123], v[92:95]
    v_cvt_pk_bf16_f32 v244, v244, v245
    v_cvt_pk_bf16_f32 v245, v246, v247
    v_cvt_pk_bf16_f32 v219, v210, 0
    v_mfma_f32_16x16x32_bf16 v[208:211], v[184:187], v[120:123], v[96:99]
    v_cvt_pk_bf16_f32 v246, v248, v249
    v_cvt_pk_bf16_f32 v247, v250, v251
    v_mfma_f32_16x16x32_bf16 v[140:143], v[188:191], v[216:219], v[140:143]
    v_cvt_pk_bf16_f32 v252, v252, v253
    v_cvt_pk_bf16_f32 v253, v254, v255
    v_mfma_f32_16x16x32_bf16 v[144:147], v[192:195], v[216:219], v[144:147]
    v_max3_f32 v236, v196, v197, v198
    ds_write_b128 v1, v[244:247] offset:32912
    ds_write_b64 v2, v[252:253] offset:37776
    v_max3_f32 v236, v236, v199, v200
    v_max3_f32 v236, v236, v201, v202
    v_mov_b32 v237, v236
    s_nop 1
    v_permlane32_swap_b32 v144, v146
    v_permlane32_swap_b32 v145, v147
    v_rcp_f32 v146, v146
    v_permlane32_swap_b32 v236, v237
    v_mul_f32 v140, v146, v140
    v_mul_f32 v141, v146, v141
    v_cvt_pk_bf16_f32 v140, v140, v141
    v_mul_f32 v142, v146, v142
    v_mul_f32 v143, v146, v143
    v_cvt_pk_bf16_f32 v141, v142, v143
    v_mul_f32 v144, v146, v144
    v_mul_f32 v145, v146, v145
    v_cvt_pk_bf16_f32 v142, v144, v145
    v_max_f32 v236, v236, v237
    v_mov_b32 v237, v236
    s_mul_i32 s62, s50, 96
    s_lshl_b32 s61, s37, 2
    ds_write_b64 v99, v[140:141] offset:6144
    ds_write_b32 v107, v142 offset:8192
    v_permlane16_swap_b32 v236, v237
    v_max3_f32 v236, v236, v237, v233
    v_sub_f32 v237, v233, v236
    v_exp_f32 v237, v237
    s_sub_u32 s61, 76864, s61
    s_lshl_b32 s63, s50, 11
    v_mov_b32 v233, v236
    v_mul_f32 v148, v237, v148
    s_add_u32 s63, s63, s61
    s_lshl_b32 s60, s50, 5
    v_mul_f32 v149, v237, v149
    v_mul_f32 v150, v237, v150
    s_add_u32 s60, s60, s61
    v_mul_f32 v151, v237, v151
    v_mul_f32 v152, v237, v152
    v_mul_f32 v153, v237, v153
    v_mul_f32 v154, v237, v154
    v_mul_f32 v155, v237, v155
    v_sub_f32 v196, v196, v233
    v_sub_f32 v197, v197, v233
    v_sub_f32 v198, v198, v233
    v_sub_f32 v199, v199, v233
    v_sub_f32 v200, v200, v233
    v_sub_f32 v201, v201, v233
    v_sub_f32 v202, v202, v233
    v_exp_f32 v196, v196
    v_exp_f32 v197, v197
    v_exp_f32 v198, v198
    v_cvt_pk_bf16_f32 v212, v196, v197
    v_exp_f32 v199, v199
    v_exp_f32 v200, v200
    v_cvt_pk_bf16_f32 v213, v198, v199
    v_exp_f32 v201, v201
    v_exp_f32 v202, v202
    v_cvt_pk_bf16_f32 v214, v200, v201
    v_cvt_pk_bf16_f32 v215, v202, 0
    v_max3_f32 v236, v204, v205, v206
    v_max3_f32 v236, v236, v207, v208
    v_mfma_f32_16x16x32_bf16 v[148:151], v[188:191], v[212:215], v[148:151]
    v_max3_f32 v236, v236, v209, v210
    v_mov_b32 v237, v236
    v_mfma_f32_16x16x32_bf16 v[152:155], v[192:195], v[212:215], v[152:155]
    s_nop 0
    v_permlane32_swap_b32 v236, v237
    v_max_f32 v236, v236, v237
    v_mov_b32 v237, v236
    s_nop 1
    v_permlane16_swap_b32 v236, v237
    v_max3_f32 v236, v236, v237, v234
    v_sub_f32 v237, v234, v236
    v_exp_f32 v237, v237
    v_mov_b32 v234, v236
    v_mul_f32 v156, v237, v156
    v_mul_f32 v157, v237, v157
    v_mul_f32 v158, v237, v158
    v_mul_f32 v159, v237, v159
    v_mul_f32 v160, v237, v160
    v_mul_f32 v161, v237, v161
    v_mul_f32 v162, v237, v162
    v_mul_f32 v163, v237, v163
    v_sub_f32 v204, v204, v234
    v_sub_f32 v205, v205, v234
    v_sub_f32 v206, v206, v234
    v_sub_f32 v207, v207, v234
    v_sub_f32 v208, v208, v234
    v_sub_f32 v209, v209, v234
    v_sub_f32 v210, v210, v234
    v_exp_f32 v204, v204
    v_exp_f32 v205, v205
    v_exp_f32 v206, v206
    v_cvt_pk_bf16_f32 v216, v204, v205
    v_exp_f32 v207, v207
    v_exp_f32 v208, v208
    v_cvt_pk_bf16_f32 v217, v206, v207
    v_exp_f32 v209, v209
    v_exp_f32 v210, v210
    v_cvt_pk_bf16_f32 v218, v208, v209
    v_cvt_pk_bf16_f32 v219, v210, 0
    s_nop 1
    v_mfma_f32_16x16x32_bf16 v[156:159], v[188:191], v[216:219], v[156:159]
    v_mfma_f32_16x16x32_bf16 v[160:163], v[192:195], v[216:219], v[160:163]
    s_waitcnt vmcnt(1) lgkmcnt(0)
    s_barrier
    v_mfma_f32_16x16x32_bf16 v[196:199], v[180:183], v[124:127], v[84:87]
    ds_read_b128 v[172:175], v3 offset:32400
    ds_read_b128 v[176:179], v4 offset:32400
    v_mfma_f32_16x16x32_bf16 v[200:203], v[184:187], v[124:127], v[88:91]
    ds_read_b128 v[220:223], v11 offset:30720
    ds_read_b128 v[224:227], v11 offset:30784
    ds_read_b128 v[228:231], v11 offset:30848
    ds_read_b128 v[180:183], v3 offset:33040
    ds_read_b128 v[184:187], v4 offset:33040
    v_max3_f32 v236, v196, v197, v198
    s_nop 1
    v_max3_f32 v236, v236, v199, v200
    v_max3_f32 v236, v236, v201, v202
    v_mov_b32 v237, v236
    s_nop 1
    v_permlane32_swap_b32 v236, v237
    v_max_f32 v236, v236, v237
    s_waitcnt lgkmcnt(6)
    v_mfma_f32_16x16x32_bf16 v[204:207], v[172:175], v[116:119], v[108:111]
    v_mov_b32 v237, v236
    s_waitcnt lgkmcnt(5)
    v_mfma_f32_16x16x32_bf16 v[208:211], v[176:179], v[116:119], v[112:115]
    v_permlane16_swap_b32 v236, v237
    v_max_f32 v235, v236, v237
    v_sub_f32 v196, v196, v235
    v_sub_f32 v197, v197, v235
    s_waitcnt lgkmcnt(4)
    v_mfma_f32_16x16x32_bf16 v[244:247], v[48:51], v[220:223], 0
    v_sub_f32 v198, v198, v235
    v_sub_f32 v199, v199, v235
    v_mfma_f32_16x16x32_bf16 v[248:251], v[60:63], v[220:223], 0
    v_sub_f32 v200, v200, v235
    s_waitcnt lgkmcnt(2)
    v_mfma_f32_16x16x32_bf16 v[244:247], v[52:55], v[224:227], v[244:247]
    v_sub_f32 v201, v201, v235
    v_sub_f32 v202, v202, v235
    v_mfma_f32_16x16x32_bf16 v[244:247], v[56:59], v[228:231], v[244:247]
    v_exp_f32 v196, v196
    v_mfma_f32_16x16x32_bf16 v[248:251], v[64:67], v[224:227], v[248:251]
    v_exp_f32 v197, v197
    v_mfma_f32_16x16x32_bf16 v[248:251], v[68:71], v[228:231], v[248:251]
    v_cvt_pk_bf16_f32 v212, v196, v197
    v_exp_f32 v198, v198
    v_exp_f32 v199, v199
    v_exp_f32 v200, v200
    v_mul_f32 v244, v10, v244
    v_mul_f32 v245, v10, v245
    v_cvt_pk_bf16_f32 v128, v244, v245
    v_mul_f32 v246, v10, v246
    v_mul_f32 v247, v10, v247
    v_cvt_pk_bf16_f32 v129, v246, v247
    v_mul_f32 v248, v10, v248
    v_mul_f32 v249, v10, v249
    v_cvt_pk_bf16_f32 v130, v248, v249
    v_mul_f32 v250, v10, v250
    v_mul_f32 v251, v10, v251
    v_cvt_pk_bf16_f32 v131, v250, v251
    v_cvt_pk_bf16_f32 v213, v198, v199
    v_mfma_f32_16x16x32_bf16 v[196:199], v[172:175], v[120:123], v[100:103]
    v_exp_f32 v201, v201
    v_exp_f32 v202, v202
    v_cvt_pk_bf16_f32 v214, v200, v201
    v_cvt_pk_bf16_f32 v215, v202, 0
    v_mfma_f32_16x16x32_bf16 v[200:203], v[176:179], v[120:123], v[104:107]
    v_max3_f32 v236, v204, v205, v206
    v_mfma_f32_16x16x32_bf16 v[164:167], v[188:191], v[212:215], 0
    v_max3_f32 v236, v236, v207, v208
    v_mfma_f32_16x16x32_bf16 v[168:171], v[192:195], v[212:215], 0
    v_max3_f32 v236, v236, v209, v210
    ds_read_b128 v[220:223], v11 offset:38400
    ds_read_b128 v[224:227], v11 offset:38464
    ds_read_b128 v[228:231], v11 offset:38528
    ds_read_b64_tr_b16 v[188:189], v5 offset:37520
    ds_read_b64_tr_b16 v[190:191], v6 offset:37520
    ds_read_b64_tr_b16 v[192:193], v7 offset:32400
    ds_read_b64_tr_b16 v[194:195], v8 offset:32400
    v_mov_b32 v237, v236
    v_cndmask_b32 v109, v109, v91, s[68:69]
    v_cndmask_b32 v110, v110, v91, s[68:69]
    v_permlane32_swap_b32 v236, v237
    v_max_f32 v236, v236, v237
    v_mov_b32 v237, v236
    v_cndmask_b32 v111, v111, v91, s[68:69]
    v_cndmask_b32 v112, v112, v91, s[70:71]
    v_permlane16_swap_b32 v236, v237
    v_max3_f32 v236, v236, v237, v233
    v_sub_f32 v237, v233, v236
    v_exp_f32 v237, v237
    v_mov_b32 v233, v236
    v_mul_f32 v148, v237, v148
    v_mul_f32 v149, v237, v149
    v_mul_f32 v150, v237, v150
    v_mul_f32 v151, v237, v151
    v_mul_f32 v152, v237, v152
    s_waitcnt lgkmcnt(6)
    v_mfma_f32_16x16x32_bf16 v[244:247], v[48:51], v[220:223], 0
    v_mul_f32 v153, v237, v153
    v_mul_f32 v154, v237, v154
    v_mfma_f32_16x16x32_bf16 v[248:251], v[60:63], v[220:223], 0
    v_mul_f32 v155, v237, v155
    s_waitcnt lgkmcnt(4)
    v_mfma_f32_16x16x32_bf16 v[244:247], v[52:55], v[224:227], v[244:247]
    v_sub_f32 v204, v204, v233
    v_sub_f32 v205, v205, v233
    v_mfma_f32_16x16x32_bf16 v[244:247], v[56:59], v[228:231], v[244:247]
    v_sub_f32 v206, v206, v233
    v_sub_f32 v207, v207, v233
    v_mfma_f32_16x16x32_bf16 v[248:251], v[64:67], v[224:227], v[248:251]
    v_sub_f32 v208, v208, v233
    v_sub_f32 v209, v209, v233
    v_mfma_f32_16x16x32_bf16 v[248:251], v[68:71], v[228:231], v[248:251]
    v_sub_f32 v210, v210, v233
    v_exp_f32 v204, v204
    v_mul_f32 v244, v10, v244
    v_mul_f32 v245, v10, v245
    v_cvt_pk_bf16_f32 v132, v244, v245
    v_mul_f32 v246, v10, v246
    v_mul_f32 v247, v10, v247
    v_cvt_pk_bf16_f32 v133, v246, v247
    v_mul_f32 v248, v10, v248
    v_mul_f32 v249, v10, v249
    v_cvt_pk_bf16_f32 v134, v248, v249
    v_mul_f32 v250, v10, v250
    v_mul_f32 v251, v10, v251
    v_cvt_pk_bf16_f32 v135, v250, v251
    v_exp_f32 v205, v205
    v_exp_f32 v206, v206
    v_cvt_pk_bf16_f32 v216, v204, v205
    v_exp_f32 v207, v207
    v_exp_f32 v208, v208
    v_cvt_pk_bf16_f32 v217, v206, v207
    v_mfma_f32_16x16x32_bf16 v[204:207], v[172:175], v[124:127], v[92:95]
    v_exp_f32 v209, v209
    v_exp_f32 v210, v210
    v_cvt_pk_bf16_f32 v218, v208, v209
    v_cvt_pk_bf16_f32 v219, v210, 0
    v_mfma_f32_16x16x32_bf16 v[208:211], v[176:179], v[124:127], v[96:99]
    v_max3_f32 v236, v196, v197, v198
    s_waitcnt lgkmcnt(0)
    v_mfma_f32_16x16x32_bf16 v[148:151], v[188:191], v[216:219], v[148:151]
    v_max3_f32 v236, v236, v199, v200
    v_mfma_f32_16x16x32_bf16 v[152:155], v[192:195], v[216:219], v[152:155]
    v_max3_f32 v236, v236, v201, v202
    ds_read_b128 v[220:223], v11 offset:46080
    ds_read_b128 v[224:227], v11 offset:46144
    ds_read_b128 v[228:231], v11 offset:46208
    v_mov_b32 v237, v236
    v_cndmask_b32 v113, v113, v91, s[70:71]
    v_cndmask_b32 v114, v114, v91, s[70:71]
    v_permlane32_swap_b32 v236, v237
    v_permlane32_swap_b32 v152, v154
    v_permlane32_swap_b32 v153, v155
    v_rcp_f32 v154, v154
    v_max_f32 v236, v236, v237
    v_mul_f32 v148, v154, v148
    v_mul_f32 v149, v154, v149
    v_cvt_pk_bf16_f32 v148, v148, v149
    v_mul_f32 v150, v154, v150
    v_mul_f32 v151, v154, v151
    v_cvt_pk_bf16_f32 v149, v150, v151
    v_mul_f32 v152, v154, v152
    v_mul_f32 v153, v154, v153
    v_cvt_pk_bf16_f32 v150, v152, v153
    ds_write_b64 v99, v[148:149] offset:12288
    s_waitcnt lgkmcnt(3)
    v_mfma_f32_16x16x32_bf16 v[244:247], v[48:51], v[220:223], 0
    v_mov_b32 v237, v236
    s_waitcnt lgkmcnt(2)
    v_mfma_f32_16x16x32_bf16 v[244:247], v[52:55], v[224:227], v[244:247]
    v_permlane16_swap_b32 v236, v237
    v_mfma_f32_16x16x32_bf16 v[248:251], v[60:63], v[220:223], 0
    v_max3_f32 v236, v236, v237, v234
    s_waitcnt lgkmcnt(1)
    v_mfma_f32_16x16x32_bf16 v[244:247], v[56:59], v[228:231], v[244:247]
    v_sub_f32 v237, v234, v236
    v_mfma_f32_16x16x32_bf16 v[248:251], v[64:67], v[224:227], v[248:251]
    v_exp_f32 v237, v237
    v_mfma_f32_16x16x32_bf16 v[248:251], v[68:71], v[228:231], v[248:251]
    v_mov_b32 v234, v236
    ds_write_b32 v107, v150 offset:14336
    ds_read_b128 v[220:223], v0 offset:15360
    ds_read_b128 v[224:227], v0 offset:15424
    ds_read_b128 v[228:231], v0 offset:15488
    v_mul_f32 v244, v10, v244
    v_mul_f32 v245, v10, v245
    v_cvt_pk_bf16_f32 v136, v244, v245
    v_mul_f32 v246, v10, v246
    v_mul_f32 v247, v10, v247
    v_cvt_pk_bf16_f32 v137, v246, v247
    v_mul_f32 v248, v10, v248
    v_mul_f32 v249, v10, v249
    v_cvt_pk_bf16_f32 v138, v248, v249
    v_mul_f32 v250, v10, v250
    v_mul_f32 v251, v10, v251
    v_cvt_pk_bf16_f32 v139, v250, v251
    v_add_u32 v10, s51, v107
    v_bfe_u32 v244, v107, 8, 2
    v_mad_i32_i24 v11, v244, -8, v115
    v_subrev_u32 v11, s62, v11
    v_bfe_u32 v245, v107, 4, 2
    v_add_u32 v247, s63, v107
    v_mad_i32_i24 v246, v245, -8, v107
    v_add_u32 v246, s60, v246
    v_mul_f32 v156, v237, v156
    v_mul_f32 v157, v237, v157
    v_mul_f32 v158, v237, v158
    v_mul_f32 v159, v237, v159
    v_mul_f32 v160, v237, v160
    v_mul_f32 v161, v237, v161
    v_mul_f32 v162, v237, v162
    v_mul_f32 v163, v237, v163
    v_sub_f32 v196, v196, v234
    ds_read_b64_tr_b16 v[48:49], v247
    ds_read_b64_tr_b16 v[50:51], v247 offset:3072
    ds_read_b64_tr_b16 v[52:53], v247 offset:6144
    ds_read_b64_tr_b16 v[54:55], v247 offset:9216
    ds_read_b64_tr_b16 v[56:57], v247 offset:12288
    ds_read_b64_tr_b16 v[58:59], v247 offset:15360
    v_sub_f32 v197, v197, v234
    s_waitcnt lgkmcnt(8)
    v_mfma_f32_16x16x32_bf16 v[248:251], v[24:27], v[220:223], 0
    v_sub_f32 v198, v198, v234
    v_sub_f32 v199, v199, v234
    v_mfma_f32_16x16x32_bf16 v[252:255], v[36:39], v[220:223], 0
    v_sub_f32 v200, v200, v234
    s_waitcnt lgkmcnt(6)
    v_mfma_f32_16x16x32_bf16 v[248:251], v[28:31], v[224:227], v[248:251]
    v_sub_f32 v201, v201, v234
    v_sub_f32 v202, v202, v234
    v_mfma_f32_16x16x32_bf16 v[248:251], v[32:35], v[228:231], v[248:251]
    v_exp_f32 v196, v196
    v_mfma_f32_16x16x32_bf16 v[252:255], v[40:43], v[224:227], v[252:255]
    v_exp_f32 v197, v197
    v_mfma_f32_16x16x32_bf16 v[252:255], v[44:47], v[228:231], v[252:255]
    v_cvt_pk_bf16_f32 v212, v196, v197
    ds_read_b64_tr_b16 v[60:61], v247 offset:8
    ds_read_b64_tr_b16 v[62:63], v247 offset:3080
    ds_read_b64_tr_b16 v[64:65], v247 offset:6152
    ds_read_b64_tr_b16 v[66:67], v247 offset:9224
    ds_read_b64_tr_b16 v[68:69], v247 offset:12296
    ds_read_b64_tr_b16 v[70:71], v247 offset:15368
    v_exp_f32 v198, v198
    v_cvt_pk_bf16_f32 v252, v252, v253
    v_cvt_pk_bf16_f32 v253, v254, v255
    v_exp_f32 v199, v199
    ds_read_b64_tr_b16 v[72:73], v246 offset:1024
    ds_read_b64_tr_b16 v[74:75], v246 offset:4096
    v_cvt_pk_bf16_f32 v213, v198, v199
    v_mfma_f32_16x16x32_bf16 v[196:199], v[172:175], v[128:131], v[84:87]
    v_exp_f32 v200, v200
    v_exp_f32 v201, v201
    v_exp_f32 v202, v202
    v_cvt_pk_bf16_f32 v214, v200, v201
    ds_read_b64_tr_b16 v[76:77], v246 offset:7168
    ds_read_b64_tr_b16 v[78:79], v246 offset:10240
    ds_read_b64_tr_b16 v[80:81], v246 offset:13312
    ds_read_b64_tr_b16 v[82:83], v246 offset:16384
    ds_write_b64 v2, v[252:253] offset:5120
    v_mfma_f32_16x16x32_bf16 v[244:247], v[12:15], v[220:223], 0
    v_cvt_pk_bf16_f32 v215, v202, 0
    v_max3_f32 v236, v204, v205, v206
    v_mfma_f32_16x16x32_bf16 v[244:247], v[16:19], v[224:227], v[244:247]
    v_max3_f32 v236, v236, v207, v208
    v_max3_f32 v236, v236, v209, v210
    v_mfma_f32_16x16x32_bf16 v[244:247], v[20:23], v[228:231], v[244:247]
    v_mov_b32 v237, v236
    v_mfma_f32_16x16x32_bf16 v[156:159], v[188:191], v[212:215], v[156:159]
    ds_read_b128 v[220:223], v0 offset:21504
    ds_read_b128 v[224:227], v0 offset:21568
    v_mfma_f32_16x16x32_bf16 v[160:163], v[192:195], v[212:215], v[160:163]
    v_permlane32_swap_b32 v236, v237
    v_mfma_f32_16x16x32_bf16 v[200:203], v[176:179], v[128:131], v[88:91]
    v_max_f32 v236, v236, v237
    v_cvt_pk_bf16_f32 v244, v244, v245
    v_cvt_pk_bf16_f32 v245, v246, v247
    v_cvt_pk_bf16_f32 v246, v248, v249
    v_cvt_pk_bf16_f32 v247, v250, v251
    v_mov_b32 v237, v236
    ds_write_b128 v1, v[244:247]
    ds_read_b128 v[228:231], v0 offset:21632
    s_mul_i32 s57, s39, 1
    v_permlane16_swap_b32 v236, v237
    s_add_u32 s57, s57, s54
    v_max3_f32 v236, v236, v237, v235
    v_sub_f32 v237, v235, v236
    v_exp_f32 v237, v237
    v_mov_b32 v235, v236
    v_mul_f32 v164, v237, v164
    s_waitcnt lgkmcnt(3)
    v_mfma_f32_16x16x32_bf16 v[244:247], v[12:15], v[220:223], 0
    v_mul_f32 v165, v237, v165
    v_mul_f32 v166, v237, v166
    v_mfma_f32_16x16x32_bf16 v[248:251], v[24:27], v[220:223], 0
    v_mul_f32 v167, v237, v167
    v_mul_f32 v168, v237, v168
    v_mfma_f32_16x16x32_bf16 v[252:255], v[36:39], v[220:223], 0
    v_mul_f32 v169, v237, v169
    s_waitcnt lgkmcnt(2)
    v_mfma_f32_16x16x32_bf16 v[244:247], v[16:19], v[224:227], v[244:247]
    v_mul_f32 v170, v237, v170
    v_mul_f32 v171, v237, v171
    v_mfma_f32_16x16x32_bf16 v[248:251], v[28:31], v[224:227], v[248:251]
    v_sub_f32 v204, v204, v235
    v_sub_f32 v205, v205, v235
    v_mfma_f32_16x16x32_bf16 v[252:255], v[40:43], v[224:227], v[252:255]
    v_sub_f32 v206, v206, v235
    v_sub_f32 v207, v207, v235
    v_sub_f32 v208, v208, v235
    v_sub_f32 v209, v209, v235
    v_sub_f32 v210, v210, v235
    s_waitcnt lgkmcnt(0)
    v_mfma_f32_16x16x32_bf16 v[244:247], v[20:23], v[228:231], v[244:247]
    v_exp_f32 v204, v204
    v_mfma_f32_16x16x32_bf16 v[248:251], v[32:35], v[228:231], v[248:251]
    v_exp_f32 v205, v205
    v_mfma_f32_16x16x32_bf16 v[252:255], v[44:47], v[228:231], v[252:255]
    v_cvt_pk_bf16_f32 v216, v204, v205
    v_exp_f32 v206, v206
    v_exp_f32 v207, v207
    v_exp_f32 v208, v208
    v_cvt_pk_bf16_f32 v217, v206, v207
    v_mfma_f32_16x16x32_bf16 v[204:207], v[180:183], v[120:123], v[108:111]
    v_exp_f32 v209, v209
    v_exp_f32 v210, v210
    v_cvt_pk_bf16_f32 v218, v208, v209
    v_cvt_pk_bf16_f32 v219, v210, 0
    v_mfma_f32_16x16x32_bf16 v[208:211], v[184:187], v[120:123], v[112:115]
    v_cvt_pk_bf16_f32 v244, v244, v245
    v_cvt_pk_bf16_f32 v245, v246, v247
    v_mfma_f32_16x16x32_bf16 v[164:167], v[188:191], v[216:219], v[164:167]
    v_cvt_pk_bf16_f32 v246, v248, v249
    v_cvt_pk_bf16_f32 v247, v250, v251
    v_mfma_f32_16x16x32_bf16 v[168:171], v[192:195], v[216:219], v[168:171]
    v_cvt_pk_bf16_f32 v252, v252, v253
    v_cvt_pk_bf16_f32 v253, v254, v255
    v_max3_f32 v236, v196, v197, v198
    v_max3_f32 v236, v236, v199, v200
    v_max3_f32 v236, v236, v201, v202
    v_mov_b32 v237, v236
    ds_write_b128 v1, v[244:247] offset:512
    ds_write_b64 v2, v[252:253] offset:5376
    ds_read_b128 v[220:223], v0 offset:27648
    ds_read_b128 v[224:227], v0 offset:27712
    ds_read_b128 v[228:231], v0 offset:27776
    v_permlane32_swap_b32 v236, v237
    v_max_f32 v236, v236, v237
    v_mov_b32 v237, v236
    s_nop 1
    v_permlane16_swap_b32 v236, v237
    v_max_f32 v232, v236, v237
    v_sub_f32 v196, v196, v232
    v_sub_f32 v197, v197, v232
    v_sub_f32 v198, v198, v232
    v_sub_f32 v199, v199, v232
    v_sub_f32 v200, v200, v232
    v_sub_f32 v201, v201, v232
    v_sub_f32 v202, v202, v232
    v_exp_f32 v196, v196
    v_exp_f32 v197, v197
    v_exp_f32 v198, v198
    v_cvt_pk_bf16_f32 v212, v196, v197
    v_exp_f32 v199, v199
    v_exp_f32 v200, v200
    v_cvt_pk_bf16_f32 v213, v198, v199
    v_mfma_f32_16x16x32_bf16 v[196:199], v[180:183], v[124:127], v[100:103]
    v_exp_f32 v201, v201
    v_exp_f32 v202, v202
    v_cvt_pk_bf16_f32 v214, v200, v201
    v_cvt_pk_bf16_f32 v215, v202, 0
    v_mfma_f32_16x16x32_bf16 v[200:203], v[184:187], v[124:127], v[104:107]
    v_max3_f32 v236, v204, v205, v206
    v_max3_f32 v236, v236, v207, v208
    v_mfma_f32_16x16x32_bf16 v[140:143], v[188:191], v[212:215], 0
    v_max3_f32 v236, v236, v209, v210
    v_mov_b32 v237, v236
    v_mfma_f32_16x16x32_bf16 v[144:147], v[192:195], v[212:215], 0
    ds_read_b64_tr_b16 v[188:189], v5 offset:37840
    s_waitcnt lgkmcnt(1)
    v_mfma_f32_16x16x32_bf16 v[244:247], v[12:15], v[220:223], 0
    v_permlane32_swap_b32 v236, v237
    v_mfma_f32_16x16x32_bf16 v[244:247], v[16:19], v[224:227], v[244:247]
    v_max_f32 v236, v236, v237
    v_mov_b32 v237, v236
    v_mfma_f32_16x16x32_bf16 v[244:247], v[20:23], v[228:231], v[244:247]
    ds_read_b64_tr_b16 v[190:191], v6 offset:37840
    ds_read_b64_tr_b16 v[192:193], v7 offset:33040
    v_mfma_f32_16x16x32_bf16 v[248:251], v[24:27], v[220:223], 0
    v_permlane16_swap_b32 v236, v237
    v_mfma_f32_16x16x32_bf16 v[248:251], v[28:31], v[224:227], v[248:251]
    v_max3_f32 v236, v236, v237, v234
    v_sub_f32 v237, v234, v236
    v_mfma_f32_16x16x32_bf16 v[248:251], v[32:35], v[228:231], v[248:251]
    v_exp_f32 v237, v237
    v_mfma_f32_16x16x32_bf16 v[252:255], v[36:39], v[220:223], 0
    v_mov_b32 v234, v236
    v_mul_f32 v156, v237, v156
    v_mfma_f32_16x16x32_bf16 v[252:255], v[40:43], v[224:227], v[252:255]
    v_mul_f32 v157, v237, v157
    v_mul_f32 v158, v237, v158
    v_mfma_f32_16x16x32_bf16 v[252:255], v[44:47], v[228:231], v[252:255]
    v_mul_f32 v159, v237, v159
    v_mul_f32 v160, v237, v160
    v_mul_f32 v161, v237, v161
    v_mul_f32 v162, v237, v162
    v_mul_f32 v163, v237, v163
    v_sub_f32 v204, v204, v234
    v_sub_f32 v205, v205, v234
    v_sub_f32 v206, v206, v234
    v_sub_f32 v207, v207, v234
    v_sub_f32 v208, v208, v234
    v_sub_f32 v209, v209, v234
    v_sub_f32 v210, v210, v234
    v_exp_f32 v204, v204
    v_exp_f32 v205, v205
    v_exp_f32 v206, v206
    v_cvt_pk_bf16_f32 v216, v204, v205
    v_exp_f32 v207, v207
    v_exp_f32 v208, v208
    v_cvt_pk_bf16_f32 v217, v206, v207
    v_mfma_f32_16x16x32_bf16 v[204:207], v[180:183], v[128:131], v[92:95]
    v_exp_f32 v209, v209
    v_exp_f32 v210, v210
    v_cvt_pk_bf16_f32 v218, v208, v209
    v_cvt_pk_bf16_f32 v219, v210, 0
    v_mfma_f32_16x16x32_bf16 v[208:211], v[184:187], v[128:131], v[96:99]
    v_cvt_pk_bf16_f32 v244, v244, v245
    s_waitcnt lgkmcnt(0)
    v_mfma_f32_16x16x32_bf16 v[156:159], v[188:191], v[216:219], v[156:159]
    v_cvt_pk_bf16_f32 v245, v246, v247
    ds_read_b64_tr_b16 v[194:195], v8 offset:33040
    v_cvt_pk_bf16_f32 v246, v248, v249
    v_cvt_pk_bf16_f32 v247, v250, v251
    v_cvt_pk_bf16_f32 v252, v252, v253
    v_cvt_pk_bf16_f32 v253, v254, v255
    v_max3_f32 v236, v196, v197, v198
    v_max3_f32 v236, v236, v199, v200
    v_max3_f32 v236, v236, v201, v202
    v_mov_b32 v237, v236
    ds_write_b128 v1, v[244:247] offset:1024
    ds_write_b64 v2, v[252:253] offset:5632
    v_permlane32_swap_b32 v236, v237
    v_max_f32 v236, v236, v237
    v_mov_b32 v237, v236
    s_nop 1
    v_permlane16_swap_b32 v236, v237
    v_max3_f32 v236, v236, v237, v235
    v_sub_f32 v237, v235, v236
    v_exp_f32 v237, v237
    s_waitcnt lgkmcnt(2)
    v_mfma_f32_16x16x32_bf16 v[160:163], v[192:195], v[216:219], v[160:163]
    v_mov_b32 v235, v236
    v_mul_f32 v164, v237, v164
    v_mul_f32 v165, v237, v165
    v_mul_f32 v166, v237, v166
    v_mul_f32 v167, v237, v167
    v_mul_f32 v168, v237, v168
    v_mul_f32 v169, v237, v169
    v_mul_f32 v170, v237, v170
    v_permlane32_swap_b32 v160, v162
    v_permlane32_swap_b32 v161, v163
    v_rcp_f32 v162, v162
    v_mul_f32 v171, v237, v171
    v_mul_f32 v156, v162, v156
    v_mul_f32 v157, v162, v157
    v_cvt_pk_bf16_f32 v156, v156, v157
    v_mul_f32 v158, v162, v158
    v_mul_f32 v159, v162, v159
    v_cvt_pk_bf16_f32 v157, v158, v159
    v_mul_f32 v160, v162, v160
    v_mul_f32 v161, v162, v161
    v_cvt_pk_bf16_f32 v158, v160, v161
    v_sub_f32 v196, v196, v235
    v_sub_f32 v197, v197, v235
    v_sub_f32 v198, v198, v235
    v_sub_f32 v199, v199, v235
    v_sub_f32 v200, v200, v235
    v_sub_f32 v201, v201, v235
    v_sub_f32 v202, v202, v235
    v_exp_f32 v196, v196
    v_exp_f32 v197, v197
    v_exp_f32 v198, v198
    v_cvt_pk_bf16_f32 v212, v196, v197
    v_exp_f32 v199, v199
    v_exp_f32 v200, v200
    v_cvt_pk_bf16_f32 v213, v198, v199
    v_exp_f32 v201, v201
    v_exp_f32 v202, v202
    v_cvt_pk_bf16_f32 v214, v200, v201
    ds_write_b64 v99, v[156:157] offset:18432
    ds_write_b32 v107, v158 offset:20480
    v_cvt_pk_bf16_f32 v215, v202, 0
    v_max3_f32 v236, v204, v205, v206
    v_max3_f32 v236, v236, v207, v208
    v_mfma_f32_16x16x32_bf16 v[164:167], v[188:191], v[212:215], v[164:167]
    v_max3_f32 v236, v236, v209, v210
    v_mov_b32 v237, v236
    v_mfma_f32_16x16x32_bf16 v[168:171], v[192:195], v[212:215], v[168:171]
    s_nop 0
    v_permlane32_swap_b32 v236, v237
    v_max_f32 v236, v236, v237
    v_mov_b32 v237, v236
    s_nop 1
    v_permlane16_swap_b32 v236, v237
    v_max3_f32 v236, v236, v237, v232
    v_sub_f32 v237, v232, v236
    v_exp_f32 v237, v237
    v_mov_b32 v232, v236
    v_mul_f32 v140, v237, v140
    v_mul_f32 v141, v237, v141
    v_mul_f32 v142, v237, v142
    v_mul_f32 v143, v237, v143
    v_mul_f32 v144, v237, v144
    v_mul_f32 v145, v237, v145
    v_mul_f32 v146, v237, v146
    v_mul_f32 v147, v237, v147
    v_sub_f32 v204, v204, v232
    v_sub_f32 v205, v205, v232
    v_sub_f32 v206, v206, v232
    v_sub_f32 v207, v207, v232
    v_sub_f32 v208, v208, v232
    v_sub_f32 v209, v209, v232
    v_sub_f32 v210, v210, v232
    v_exp_f32 v204, v204
    v_exp_f32 v205, v205
    v_exp_f32 v206, v206
    v_cvt_pk_bf16_f32 v216, v204, v205
    v_exp_f32 v207, v207
    v_exp_f32 v208, v208
    v_cvt_pk_bf16_f32 v217, v206, v207
    v_exp_f32 v209, v209
    v_exp_f32 v210, v210
    v_cvt_pk_bf16_f32 v218, v208, v209
    v_cvt_pk_bf16_f32 v219, v210, 0
    s_nop 1
    v_mfma_f32_16x16x32_bf16 v[140:143], v[188:191], v[216:219], v[140:143]
    v_mfma_f32_16x16x32_bf16 v[144:147], v[192:195], v[216:219], v[144:147]
    s_waitcnt vmcnt(0) lgkmcnt(0)
    s_barrier
    v_mfma_f32_16x16x32_bf16 v[196:199], v[180:183], v[132:135], v[84:87]
    ds_read_b128 v[172:175], v3
    ds_read_b128 v[176:179], v4
    v_mfma_f32_16x16x32_bf16 v[200:203], v[184:187], v[132:135], v[88:91]
    ds_read_b128 v[220:223], v10 offset:12288
    ds_read_b128 v[224:227], v10 offset:13312
    ds_read_b128 v[228:231], v10 offset:14336
    ds_read_b128 v[180:183], v3 offset:640
    ds_read_b128 v[184:187], v4 offset:640
    v_max3_f32 v236, v196, v197, v198
    s_nop 1
    v_max3_f32 v236, v236, v199, v200
    v_max3_f32 v236, v236, v201, v202
    v_mov_b32 v237, v236
    s_nop 1
    v_permlane32_swap_b32 v236, v237
    v_max_f32 v236, v236, v237
    v_mov_b32 v237, v236
    s_nop 1
    v_permlane16_swap_b32 v236, v237
    v_max_f32 v233, v236, v237
    v_sub_f32 v196, v196, v233
    v_sub_f32 v197, v197, v233
    v_sub_f32 v198, v198, v233
    v_sub_f32 v199, v199, v233
    v_sub_f32 v200, v200, v233
    v_sub_f32 v201, v201, v233
    s_waitcnt lgkmcnt(6)
    v_mfma_f32_16x16x32_bf16 v[204:207], v[172:175], v[124:127], v[108:111]
    v_sub_f32 v202, v202, v233
    s_waitcnt lgkmcnt(5)
    v_mfma_f32_16x16x32_bf16 v[208:211], v[176:179], v[124:127], v[112:115]
    v_exp_f32 v196, v196
    s_waitcnt lgkmcnt(4)
    v_mfma_f32_16x16x32_bf16 v[244:247], v[48:51], v[220:223], 0
    v_exp_f32 v197, v197
    v_mfma_f32_16x16x32_bf16 v[248:251], v[60:63], v[220:223], 0
    v_cvt_pk_bf16_f32 v212, v196, v197
    v_exp_f32 v198, v198
    v_mfma_f32_16x16x32_bf16 v[252:255], v[72:75], v[220:223], 0
    v_exp_f32 v199, v199
    s_waitcnt lgkmcnt(0)
    v_mfma_f32_16x16x32_bf16 v[244:247], v[52:55], v[224:227], v[244:247]
    v_cvt_pk_bf16_f32 v213, v198, v199
    v_exp_f32 v200, v200
    v_mfma_f32_16x16x32_bf16 v[244:247], v[56:59], v[228:231], v[244:247]
    v_exp_f32 v201, v201
    v_mfma_f32_16x16x32_bf16 v[248:251], v[64:67], v[224:227], v[248:251]
    v_cvt_pk_bf16_f32 v214, v200, v201
    v_exp_f32 v202, v202
    v_mfma_f32_16x16x32_bf16 v[248:251], v[68:71], v[228:231], v[248:251]
    v_cvt_pk_bf16_f32 v215, v202, 0
    v_max3_f32 v236, v204, v205, v206
    v_mfma_f32_16x16x32_bf16 v[252:255], v[76:79], v[224:227], v[252:255]
    v_cvt_pk_bf16_f32 v244, v244, v245
    v_cvt_pk_bf16_f32 v245, v246, v247
    v_mfma_f32_16x16x32_bf16 v[252:255], v[80:83], v[228:231], v[252:255]
    v_max3_f32 v236, v236, v207, v208
    v_max3_f32 v236, v236, v209, v210
    v_mfma_f32_16x16x32_bf16 v[148:151], v[188:191], v[212:215], 0
    v_cvt_pk_bf16_f32 v246, v248, v249
    v_cvt_pk_bf16_f32 v247, v250, v251
    v_mfma_f32_16x16x32_bf16 v[152:155], v[192:195], v[212:215], 0
    buffer_store_dwordx4 v[244:247], v115, s[28:31], s57 offen sc0 sc1
    ds_read_b64_tr_b16 v[188:189], v5 offset:5120
    ds_read_b64_tr_b16 v[190:191], v6 offset:5120
    ds_read_b64_tr_b16 v[192:193], v7
    v_mfma_f32_16x16x32_bf16 v[196:199], v[172:175], v[128:131], v[100:103]
    v_cvt_pk_bf16_f32 v252, v252, v253
    v_cvt_pk_bf16_f32 v253, v254, v255
    v_mfma_f32_16x16x32_bf16 v[200:203], v[176:179], v[128:131], v[104:107]
    buffer_store_dwordx2 v[252:253], v11, s[28:31], s57 offen offset:64 sc0 sc1
    ds_read_b64_tr_b16 v[194:195], v8
    ds_read_b128 v[220:223], v0 offset:30720
    ds_read_b128 v[224:227], v0 offset:30784
    ds_read_b128 v[228:231], v0 offset:30848
    v_mov_b32 v237, v236
    s_nop 1
    v_permlane32_swap_b32 v236, v237
    v_max_f32 v236, v236, v237
    v_mov_b32 v237, v236
    s_nop 1
    v_permlane16_swap_b32 v236, v237
    v_max3_f32 v236, v236, v237, v235
    v_sub_f32 v237, v235, v236
    v_exp_f32 v237, v237
    v_mov_b32 v235, v236
    v_mul_f32 v164, v237, v164
    v_mul_f32 v165, v237, v165
    v_mul_f32 v166, v237, v166
    s_waitcnt lgkmcnt(2)
    v_mul_f32 v167, v237, v167
    v_mul_f32 v168, v237, v168
    v_mfma_f32_16x16x32_bf16 v[244:247], v[12:15], v[220:223], 0
    v_mul_f32 v169, v237, v169
    v_mul_f32 v170, v237, v170
    v_mfma_f32_16x16x32_bf16 v[248:251], v[24:27], v[220:223], 0
    v_mul_f32 v171, v237, v171
    v_sub_f32 v204, v204, v235
    v_mfma_f32_16x16x32_bf16 v[252:255], v[36:39], v[220:223], 0
    v_sub_f32 v205, v205, v235
    s_waitcnt lgkmcnt(0)
    v_mfma_f32_16x16x32_bf16 v[244:247], v[16:19], v[224:227], v[244:247]
    v_sub_f32 v206, v206, v235
    v_sub_f32 v207, v207, v235
    v_mfma_f32_16x16x32_bf16 v[244:247], v[20:23], v[228:231], v[244:247]
    v_sub_f32 v208, v208, v235
    v_sub_f32 v209, v209, v235
    v_mfma_f32_16x16x32_bf16 v[248:251], v[28:31], v[224:227], v[248:251]
    v_sub_f32 v210, v210, v235
    v_exp_f32 v204, v204
    v_mfma_f32_16x16x32_bf16 v[248:251], v[32:35], v[228:231], v[248:251]
    v_exp_f32 v205, v205
    v_mfma_f32_16x16x32_bf16 v[252:255], v[40:43], v[224:227], v[252:255]
    v_cvt_pk_bf16_f32 v216, v204, v205
    v_exp_f32 v206, v206
    v_mfma_f32_16x16x32_bf16 v[252:255], v[44:47], v[228:231], v[252:255]
    v_exp_f32 v207, v207
    v_exp_f32 v208, v208
    v_cvt_pk_bf16_f32 v217, v206, v207
    v_mfma_f32_16x16x32_bf16 v[204:207], v[172:175], v[132:135], v[92:95]
    v_exp_f32 v209, v209
    v_exp_f32 v210, v210
    v_cvt_pk_bf16_f32 v218, v208, v209
    v_cvt_pk_bf16_f32 v219, v210, 0
    v_mfma_f32_16x16x32_bf16 v[208:211], v[176:179], v[132:135], v[96:99]
    v_cvt_pk_bf16_f32 v244, v244, v245
    v_cvt_pk_bf16_f32 v245, v246, v247
    v_mfma_f32_16x16x32_bf16 v[164:167], v[188:191], v[216:219], v[164:167]
    v_cvt_pk_bf16_f32 v246, v248, v249
    v_cvt_pk_bf16_f32 v247, v250, v251
    v_mfma_f32_16x16x32_bf16 v[168:171], v[192:195], v[216:219], v[168:171]
    v_cvt_pk_bf16_f32 v252, v252, v253
    v_cvt_pk_bf16_f32 v253, v254, v255
    v_max3_f32 v236, v196, v197, v198
    v_max3_f32 v236, v236, v199, v200
    v_max3_f32 v236, v236, v201, v202
    v_mov_b32 v237, v236
    ds_write_b128 v1, v[244:247] offset:32400
    ds_write_b64 v2, v[252:253] offset:37520
    ds_read_b128 v[220:223], v0 offset:36864
    ds_read_b128 v[224:227], v0 offset:36928
    v_permlane32_swap_b32 v168, v170
    v_permlane32_swap_b32 v169, v171
    v_rcp_f32 v170, v170
    v_permlane32_swap_b32 v236, v237
    v_mul_f32 v164, v170, v164
    v_mul_f32 v165, v170, v165
    v_cvt_pk_bf16_f32 v164, v164, v165
    v_mul_f32 v166, v170, v166
    v_mul_f32 v167, v170, v167
    v_cvt_pk_bf16_f32 v165, v166, v167
    v_mul_f32 v168, v170, v168
    v_mul_f32 v169, v170, v169
    v_cvt_pk_bf16_f32 v166, v168, v169
    v_max_f32 v236, v236, v237
    v_mov_b32 v237, v236
    ds_write_b64 v99, v[164:165] offset:24576
    ds_write_b32 v107, v166 offset:26624
    ds_read_b128 v[228:231], v0 offset:36992
    s_mul_i32 s58, s39, 3
    v_permlane16_swap_b32 v236, v237
    s_add_u32 s58, s58, s54
    v_max3_f32 v236, v236, v237, v232
    v_sub_f32 v237, v232, v236
    s_waitcnt lgkmcnt(4)
    v_exp_f32 v237, v237
    v_mfma_f32_16x16x32_bf16 v[244:247], v[12:15], v[220:223], 0
    v_mov_b32 v232, v236
    v_mul_f32 v140, v237, v140
    v_mfma_f32_16x16x32_bf16 v[248:251], v[24:27], v[220:223], 0
    v_mul_f32 v141, v237, v141
    v_mul_f32 v142, v237, v142
    v_mfma_f32_16x16x32_bf16 v[252:255], v[36:39], v[220:223], 0
    v_mul_f32 v143, v237, v143
    s_waitcnt lgkmcnt(3)
    v_mfma_f32_16x16x32_bf16 v[244:247], v[16:19], v[224:227], v[244:247]
    v_mul_f32 v144, v237, v144
    v_mul_f32 v145, v237, v145
    v_mfma_f32_16x16x32_bf16 v[248:251], v[28:31], v[224:227], v[248:251]
    v_mul_f32 v146, v237, v146
    v_mul_f32 v147, v237, v147
    v_mfma_f32_16x16x32_bf16 v[252:255], v[40:43], v[224:227], v[252:255]
    v_sub_f32 v196, v196, v232
    v_sub_f32 v197, v197, v232
    v_sub_f32 v198, v198, v232
    v_sub_f32 v199, v199, v232
    v_sub_f32 v200, v200, v232
    v_sub_f32 v201, v201, v232
    v_sub_f32 v202, v202, v232
    v_exp_f32 v196, v196
    v_exp_f32 v197, v197
    s_waitcnt lgkmcnt(0)
    v_mfma_f32_16x16x32_bf16 v[244:247], v[20:23], v[228:231], v[244:247]
    v_cvt_pk_bf16_f32 v212, v196, v197
    v_exp_f32 v198, v198
    v_mfma_f32_16x16x32_bf16 v[248:251], v[32:35], v[228:231], v[248:251]
    v_exp_f32 v199, v199
    v_mfma_f32_16x16x32_bf16 v[252:255], v[44:47], v[228:231], v[252:255]
    v_cvt_pk_bf16_f32 v213, v198, v199
    v_exp_f32 v200, v200
    v_mfma_f32_16x16x32_bf16 v[196:199], v[172:175], v[136:139], v[84:87]
    v_exp_f32 v201, v201
    v_exp_f32 v202, v202
    v_cvt_pk_bf16_f32 v214, v200, v201
    v_cvt_pk_bf16_f32 v215, v202, 0
    v_mfma_f32_16x16x32_bf16 v[200:203], v[176:179], v[136:139], v[88:91]
    v_cvt_pk_bf16_f32 v244, v244, v245
    v_cvt_pk_bf16_f32 v245, v246, v247
    v_mfma_f32_16x16x32_bf16 v[140:143], v[188:191], v[212:215], v[140:143]
    v_cvt_pk_bf16_f32 v246, v248, v249
    v_cvt_pk_bf16_f32 v247, v250, v251
    v_mfma_f32_16x16x32_bf16 v[144:147], v[192:195], v[212:215], v[144:147]
    v_cvt_pk_bf16_f32 v252, v252, v253
    v_cvt_pk_bf16_f32 v253, v254, v255
    v_max3_f32 v236, v204, v205, v206
    v_max3_f32 v236, v236, v207, v208
    v_max3_f32 v236, v236, v209, v210
    v_mov_b32 v237, v236
    ds_write_b128 v1, v[244:247] offset:32912
    ds_write_b64 v2, v[252:253] offset:37776
    v_permlane32_swap_b32 v236, v237
    v_max_f32 v236, v236, v237
    v_mov_b32 v237, v236
    s_nop 1
    v_permlane16_swap_b32 v236, v237
    v_max3_f32 v236, v236, v237, v233
    v_sub_f32 v237, v233, v236
    v_exp_f32 v237, v237
    v_mov_b32 v233, v236
    v_mul_f32 v148, v237, v148
    v_mul_f32 v149, v237, v149
    v_mul_f32 v150, v237, v150
    v_mul_f32 v151, v237, v151
    v_mul_f32 v152, v237, v152
    v_mul_f32 v153, v237, v153
    v_mul_f32 v154, v237, v154
    v_mul_f32 v155, v237, v155
    v_sub_f32 v204, v204, v233
    v_sub_f32 v205, v205, v233
    v_sub_f32 v206, v206, v233
    v_sub_f32 v207, v207, v233
    v_sub_f32 v208, v208, v233
    v_sub_f32 v209, v209, v233
    v_sub_f32 v210, v210, v233
    v_exp_f32 v204, v204
    v_exp_f32 v205, v205
    v_exp_f32 v206, v206
    v_cvt_pk_bf16_f32 v216, v204, v205
    v_exp_f32 v207, v207
    v_exp_f32 v208, v208
    v_cvt_pk_bf16_f32 v217, v206, v207
    v_mfma_f32_16x16x32_bf16 v[204:207], v[180:183], v[128:131], v[108:111]
    v_exp_f32 v209, v209
    v_exp_f32 v210, v210
    v_cvt_pk_bf16_f32 v218, v208, v209
    v_cvt_pk_bf16_f32 v219, v210, 0
    v_mfma_f32_16x16x32_bf16 v[208:211], v[184:187], v[128:131], v[112:115]
    v_max3_f32 v236, v196, v197, v198
    v_max3_f32 v236, v236, v199, v200
    v_mfma_f32_16x16x32_bf16 v[148:151], v[188:191], v[216:219], v[148:151]
    v_max3_f32 v236, v236, v201, v202
    v_mov_b32 v237, v236
    v_mfma_f32_16x16x32_bf16 v[152:155], v[192:195], v[216:219], v[152:155]
    s_nop 0
    v_permlane32_swap_b32 v236, v237
    v_max_f32 v236, v236, v237
    v_mov_b32 v237, v236
    s_nop 1
    v_permlane16_swap_b32 v236, v237
    v_max_f32 v234, v236, v237
    v_sub_f32 v196, v196, v234
    v_sub_f32 v197, v197, v234
    v_sub_f32 v198, v198, v234
    v_sub_f32 v199, v199, v234
    v_sub_f32 v200, v200, v234
    v_sub_f32 v201, v201, v234
    v_sub_f32 v202, v202, v234
    v_exp_f32 v196, v196
    v_exp_f32 v197, v197
    v_exp_f32 v198, v198
    v_cvt_pk_bf16_f32 v212, v196, v197
    v_exp_f32 v199, v199
    v_exp_f32 v200, v200
    v_cvt_pk_bf16_f32 v213, v198, v199
    v_mfma_f32_16x16x32_bf16 v[196:199], v[180:183], v[132:135], v[100:103]
    v_exp_f32 v201, v201
    v_exp_f32 v202, v202
    v_cvt_pk_bf16_f32 v214, v200, v201
    v_cvt_pk_bf16_f32 v215, v202, 0
    v_mfma_f32_16x16x32_bf16 v[200:203], v[184:187], v[132:135], v[104:107]
    v_max3_f32 v236, v204, v205, v206
    v_max3_f32 v236, v236, v207, v208
    v_mfma_f32_16x16x32_bf16 v[156:159], v[188:191], v[212:215], 0
    v_max3_f32 v236, v236, v209, v210
    v_mov_b32 v237, v236
    v_mfma_f32_16x16x32_bf16 v[160:163], v[192:195], v[212:215], 0
    ds_read_b64_tr_b16 v[188:189], v5 offset:5440
    ds_read_b64_tr_b16 v[190:191], v6 offset:5440
    ds_read_b64_tr_b16 v[192:193], v7 offset:640
    ds_read_b64_tr_b16 v[194:195], v8 offset:640
    v_permlane32_swap_b32 v236, v237
    v_max_f32 v236, v236, v237
    v_mov_b32 v237, v236
    s_nop 1
    v_permlane16_swap_b32 v236, v237
    v_max3_f32 v236, v236, v237, v232
    v_sub_f32 v237, v232, v236
    v_exp_f32 v237, v237
    v_mov_b32 v232, v236
    v_mul_f32 v140, v237, v140
    v_mul_f32 v141, v237, v141
    v_mul_f32 v142, v237, v142
    v_mul_f32 v143, v237, v143
    v_mul_f32 v144, v237, v144
    v_mul_f32 v145, v237, v145
    v_mul_f32 v146, v237, v146
    v_mul_f32 v147, v237, v147
    v_sub_f32 v204, v204, v232
    v_sub_f32 v205, v205, v232
    v_sub_f32 v206, v206, v232
    v_sub_f32 v207, v207, v232
    v_sub_f32 v208, v208, v232
    v_sub_f32 v209, v209, v232
    v_sub_f32 v210, v210, v232
    v_exp_f32 v204, v204
    v_exp_f32 v205, v205
    v_exp_f32 v206, v206
    v_cvt_pk_bf16_f32 v216, v204, v205
    v_exp_f32 v207, v207
    v_exp_f32 v208, v208
    v_cvt_pk_bf16_f32 v217, v206, v207
    v_exp_f32 v209, v209
    v_exp_f32 v210, v210
    v_cvt_pk_bf16_f32 v218, v208, v209
    v_cvt_pk_bf16_f32 v219, v210, 0
    s_waitcnt lgkmcnt(0)
    s_mul_i32 s59, s39, 5
    s_add_u32 s59, s59, s54
    v_max3_f32 v236, v196, v197, v198
    v_max3_f32 v236, v236, v199, v200
    v_mfma_f32_16x16x32_bf16 v[140:143], v[188:191], v[216:219], v[140:143]
    v_max3_f32 v236, v236, v201, v202
    v_mov_b32 v237, v236
    v_mfma_f32_16x16x32_bf16 v[144:147], v[192:195], v[216:219], v[144:147]
    s_nop 0
    v_permlane32_swap_b32 v236, v237
    v_max_f32 v236, v236, v237
    v_mov_b32 v237, v236
    s_nop 1
    v_permlane16_swap_b32 v236, v237
    v_max3_f32 v236, v236, v237, v233
    v_permlane32_swap_b32 v144, v146
    v_permlane32_swap_b32 v145, v147
    v_rcp_f32 v146, v146
    v_sub_f32 v237, v233, v236
    v_mul_f32 v140, v146, v140
    v_mul_f32 v141, v146, v141
    v_cvt_pk_bf16_f32 v140, v140, v141
    v_mul_f32 v142, v146, v142
    v_mul_f32 v143, v146, v143
    v_cvt_pk_bf16_f32 v141, v142, v143
    v_mul_f32 v144, v146, v144
    v_mul_f32 v145, v146, v145
    v_cvt_pk_bf16_f32 v142, v144, v145
    v_exp_f32 v237, v237
    v_mov_b32 v233, v236
    v_mul_f32 v148, v237, v148
    v_mul_f32 v149, v237, v149
    v_mul_f32 v150, v237, v150
    v_mul_f32 v151, v237, v151
    v_mul_f32 v152, v237, v152
    v_mul_f32 v153, v237, v153
    v_mul_f32 v154, v237, v154
    v_mul_f32 v155, v237, v155
    v_sub_f32 v196, v196, v233
    v_sub_f32 v197, v197, v233
    v_sub_f32 v198, v198, v233
    v_sub_f32 v199, v199, v233
    v_sub_f32 v200, v200, v233
    v_sub_f32 v201, v201, v233
    v_sub_f32 v202, v202, v233
    v_exp_f32 v196, v196
    v_exp_f32 v197, v197
    v_exp_f32 v198, v198
    v_cvt_pk_bf16_f32 v212, v196, v197
    v_exp_f32 v199, v199
    v_exp_f32 v200, v200
    v_cvt_pk_bf16_f32 v213, v198, v199
    v_exp_f32 v201, v201
    v_exp_f32 v202, v202
    v_cvt_pk_bf16_f32 v214, v200, v201
    v_cvt_pk_bf16_f32 v215, v202, 0
    ds_write_b64 v99, v[140:141] offset:30720
    ds_write_b32 v107, v142 offset:32768
    v_mfma_f32_16x16x32_bf16 v[148:151], v[188:191], v[212:215], v[148:151]
    v_mfma_f32_16x16x32_bf16 v[152:155], v[192:195], v[212:215], v[152:155]
    s_waitcnt lgkmcnt(0)
    s_barrier
    v_mfma_f32_16x16x32_bf16 v[204:207], v[180:183], v[136:139], v[92:95]
    ds_read_b128 v[172:175], v3 offset:32400
    ds_read_b128 v[176:179], v4 offset:32400
    v_mfma_f32_16x16x32_bf16 v[208:211], v[184:187], v[136:139], v[96:99]
    s_mul_i32 s60, s39, 6
    s_add_u32 s60, s60, s54
    ds_read_b128 v[220:223], v10 offset:24576
    ds_read_b128 v[224:227], v10 offset:25600
    ds_read_b128 v[228:231], v10 offset:26624
    v_max3_f32 v236, v204, v205, v206
    ds_read_b128 v[180:183], v3 offset:33040
    ds_read_b128 v[184:187], v4 offset:33040
    v_max3_f32 v236, v236, v207, v208
    v_max3_f32 v236, v236, v209, v210
    v_mov_b32 v237, v236
    s_nop 1
    v_permlane32_swap_b32 v236, v237
    v_max_f32 v236, v236, v237
    s_waitcnt lgkmcnt(6)
    v_mfma_f32_16x16x32_bf16 v[196:199], v[172:175], v[132:135], v[108:111]
    v_mov_b32 v237, v236
    s_waitcnt lgkmcnt(5)
    v_mfma_f32_16x16x32_bf16 v[200:203], v[176:179], v[132:135], v[112:115]
    v_permlane16_swap_b32 v236, v237
    v_max3_f32 v236, v236, v237, v234
    v_sub_f32 v237, v234, v236
    v_exp_f32 v237, v237
    s_waitcnt lgkmcnt(4)
    v_mov_b32 v234, v236
    v_mul_f32 v156, v237, v156
    v_mfma_f32_16x16x32_bf16 v[244:247], v[48:51], v[220:223], 0
    v_mul_f32 v157, v237, v157
    v_mul_f32 v158, v237, v158
    v_mfma_f32_16x16x32_bf16 v[248:251], v[60:63], v[220:223], 0
    v_mul_f32 v159, v237, v159
    v_mul_f32 v160, v237, v160
    v_mfma_f32_16x16x32_bf16 v[252:255], v[72:75], v[220:223], 0
    v_mul_f32 v161, v237, v161
    s_waitcnt lgkmcnt(1)
    v_mfma_f32_16x16x32_bf16 v[244:247], v[52:55], v[224:227], v[244:247]
    v_mul_f32 v162, v237, v162
    v_mul_f32 v163, v237, v163
    v_mfma_f32_16x16x32_bf16 v[244:247], v[56:59], v[228:231], v[244:247]
    v_sub_f32 v204, v204, v234
    v_sub_f32 v205, v205, v234
    v_mfma_f32_16x16x32_bf16 v[248:251], v[64:67], v[224:227], v[248:251]
    v_sub_f32 v206, v206, v234
    v_sub_f32 v207, v207, v234
    v_mfma_f32_16x16x32_bf16 v[248:251], v[68:71], v[228:231], v[248:251]
    v_sub_f32 v208, v208, v234
    v_sub_f32 v209, v209, v234
    v_mfma_f32_16x16x32_bf16 v[252:255], v[76:79], v[224:227], v[252:255]
    v_cvt_pk_bf16_f32 v244, v244, v245
    v_cvt_pk_bf16_f32 v245, v246, v247
    v_mfma_f32_16x16x32_bf16 v[252:255], v[80:83], v[228:231], v[252:255]
    v_sub_f32 v210, v210, v234
    v_exp_f32 v204, v204
    v_cvt_pk_bf16_f32 v246, v248, v249
    v_cvt_pk_bf16_f32 v247, v250, v251
    buffer_store_dwordx4 v[244:247], v115, s[28:31], s58 offen sc0 sc1
    v_exp_f32 v205, v205
    v_exp_f32 v206, v206
    v_cvt_pk_bf16_f32 v216, v204, v205
    v_cvt_pk_bf16_f32 v252, v252, v253
    v_cvt_pk_bf16_f32 v253, v254, v255
    v_exp_f32 v207, v207
    v_exp_f32 v208, v208
    v_cvt_pk_bf16_f32 v217, v206, v207
    v_exp_f32 v209, v209
    v_exp_f32 v210, v210
    v_cvt_pk_bf16_f32 v218, v208, v209
    v_cvt_pk_bf16_f32 v219, v210, 0
    v_max3_f32 v236, v196, v197, v198
    v_max3_f32 v236, v236, v199, v200
    v_mfma_f32_16x16x32_bf16 v[156:159], v[188:191], v[216:219], v[156:159]
    buffer_store_dwordx2 v[252:253], v11, s[28:31], s58 offen offset:64 sc0 sc1
    v_mfma_f32_16x16x32_bf16 v[160:163], v[192:195], v[216:219], v[160:163]
    v_max3_f32 v236, v236, v201, v202
    v_mov_b32 v237, v236
    ds_read_b64_tr_b16 v[188:189], v5 offset:37520
    ds_read_b64_tr_b16 v[190:191], v6 offset:37520
    ds_read_b64_tr_b16 v[192:193], v7 offset:32400
    ds_read_b64_tr_b16 v[194:195], v8 offset:32400
    v_permlane32_swap_b32 v236, v237
    v_max_f32 v236, v236, v237
    v_mov_b32 v237, v236
    s_nop 1
    v_permlane16_swap_b32 v236, v237
    v_max3_f32 v236, v236, v237, v233
    v_sub_f32 v237, v233, v236
    v_exp_f32 v237, v237
    v_mov_b32 v233, v236
    v_mul_f32 v148, v237, v148
    v_mul_f32 v149, v237, v149
    v_mul_f32 v150, v237, v150
    v_mul_f32 v151, v237, v151
    v_mul_f32 v152, v237, v152
    v_mul_f32 v153, v237, v153
    v_mul_f32 v154, v237, v154
    v_mul_f32 v155, v237, v155
    v_sub_f32 v196, v196, v233
    v_sub_f32 v197, v197, v233
    v_sub_f32 v198, v198, v233
    v_sub_f32 v199, v199, v233
    v_sub_f32 v200, v200, v233
    v_sub_f32 v201, v201, v233
    v_sub_f32 v202, v202, v233
    v_exp_f32 v196, v196
    v_exp_f32 v197, v197
    v_exp_f32 v198, v198
    v_cvt_pk_bf16_f32 v212, v196, v197
    v_exp_f32 v199, v199
    v_exp_f32 v200, v200
    v_cvt_pk_bf16_f32 v213, v198, v199
    v_mfma_f32_16x16x32_bf16 v[196:199], v[180:183], v[136:139], v[108:111]
    v_exp_f32 v201, v201
    v_exp_f32 v202, v202
    v_cvt_pk_bf16_f32 v214, v200, v201
    v_cvt_pk_bf16_f32 v215, v202, 0
    s_waitcnt lgkmcnt(0)
    v_mfma_f32_16x16x32_bf16 v[200:203], v[184:187], v[136:139], v[112:115]
    v_mfma_f32_16x16x32_bf16 v[148:151], v[188:191], v[212:215], v[148:151]
    v_mfma_f32_16x16x32_bf16 v[152:155], v[192:195], v[212:215], v[152:155]
    s_nop 7
    v_permlane32_swap_b32 v152, v154
    v_permlane32_swap_b32 v153, v155
    v_rcp_f32 v154, v154
    s_nop 0
    v_mul_f32 v148, v154, v148
    v_mul_f32 v149, v154, v149
    v_cvt_pk_bf16_f32 v148, v148, v149
    v_mul_f32 v150, v154, v150
    v_mul_f32 v151, v154, v151
    v_cvt_pk_bf16_f32 v149, v150, v151
    v_mul_f32 v152, v154, v152
    v_mul_f32 v153, v154, v153
    v_cvt_pk_bf16_f32 v150, v152, v153
    ds_write_b64 v99, v[148:149] offset:36864
    ds_write_b32 v107, v150 offset:38912
    s_waitcnt lgkmcnt(0)
    s_barrier
    v_mfma_f32_16x16x32_bf16 v[204:207], v[172:175], v[136:139], v[100:103]
    ds_read_b128 v[220:223], v10 offset:36864
    ds_read_b128 v[224:227], v10 offset:37888
    v_mfma_f32_16x16x32_bf16 v[208:211], v[176:179], v[136:139], v[104:107]
    ds_read_b128 v[228:231], v10 offset:38912
    s_nop 3
    v_max3_f32 v236, v204, v205, v206
    s_nop 1
    v_max3_f32 v236, v236, v207, v208
    v_max3_f32 v236, v236, v209, v210
    v_mov_b32 v237, v236
    s_nop 1
    v_permlane32_swap_b32 v236, v237
    v_max_f32 v236, v236, v237
    v_mov_b32 v237, v236
    s_nop 1
    v_permlane16_swap_b32 v236, v237
    v_max3_f32 v236, v236, v237, v234
    v_sub_f32 v237, v234, v236
    v_exp_f32 v237, v237
    v_mov_b32 v234, v236
    v_mul_f32 v156, v237, v156
    v_mul_f32 v157, v237, v157
    v_mul_f32 v158, v237, v158
    v_mul_f32 v159, v237, v159
    s_waitcnt lgkmcnt(2)
    v_mfma_f32_16x16x32_bf16 v[252:255], v[72:75], v[220:223], 0
    v_mul_f32 v160, v237, v160
    s_waitcnt lgkmcnt(1)
    v_mfma_f32_16x16x32_bf16 v[252:255], v[76:79], v[224:227], v[252:255]
    v_mul_f32 v161, v237, v161
    v_mul_f32 v162, v237, v162
    v_mul_f32 v163, v237, v163
    s_waitcnt lgkmcnt(0)
    v_mfma_f32_16x16x32_bf16 v[252:255], v[80:83], v[228:231], v[252:255]
    v_sub_f32 v204, v204, v234
    v_sub_f32 v205, v205, v234
    v_sub_f32 v206, v206, v234
    v_sub_f32 v207, v207, v234
    v_sub_f32 v208, v208, v234
    v_sub_f32 v209, v209, v234
    v_sub_f32 v210, v210, v234
    v_exp_f32 v204, v204
    v_exp_f32 v205, v205
    v_exp_f32 v206, v206
    v_cvt_pk_bf16_f32 v216, v204, v205
    v_exp_f32 v207, v207
    v_exp_f32 v208, v208
    v_cvt_pk_bf16_f32 v217, v206, v207
    v_exp_f32 v209, v209
    v_exp_f32 v210, v210
    v_cvt_pk_bf16_f32 v218, v208, v209
    v_cvt_pk_bf16_f32 v219, v210, 0
    v_cvt_pk_bf16_f32 v252, v252, v253
    v_cvt_pk_bf16_f32 v253, v254, v255
    v_mfma_f32_16x16x32_bf16 v[156:159], v[188:191], v[216:219], v[156:159]
    buffer_store_dwordx2 v[252:253], v11, s[28:31], s59 offen offset:64
    v_mfma_f32_16x16x32_bf16 v[160:163], v[192:195], v[216:219], v[160:163]
    v_max3_f32 v236, v196, v197, v198
    v_max3_f32 v236, v236, v199, v200
    v_max3_f32 v236, v236, v201, v202
    v_mov_b32 v237, v236
    ds_read_b64_tr_b16 v[188:189], v5 offset:37840
    ds_read_b64_tr_b16 v[190:191], v6 offset:37840
    ds_read_b64_tr_b16 v[192:193], v7 offset:33040
    ds_read_b64_tr_b16 v[194:195], v8 offset:33040
    v_permlane32_swap_b32 v236, v237
    v_max_f32 v236, v236, v237
    v_mov_b32 v237, v236
    s_nop 1
    v_permlane16_swap_b32 v236, v237
    v_max3_f32 v236, v236, v237, v234
    v_sub_f32 v237, v234, v236
    v_exp_f32 v237, v237
    v_mov_b32 v234, v236
    v_mul_f32 v156, v237, v156
    v_mul_f32 v157, v237, v157
    v_mul_f32 v158, v237, v158
    v_mul_f32 v159, v237, v159
    v_mul_f32 v160, v237, v160
    v_mul_f32 v161, v237, v161
    v_mul_f32 v162, v237, v162
    v_mul_f32 v163, v237, v163
    v_sub_f32 v196, v196, v234
    v_sub_f32 v197, v197, v234
    v_sub_f32 v198, v198, v234
    v_sub_f32 v199, v199, v234
    v_sub_f32 v200, v200, v234
    v_sub_f32 v201, v201, v234
    v_sub_f32 v202, v202, v234
    v_exp_f32 v196, v196
    v_exp_f32 v197, v197
    v_exp_f32 v198, v198
    v_cvt_pk_bf16_f32 v212, v196, v197
    v_exp_f32 v199, v199
    v_exp_f32 v200, v200
    v_cvt_pk_bf16_f32 v213, v198, v199
    v_exp_f32 v201, v201
    v_exp_f32 v202, v202
    v_cvt_pk_bf16_f32 v214, v200, v201
    v_cvt_pk_bf16_f32 v215, v202, 0
    s_waitcnt lgkmcnt(0)
    s_nop 0
    v_mfma_f32_16x16x32_bf16 v[156:159], v[188:191], v[212:215], v[156:159]
    v_mfma_f32_16x16x32_bf16 v[160:163], v[192:195], v[212:215], v[160:163]
    s_nop 7
    v_permlane32_swap_b32 v160, v162
    v_permlane32_swap_b32 v161, v163
    v_rcp_f32 v162, v162
    s_nop 0
    v_mul_f32 v156, v162, v156
    v_mul_f32 v157, v162, v157
    v_cvt_pk_bf16_f32 v156, v156, v157
    v_mul_f32 v158, v162, v158
    v_mul_f32 v159, v162, v159
    v_cvt_pk_bf16_f32 v157, v158, v159
    v_mul_f32 v160, v162, v160
    v_mul_f32 v161, v162, v161
    v_cvt_pk_bf16_f32 v158, v160, v161
    ds_write_b64 v99, v[156:157] offset:43008
    ds_write_b32 v107, v158 offset:45056
    s_waitcnt lgkmcnt(0)
    s_barrier
    ds_read_b128 v[220:223], v10 offset:43008
    ds_read_b128 v[224:227], v10 offset:44032
    ds_read_b128 v[228:231], v10 offset:45056
    s_waitcnt lgkmcnt(2)
    v_mfma_f32_16x16x32_bf16 v[244:247], v[48:51], v[220:223], 0
    s_waitcnt lgkmcnt(1)
    v_mfma_f32_16x16x32_bf16 v[244:247], v[52:55], v[224:227], v[244:247]
    s_waitcnt lgkmcnt(0)
    v_mfma_f32_16x16x32_bf16 v[244:247], v[56:59], v[228:231], v[244:247]
    v_mfma_f32_16x16x32_bf16 v[248:251], v[60:63], v[220:223], 0
    v_mfma_f32_16x16x32_bf16 v[248:251], v[64:67], v[224:227], v[248:251]
    v_mfma_f32_16x16x32_bf16 v[248:251], v[68:71], v[228:231], v[248:251]
    s_nop 4
    v_cvt_pk_bf16_f32 v244, v244, v245
    v_cvt_pk_bf16_f32 v245, v246, v247
    s_nop 0
    v_cvt_pk_bf16_f32 v246, v248, v249
    v_cvt_pk_bf16_f32 v247, v250, v251
    buffer_store_dwordx4 v[244:247], v115, s[28:31], s60 offen
    s_branch L_fin
L_s1:
    s_and_b32 s56, s36, 5
    s_lshl_b32 s55, s56, 10
    s_mul_i32 s4, s56, 9216
    s_and_b32 s56, s36, 2
    s_lshl_b32 s57, s56, 3
    v_xor_b32 v12, s57, v139
    s_mul_i32 s57, s56, 96
    s_add_u32 s57, s57, s4
    s_mul_i32 s58, s56, 9216
    s_add_u32 s58, s58, s55
    s_add_u32 m0, s58, 88896
    s_nop 0
    buffer_load_dwordx4 v12, s[20:23], s57 offen offset:192 lds
    s_add_u32 m0, s58, 94976
    s_nop 0
    buffer_load_dwordx4 v12, s[20:23], s57 offen offset:256 lds
    s_add_u32 m0, s58, 101056
    s_nop 0
    buffer_load_dwordx4 v12, s[20:23], s57 offen offset:320 lds
    s_mov_b32 s61, 52224
    s_movk_i32 s62, 6144
    s_mul_i32 s63, s37, 3
    v_lshl_add_u32 v15, v154, 9, s61
    v_and_b32 v17, 12, v152
    v_lshl_add_u32 v15, v17, 4, v15
    v_lshrrev_b32 v161, 3, v152
    v_and_b32 v161, 2, v161
    v_lshrrev_b32 v16, 1, v156
    v_and_b32 v162, v16, v156
    v_add3_u32 v17, s63, v156, 12
    v_mad_u32_u24 v17, v162, 11, v17
    v_lshrrev_b32 v18, 2, v17
    v_mad_u32_u24 v132, v18, s62, v15
    v_xor_b32 v17, v17, v161
    v_xor_b32 v17, v17, v162
    v_and_b32 v17, 3, v17
    v_lshl_add_u32 v132, v17, 4, v132
    v_lshl_add_u32 v132, v16, 3, v132
    v_xor_b32 v133, 8, v132
    v_add3_u32 v20, s63, v16, 24
    v_lshrrev_b32 v21, 2, v20
    s_mul_i32 s49, s37, 7936
    s_add_u32 s49, s49, 95296
    s_mul_i32 s56, s45, 86016
    s_sub_u32 s48, s48, s56
    s_max_i32 s57, s41, 0
    s_add_u32 s58, s41, 20
    s_min_i32 s58, s58, s44
    s_sub_u32 s57, s57, s58
    s_mul_i32 s57, s57, s43
    s_add_u32 s57, s57, s38
    s_cmp_eq_u32 s37, 3
    s_cselect_b32 s57, s57, 0
    s_movk_i32 s61, -18432
    v_mad_u32_u24 v134, v21, s62, v15
    v_xor_b32 v20, v20, v161
    v_xor_b32 v20, 1, v20
    v_and_b32 v20, 3, v20
    v_lshl_add_u32 v134, v20, 4, v134
    v_and_b32 v19, 1, v156
    v_lshl_add_u32 v134, v19, 3, v134
    v_lshrrev_b32 v22, 1, v153
    v_and_b32 v22, 2, v22
    v_xor_b32 v22, v22, v154
    v_mul_u32_u24 v23, 192, v153
    v_lshl_add_u32 v0, v22, 4, v23
    v_mul_u32_u24 v163, 1280, v154
    v_add_u32 v163, s49, v163
    v_lshl_add_u32 v1, v153, 4, v163
    v_mul_u32_u24 v23, 704, v154
    v_lshl_add_u32 v22, v153, 3, s49
    v_add_u32 v2, v22, v23
    v_cmp_lt_u32 vcc, 59, v152
    v_mov_b32 v24, s57
    v_add_u32 v159, 4, v152
    v_cndmask_b32 v24, 0, v24, vcc
    v_add3_u32 v136, v136, v24, s56
    s_lshr_b32 s56, s36, 2
    s_mul_i32 s56, s56, 7
    s_add_u32 s56, s56, s41
    v_bfe_u32 v157, v159, 3, 1
    s_lshl_b32 s5, s36, 10
    s_add_u32 s5, s5, 56320
    s_add_u32 s59, s5, 192
    v_and_b32 v159, 7, v159
    v_min_u32 v158, 6, v159
    v_lshrrev_b32 v160, 1, v154
    v_and_b32 v160, v160, v154
    v_add_u32 v36, s56, v158
    v_max_i32 v36, 0, v36
    v_min_i32 v36, 105, v36
    v_subrev_u32 v33, s56, v36
    v_sub_u32 v36, v159, v158
    v_lshl_add_u32 v33, v36, 6, v33
    v_lshlrev_b32 v36, 6, v157
    v_sub_u32 v34, s59, v36
    v_sub_u32 v35, 3, v158
    v_mov_b32 v91, 0xff800000
    v_mov_b32 v37, 0x6408640c
    v_sub_u32 v38, v154, v160
    v_lshl_add_u32 v39, v160, 6, v34
    v_lshlrev_b32 v25, 2, v154
    v_sub_u32 v40, v25, v33
    v_add_u32 v25, v25, v35
    v_cmp_gt_u32 s[64:65], 7, v40
    v_lshl_add_u32 v26, v38, 2, 1
    v_sub_u32 v41, v26, v33
    v_cndmask_b32 v25, 13, v25, s[64:65]
    v_lshl_add_u32 v25, v25, 2, v34
    v_add_u32 v26, v26, v35
    v_cmp_gt_u32 s[66:67], 7, v41
    v_lshl_add_u32 v27, v38, 2, 2
    v_sub_u32 v42, v27, v33
    v_cndmask_b32 v26, 13, v26, s[66:67]
    v_lshl_add_u32 v26, v26, 2, v39
    v_add_u32 v27, v27, v35
    v_cmp_gt_u32 s[68:69], 7, v42
    v_lshl_add_u32 v28, v38, 2, 3
    v_sub_u32 v43, v28, v33
    v_cndmask_b32 v27, 13, v27, s[68:69]
    v_lshl_add_u32 v27, v27, 2, v39
    v_add_u32 v28, v28, v35
    v_cmp_gt_u32 s[70:71], 7, v43
    v_lshl_add_u32 v29, v154, 1, 0
    v_sub_u32 v44, v29, v33
    v_cndmask_b32 v28, 13, v28, s[70:71]
    v_lshl_add_u32 v28, v28, 2, v39
    v_add_u32 v29, v29, v35
    v_cmp_gt_u32 s[64:65], 7, v44
    v_lshl_add_u32 v30, v154, 1, 1
    v_sub_u32 v45, v30, v33
    v_cndmask_b32 v29, 13, v29, s[64:65]
    v_lshl_add_u32 v29, v29, 2, v34
    v_add_u32 v30, v30, v35
    v_cmp_gt_u32 s[66:67], 7, v45
    v_lshlrev_b32 v46, 3, v154
    v_bfe_u32 v31, v37, v46, 8
    v_cndmask_b32 v30, 13, v30, s[66:67]
    v_lshl_add_u32 v30, v30, 2, v34
    v_sub_u32 v46, v31, v33
    v_add_u32 v31, v31, v35
    v_cmp_gt_u32 s[68:69], 7, v46
    v_mov_b32 v47, 0x01201514
    v_mov_b32 v220, 0x03021716
    v_cndmask_b32 v31, 13, v31, s[68:69]
    v_lshl_add_u32 v31, v31, 2, v34
    v_mov_b32 v221, 0x1d1c1918
    v_mov_b32 v222, 0x1f1e1b1a
    v_add_u32 v223, 3, v153
    v_and_b32 v223, 16, v223
    v_add_u32 v223, v223, v153
    v_and_b32 v225, 7, v153
    v_or_b32 v225, 0x0c0c0c00, v225
    v_cmp_gt_u32 s[70:71], 8, v153
    v_perm_b32 v226, v220, v47, v225
    v_perm_b32 v224, v222, v221, v225
    v_cndmask_b32 v224, v224, v226, s[70:71]
    v_lshl_add_u32 v3, v223, 4, v163
    v_lshl_add_u32 v4, v224, 4, v163
    v_add_u32 v227, 3, v155
    v_and_b32 v227, 16, v227
    v_add_u32 v227, v227, v155
    v_and_b32 v229, 7, v155
    v_or_b32 v229, 0x0c0c0c00, v229
    v_cmp_gt_u32 s[64:65], 8, v155
    v_perm_b32 v230, v220, v47, v229
    v_perm_b32 v228, v222, v221, v229
    v_cndmask_b32 v228, v228, v230, s[64:65]
    v_mul_u32_u24 v233, 704, v156
    v_add_u32 v233, s49, v233
    v_lshl_add_u32 v5, v227, 3, v233
    v_lshl_add_u32 v6, v228, 3, v233
    s_add_u32 s56, s49, 3952
    v_lshl_add_u32 v231, v156, 3, s56
    v_cmp_gt_u32 s[66:67], 2, v156
    v_lshl_add_u32 v7, v227, 4, v231
    v_lshl_add_u32 v8, v228, 4, v231
    v_mov_b32 v232, 127040
    v_cndmask_b32 v7, v232, v7, s[66:67]
    v_cndmask_b32 v8, v232, v8, s[66:67]
    v_mov_b32 v9, 0
    v_mad_i32_i24 v135, v162, s61, v132
    v_xor_b32 v137, 8, v135
    v_mad_u32_u24 v234, v157, 20, v158
    v_add_u32 v234, 70, v234
    v_lshrrev_b32 v235, 1, v234
    v_and_b32 v235, 2, v235
    v_xor_b32 v235, v235, v154
    v_mul_u32_u24 v236, 192, v234
    v_lshl_add_u32 v11, v235, 4, v236
    v_sub_u32 v10, v159, v158
    v_or_b32 v10, v10, v160
    v_add_u32 v10, -1, v10
    v_and_b32 v10, 0x3e96c740, v10
    v_lshl_add_u32 v32, v152, 2, s5
    v_cmp_gt_u32 vcc, 13, v153
    s_waitcnt vmcnt(8)
    v_lshlrev_b32 v208, 16, v208
    v_mul_f32 v208, 0x3fb8aa3b, v208
    v_cndmask_b32 v208, v91, v208, vcc
    s_waitcnt vmcnt(7)
    v_lshlrev_b32 v209, 16, v209
    v_mul_f32 v209, 0x3fb8aa3b, v209
    v_cndmask_b32 v209, v91, v209, vcc
    s_waitcnt vmcnt(6)
    v_lshlrev_b32 v210, 16, v210
    v_mul_f32 v210, 0x3fb8aa3b, v210
    v_cndmask_b32 v210, v91, v210, vcc
    s_waitcnt vmcnt(5)
    v_lshlrev_b32 v211, 16, v211
    v_mul_f32 v211, 0x3fb8aa3b, v211
    v_cndmask_b32 v211, v91, v211, vcc
    ds_write_b32 v232, v9 offset:33056
    ds_write_b32 v32, v208
    ds_write_b32 v32, v209 offset:256
    ds_write_b32 v32, v210 offset:512
    ds_write_b32 v32, v211 offset:768
    ds_read_b32 v164, v25 offset:512
    ds_read_b32 v165, v26 offset:512
    ds_read_b32 v166, v27 offset:512
    ds_read_b32 v167, v28 offset:512
    ds_read_b32 v168, v29 offset:576
    ds_read_b32 v169, v30 offset:576
    ds_read_b32 v170, v31 offset:576
    ds_read_b32 v84, v25
    ds_read_b32 v85, v26
    ds_read_b32 v86, v27
    ds_read_b32 v87, v28
    ds_read_b32 v88, v29 offset:64
    ds_read_b32 v89, v30 offset:64
    ds_read_b32 v90, v31 offset:64
    ds_read_b32 v92, v25 offset:128
    ds_read_b32 v93, v26 offset:128
    ds_read_b32 v94, v27 offset:128
    ds_read_b32 v95, v28 offset:128
    ds_read_b32 v96, v29 offset:192
    ds_read_b32 v97, v30 offset:192
    ds_read_b32 v98, v31 offset:192
    ds_read_b32 v100, v25 offset:256
    ds_read_b32 v101, v26 offset:256
    ds_read_b32 v102, v27 offset:256
    ds_read_b32 v103, v28 offset:256
    ds_read_b32 v104, v29 offset:320
    ds_read_b32 v105, v30 offset:320
    ds_read_b32 v106, v31 offset:320
    ds_read_b32 v108, v25 offset:384
    ds_read_b32 v109, v26 offset:384
    ds_read_b32 v110, v27 offset:384
    ds_read_b32 v111, v28 offset:384
    ds_read_b32 v112, v29 offset:448
    ds_read_b32 v113, v30 offset:448
    ds_read_b32 v114, v31 offset:448
    s_add_u32 s48, s48, s39
    s_add_u32 m0, s42, 15360
    s_nop 0
    buffer_load_dwordx4 v136, s[16:19], s48 offen lds
    s_add_u32 s48, s48, s39
    s_add_u32 m0, s42, 23040
    s_nop 0
    buffer_load_dwordx4 v136, s[16:19], s48 offen lds
    s_waitcnt vmcnt(2) lgkmcnt(5)
    s_barrier
    s_add_u32 m0, s55, 82816
    s_and_b32 s56, s36, 2
    buffer_load_dwordx4 v139, s[20:23], s4 offen offset:128 lds
    s_lshl_b32 s57, s56, 5
    v_cmp_gt_u32 vcc, 7, v159
    s_add_u32 s4, s4, s57
    s_mul_i32 s56, s56, 3072
    ds_read_b128 v[220:223], v0 offset:3072
    s_add_u32 s55, s55, s56
    s_add_u32 m0, s55, 70656
    s_mov_b32 s64, 0x0ff00ff0
    ds_read_b128 v[224:227], v0 offset:3136
    buffer_load_dwordx4 v139, s[20:23], s4 offen lds
    ds_read_b128 v[228:231], v0 offset:3200
    ds_read_b64_tr_b16 v[12:13], v132 offset:18432
    s_mov_b32 s65, 0x0ff00ff0
    ds_read_b64_tr_b16 v[14:15], v132 offset:18688
    v_cndmask_b32 v84, v84, v91, s[64:65]
    s_mov_b32 s66, 0x0ff00ff0
    s_mov_b32 s67, 0x00000ff0
    ds_read_b64_tr_b16 v[16:17], v132 offset:20480
    v_cndmask_b32 v85, v85, v91, s[66:67]
    v_cndmask_b32 v86, v86, v91, s[66:67]
    v_cndmask_b32 v87, v87, v91, s[66:67]
    s_cmp_eq_u32 s46, 0
    s_cselect_b64 s[64:65], -1, 0
    ds_read_b64_tr_b16 v[18:19], v132 offset:20736
    s_mov_b32 s66, s64
    s_and_b32 s67, s64, 0xffff
    v_cndmask_b32 v164, v84, v164, s[64:65]
    v_cndmask_b32 v165, v85, v165, s[64:65]
    s_mov_b32 s68, 0x00000000
    s_mov_b32 s69, 0xf00f0000
    v_cndmask_b32 v166, v86, v166, s[64:65]
    v_cndmask_b32 v167, v87, v167, s[64:65]
    s_mov_b32 s70, 0xf00ff00f
    s_mov_b32 s71, 0xf00ff00f
    v_cndmask_b32 v168, v88, v168, s[64:65]
    v_cndmask_b32 v169, v89, v169, s[64:65]
    s_mul_i32 s54, s45, 1032192
    v_cndmask_b32 v170, v90, v170, s[64:65]
    v_cndmask_b32 v76, v92, v91, s[64:65]
    v_cndmask_b32 v77, v93, v91, s[66:67]
    ds_read_b64_tr_b16 v[20:21], v132 offset:22528
    ds_read_b64_tr_b16 v[22:23], v132 offset:22784
    ds_read_b64_tr_b16 v[24:25], v133 offset:18432
    ds_read_b64_tr_b16 v[26:27], v133 offset:18688
    v_cndmask_b32 v78, v94, v91, s[66:67]
    v_cndmask_b32 v79, v95, v91, s[66:67]
    v_cndmask_b32 v80, v84, v91, s[64:65]
    v_cndmask_b32 v81, v85, v91, s[66:67]
    v_cndmask_b32 v82, v86, v91, s[66:67]
    v_cndmask_b32 v83, v87, v91, s[66:67]
    s_andn2_b64 s[66:67], s[68:69], s[64:65]
    s_andn2_b64 s[64:65], s[70:71], s[64:65]
    s_waitcnt lgkmcnt(6)
    v_mfma_f32_16x16x32_bf16 v[244:247], v[12:15], v[220:223], 0
    ds_read_b64_tr_b16 v[28:29], v133 offset:20480
    ds_read_b64_tr_b16 v[30:31], v133 offset:20736
    ds_read_b64_tr_b16 v[32:33], v133 offset:22528
    s_waitcnt lgkmcnt(7)
    v_mfma_f32_16x16x32_bf16 v[244:247], v[16:19], v[224:227], v[244:247]
    ds_read_b64_tr_b16 v[34:35], v133 offset:22784
    ds_read_b64_tr_b16 v[36:37], v134 offset:18432
    ds_read_b64_tr_b16 v[38:39], v134 offset:18688
    ds_read_b64_tr_b16 v[40:41], v134 offset:20480
    ds_read_b64_tr_b16 v[42:43], v134 offset:20736
    ds_read_b64_tr_b16 v[44:45], v134 offset:22528
    ds_read_b64_tr_b16 v[46:47], v134 offset:22784
    s_lshr_b32 s56, s37, 1
    s_and_b32 s50, s37, 1
    s_waitcnt lgkmcnt(12)
    v_mfma_f32_16x16x32_bf16 v[244:247], v[20:23], v[228:231], v[244:247]
    s_lshl_b32 s59, s56, 10
    s_waitcnt lgkmcnt(10)
    v_mfma_f32_16x16x32_bf16 v[248:251], v[24:27], v[220:223], 0
    s_lshl3_add_u32 s59, s50, s59
    v_cndmask_b32 v109, v109, v91, s[66:67]
    s_mul_i32 s51, s56, 3072
    s_mul_i32 s56, s56, 7
    v_cndmask_b32 v110, v110, v91, s[66:67]
    v_cndmask_b32 v111, v111, v91, s[66:67]
    s_waitcnt lgkmcnt(8)
    v_mfma_f32_16x16x32_bf16 v[248:251], v[28:31], v[224:227], v[248:251]
    v_cndmask_b32 v112, v112, v91, s[64:65]
    s_waitcnt lgkmcnt(6)
    v_mfma_f32_16x16x32_bf16 v[248:251], v[32:35], v[228:231], v[248:251]
    s_waitcnt lgkmcnt(4)
    v_mfma_f32_16x16x32_bf16 v[252:255], v[36:39], v[220:223], 0
    ds_read_b128 v[220:223], v0 offset:9216
    s_waitcnt lgkmcnt(3)
    v_mfma_f32_16x16x32_bf16 v[252:255], v[40:43], v[224:227], v[252:255]
    ds_read_b128 v[224:227], v0 offset:9280
    s_waitcnt lgkmcnt(2)
    v_mfma_f32_16x16x32_bf16 v[252:255], v[44:47], v[228:231], v[252:255]
    ds_read_b128 v[228:231], v0 offset:9344
    v_cndmask_b32 v113, v113, v91, s[64:65]
    v_cndmask_b32 v114, v114, v91, s[64:65]
    v_lshl_add_u32 v99, v152, 4, s59
    v_bfe_u32 v50, v152, 3, 1
    s_lshl_b32 s59, s37, 2
    s_sub_u32 s51, s51, s59
    v_lshl_add_u32 v107, v152, 4, s59
    v_mul_u32_u24 v50, 24, v50
    v_bfe_u32 v51, v152, 2, 1
    s_add_u32 s56, s56, s41
    s_add_u32 s56, s56, 3
    s_mul_i32 s59, s50, 128
    s_add_u32 s59, s59, s47
    v_add_u32 v48, s56, v158
    v_lshl_add_u32 v49, v154, 4, s59
    v_mad_u32_u24 v48, v48, s43, v49
    s_mul_i32 s59, s45, 12
    s_add_u32 s59, s59, s40
    s_add_u32 s59, s59, 3
    s_and_b32 s52, s37, 1
    s_mul_i32 s53, s52, 9216
    v_add_u32 v49, s59, v157
    v_mad_i32_i24 v48, v49, s38, v48
    v_mov_b32 v49, 0x80000000
    s_mul_i32 s52, s52, 3072
    s_add_u32 s48, s48, s39
    v_cndmask_b32 v115, v49, v48, vcc
    v_add3_u32 v50, v50, v51, 20
    s_add_u32 m0, s42, 30720
    v_mad_i32_i24 v50, v161, -2, v50
    v_and_b32 v51, 2, v154
    v_add_u32 v50, v51, v50
    v_mul_u32_u24 v50, 192, v50
    v_lshl_add_u32 v138, v156, 4, v50
    v_cvt_pk_bf16_f32 v244, v244, v245
    v_cvt_pk_bf16_f32 v245, v246, v247
    v_cvt_pk_bf16_f32 v246, v248, v249
    v_cvt_pk_bf16_f32 v247, v250, v251
    s_waitcnt lgkmcnt(0)
    ds_write_b128 v1, v[244:247] offset:32656
    v_mfma_f32_16x16x32_bf16 v[244:247], v[12:15], v[220:223], 0
    v_cvt_pk_bf16_f32 v252, v252, v253
    v_cvt_pk_bf16_f32 v253, v254, v255
    ds_write_b64 v2, v[252:253] offset:37648
    buffer_load_dwordx4 v136, s[16:19], s48 offen lds
    s_add_u32 s48, s48, s39
    s_add_u32 m0, s42, 38400
    v_mfma_f32_16x16x32_bf16 v[244:247], v[16:19], v[224:227], v[244:247]
    buffer_load_dwordx4 v136, s[16:19], s48 offen lds
    v_mfma_f32_16x16x32_bf16 v[244:247], v[20:23], v[228:231], v[244:247]
    s_add_u32 s48, s48, s39
    s_add_u32 m0, s42, 46080
    v_mfma_f32_16x16x32_bf16 v[248:251], v[24:27], v[220:223], 0
    buffer_load_dwordx4 v136, s[16:19], s48 offen lds
    v_mfma_f32_16x16x32_bf16 v[248:251], v[28:31], v[224:227], v[248:251]
    s_add_u32 s48, s48, s39
    s_add_u32 m0, s42, 53760
    v_mfma_f32_16x16x32_bf16 v[248:251], v[32:35], v[228:231], v[248:251]
    v_cvt_pk_bf16_f32 v244, v244, v245
    v_cvt_pk_bf16_f32 v245, v246, v247
    v_mfma_f32_16x16x32_bf16 v[252:255], v[36:39], v[220:223], 0
    ds_read_b128 v[220:223], v0 offset:12288
    v_mfma_f32_16x16x32_bf16 v[252:255], v[40:43], v[224:227], v[252:255]
    ds_read_b128 v[224:227], v0 offset:12352
    v_mfma_f32_16x16x32_bf16 v[252:255], v[44:47], v[228:231], v[252:255]
    ds_read_b128 v[228:231], v0 offset:12416
    v_cvt_pk_bf16_f32 v246, v248, v249
    v_cvt_pk_bf16_f32 v247, v250, v251
    ds_write_b128 v1, v[244:247] offset:33168
    s_nop 3
    v_cvt_pk_bf16_f32 v252, v252, v253
    v_cvt_pk_bf16_f32 v253, v254, v255
    ds_write_b64 v2, v[252:253] offset:37904
    s_waitcnt lgkmcnt(4)
    v_mfma_f32_16x16x32_bf16 v[244:247], v[12:15], v[220:223], 0
    s_waitcnt lgkmcnt(3)
    v_mfma_f32_16x16x32_bf16 v[244:247], v[16:19], v[224:227], v[244:247]
    s_waitcnt lgkmcnt(2)
    v_mfma_f32_16x16x32_bf16 v[244:247], v[20:23], v[228:231], v[244:247]
    v_mfma_f32_16x16x32_bf16 v[248:251], v[24:27], v[220:223], 0
    v_mfma_f32_16x16x32_bf16 v[248:251], v[28:31], v[224:227], v[248:251]
    v_mfma_f32_16x16x32_bf16 v[248:251], v[32:35], v[228:231], v[248:251]
    v_mfma_f32_16x16x32_bf16 v[252:255], v[36:39], v[220:223], 0
    v_mfma_f32_16x16x32_bf16 v[252:255], v[40:43], v[224:227], v[252:255]
    v_mfma_f32_16x16x32_bf16 v[252:255], v[44:47], v[228:231], v[252:255]
    s_nop 1
    v_cvt_pk_bf16_f32 v244, v244, v245
    v_cvt_pk_bf16_f32 v245, v246, v247
    s_nop 0
    v_cvt_pk_bf16_f32 v246, v248, v249
    v_cvt_pk_bf16_f32 v247, v250, v251
    ds_write_b128 v1, v[244:247] offset:33424
    v_cvt_pk_bf16_f32 v252, v252, v253
    v_cvt_pk_bf16_f32 v253, v254, v255
    ds_write_b64 v2, v[252:253] offset:38032
    s_waitcnt vmcnt(3) lgkmcnt(0)
    s_barrier
    buffer_load_dwordx4 v136, s[16:19], s48 offen lds
    s_add_u32 s48, s48, s39
    s_add_u32 m0, s42, 61440
    ds_read_b128 v[220:223], v0 offset:18432
    buffer_load_dwordx4 v136, s[16:19], s48 offen lds
    s_add_u32 m0, s52, 89152
    ds_read_b128 v[224:227], v0 offset:18496
    ds_read_b128 v[228:231], v0 offset:18560
    ds_read_b64_tr_b16 v[48:49], v135
    ds_read_b64_tr_b16 v[50:51], v135 offset:256
    ds_read_b64_tr_b16 v[52:53], v135 offset:2048
    ds_read_b64_tr_b16 v[54:55], v135 offset:2304
    ds_read_b64_tr_b16 v[56:57], v135 offset:4096
    ds_read_b64_tr_b16 v[58:59], v135 offset:4352
    ds_read_b64_tr_b16 v[60:61], v137
    ds_read_b64_tr_b16 v[62:63], v137 offset:256
    ds_read_b64_tr_b16 v[64:65], v137 offset:2048
    s_waitcnt lgkmcnt(11)
    ds_read_b64_tr_b16 v[66:67], v137 offset:2304
    ds_read_b64_tr_b16 v[68:69], v137 offset:4096
    ds_read_b64_tr_b16 v[70:71], v137 offset:4352
    v_mfma_f32_16x16x32_bf16 v[244:247], v[12:15], v[220:223], 0
    s_waitcnt lgkmcnt(11)
    v_mfma_f32_16x16x32_bf16 v[244:247], v[16:19], v[224:227], v[244:247]
    v_mfma_f32_16x16x32_bf16 v[244:247], v[20:23], v[228:231], v[244:247]
    v_mfma_f32_16x16x32_bf16 v[248:251], v[24:27], v[220:223], 0
    v_mfma_f32_16x16x32_bf16 v[248:251], v[28:31], v[224:227], v[248:251]
    v_mfma_f32_16x16x32_bf16 v[248:251], v[32:35], v[228:231], v[248:251]
    ds_read_b128 v[172:175], v3 offset:32512
    v_mfma_f32_16x16x32_bf16 v[252:255], v[36:39], v[220:223], 0
    v_mfma_f32_16x16x32_bf16 v[252:255], v[40:43], v[224:227], v[252:255]
    v_mfma_f32_16x16x32_bf16 v[252:255], v[44:47], v[228:231], v[252:255]
    ds_read_b128 v[176:179], v4 offset:32512
    v_cvt_pk_bf16_f32 v244, v244, v245
    v_cvt_pk_bf16_f32 v245, v246, v247
    ds_read_b128 v[220:223], v11
    ds_read_b128 v[224:227], v11 offset:64
    v_cvt_pk_bf16_f32 v246, v248, v249
    v_cvt_pk_bf16_f32 v247, v250, v251
    ds_write_b128 v1, v[244:247] offset:256
    ds_read_b128 v[228:231], v11 offset:128
    v_cvt_pk_bf16_f32 v252, v252, v253
    v_cvt_pk_bf16_f32 v253, v254, v255
    ds_write_b64 v2, v[252:253] offset:5248
    ds_read_b64_tr_b16 v[188:189], v5 offset:37576
    ds_read_b64_tr_b16 v[190:191], v6 offset:37576
    ds_read_b64_tr_b16 v[192:193], v7 offset:32400
    ds_read_b64_tr_b16 v[194:195], v8 offset:32400
    s_waitcnt lgkmcnt(8)
    ds_read_b128 v[180:183], v3 offset:33152
    v_mfma_f32_16x16x32_bf16 v[244:247], v[48:51], v[220:223], 0
    ds_read_b128 v[184:187], v4 offset:33152
    s_waitcnt lgkmcnt(9)
    v_mfma_f32_16x16x32_bf16 v[244:247], v[52:55], v[224:227], v[244:247]
    s_waitcnt lgkmcnt(7)
    v_mfma_f32_16x16x32_bf16 v[244:247], v[56:59], v[228:231], v[244:247]
    v_mfma_f32_16x16x32_bf16 v[248:251], v[60:63], v[220:223], 0
    ds_read_b128 v[220:223], v11 offset:7680
    v_mfma_f32_16x16x32_bf16 v[248:251], v[64:67], v[224:227], v[248:251]
    ds_read_b128 v[224:227], v11 offset:7744
    v_mfma_f32_16x16x32_bf16 v[248:251], v[68:71], v[228:231], v[248:251]
    ds_read_b128 v[228:231], v11 offset:7808
    s_nop 1
    v_mul_f32 v244, v10, v244
    v_mul_f32 v245, v10, v245
    v_cvt_pk_bf16_f32 v72, v244, v245
    v_mul_f32 v246, v10, v246
    v_mul_f32 v247, v10, v247
    v_cvt_pk_bf16_f32 v73, v246, v247
    s_waitcnt lgkmcnt(0)
    v_mfma_f32_16x16x32_bf16 v[244:247], v[48:51], v[220:223], 0
    v_mfma_f32_16x16x32_bf16 v[244:247], v[52:55], v[224:227], v[244:247]
    v_mfma_f32_16x16x32_bf16 v[244:247], v[56:59], v[228:231], v[244:247]
    v_mul_f32 v248, v10, v248
    v_mul_f32 v249, v10, v249
    v_cvt_pk_bf16_f32 v74, v248, v249
    v_mul_f32 v250, v10, v250
    v_mul_f32 v251, v10, v251
    v_cvt_pk_bf16_f32 v75, v250, v251
    v_mfma_f32_16x16x32_bf16 v[248:251], v[60:63], v[220:223], 0
    ds_read_b128 v[220:223], v0 offset:24576
    v_mul_f32 v244, v10, v244
    v_mfma_f32_16x16x32_bf16 v[248:251], v[64:67], v[224:227], v[248:251]
    v_mul_f32 v245, v10, v245
    v_cvt_pk_bf16_f32 v116, v244, v245
    v_mfma_f32_16x16x32_bf16 v[248:251], v[68:71], v[228:231], v[248:251]
    v_mul_f32 v246, v10, v246
    v_mul_f32 v247, v10, v247
    v_mfma_f32_16x16x32_bf16 v[204:207], v[172:175], v[72:75], v[164:167]
    v_cvt_pk_bf16_f32 v117, v246, v247
    v_mfma_f32_16x16x32_bf16 v[208:211], v[176:179], v[72:75], v[168:171]
    ds_read_b128 v[224:227], v0 offset:24640
    ds_read_b128 v[228:231], v0 offset:24704
    v_mfma_f32_16x16x32_bf16 v[196:199], v[180:183], v[72:75], v[76:79]
    v_mul_f32 v248, v10, v248
    v_mul_f32 v249, v10, v249
    v_cvt_pk_bf16_f32 v118, v248, v249
    v_mul_f32 v250, v10, v250
    v_mul_f32 v251, v10, v251
    v_cvt_pk_bf16_f32 v119, v250, v251
    v_max3_f32 v236, v204, v205, v206
    v_max3_f32 v236, v236, v207, v208
    v_mfma_f32_16x16x32_bf16 v[200:203], v[184:187], v[72:75], v[96:99]
    v_max3_f32 v236, v236, v209, v210
    s_waitcnt lgkmcnt(2)
    v_mfma_f32_16x16x32_bf16 v[244:247], v[12:15], v[220:223], 0
    v_mfma_f32_16x16x32_bf16 v[248:251], v[24:27], v[220:223], 0
    v_mfma_f32_16x16x32_bf16 v[252:255], v[36:39], v[220:223], 0
    s_waitcnt lgkmcnt(1)
    v_mfma_f32_16x16x32_bf16 v[244:247], v[16:19], v[224:227], v[244:247]
    v_mov_b32 v237, v236
    v_add_u32 v0, 30720, v0
    s_waitcnt lgkmcnt(0)
    v_permlane32_swap_b32 v236, v237
    v_mfma_f32_16x16x32_bf16 v[244:247], v[20:23], v[228:231], v[244:247]
    v_max_f32 v236, v236, v237
    v_mov_b32 v237, v236
    v_mfma_f32_16x16x32_bf16 v[248:251], v[28:31], v[224:227], v[248:251]
    v_mfma_f32_16x16x32_bf16 v[248:251], v[32:35], v[228:231], v[248:251]
    v_permlane16_swap_b32 v236, v237
    v_mfma_f32_16x16x32_bf16 v[252:255], v[40:43], v[224:227], v[252:255]
    v_max_f32 v232, v236, v237
    v_sub_f32 v204, v204, v232
    v_mfma_f32_16x16x32_bf16 v[252:255], v[44:47], v[228:231], v[252:255]
    v_sub_f32 v205, v205, v232
    v_sub_f32 v206, v206, v232
    v_sub_f32 v207, v207, v232
    v_sub_f32 v208, v208, v232
    v_sub_f32 v209, v209, v232
    v_sub_f32 v210, v210, v232
    v_exp_f32 v204, v204
    v_exp_f32 v205, v205
    v_exp_f32 v206, v206
    v_cvt_pk_bf16_f32 v216, v204, v205
    v_exp_f32 v207, v207
    v_exp_f32 v208, v208
    v_cvt_pk_bf16_f32 v217, v206, v207
    v_exp_f32 v209, v209
    v_exp_f32 v210, v210
    v_cvt_pk_bf16_f32 v218, v208, v209
    v_cvt_pk_bf16_f32 v219, v210, 0
    v_cvt_pk_bf16_f32 v244, v244, v245
    v_cvt_pk_bf16_f32 v245, v246, v247
    v_mfma_f32_16x16x32_bf16 v[140:143], v[188:191], v[216:219], 0
    v_cvt_pk_bf16_f32 v246, v248, v249
    v_cvt_pk_bf16_f32 v247, v250, v251
    v_mfma_f32_16x16x32_bf16 v[144:147], v[192:195], v[216:219], 0
    v_cvt_pk_bf16_f32 v252, v252, v253
    v_cvt_pk_bf16_f32 v253, v254, v255
    v_max3_f32 v236, v196, v197, v198
    v_max3_f32 v236, v236, v199, v200
    v_max3_f32 v236, v236, v201, v202
    v_mov_b32 v237, v236
    ds_read_b64_tr_b16 v[188:189], v5 offset:37896
    ds_read_b64_tr_b16 v[190:191], v6 offset:37896
    ds_read_b64_tr_b16 v[192:193], v7 offset:33040
    ds_read_b64_tr_b16 v[194:195], v8 offset:33040
    ds_write_b128 v1, v[244:247] offset:768
    ds_write_b64 v2, v[252:253] offset:5504
    v_permlane32_swap_b32 v236, v237
    v_max_f32 v236, v236, v237
    v_mov_b32 v237, v236
    s_nop 1
    v_permlane16_swap_b32 v236, v237
    v_max3_f32 v236, v236, v237, v232
    v_sub_f32 v237, v232, v236
    v_exp_f32 v237, v237
    v_mov_b32 v232, v236
    v_mul_f32 v140, v237, v140
    v_mul_f32 v141, v237, v141
    v_mul_f32 v142, v237, v142
    v_mul_f32 v143, v237, v143
    v_mul_f32 v144, v237, v144
    v_mul_f32 v145, v237, v145
    v_mul_f32 v146, v237, v146
    v_mul_f32 v147, v237, v147
    v_sub_f32 v196, v196, v232
    v_sub_f32 v197, v197, v232
    v_sub_f32 v198, v198, v232
    v_sub_f32 v199, v199, v232
    v_sub_f32 v200, v200, v232
    v_sub_f32 v201, v201, v232
    v_sub_f32 v202, v202, v232
    v_exp_f32 v196, v196
    v_exp_f32 v197, v197
    v_exp_f32 v198, v198
    v_cvt_pk_bf16_f32 v212, v196, v197
    v_exp_f32 v199, v199
    v_exp_f32 v200, v200
    v_cvt_pk_bf16_f32 v213, v198, v199
    v_exp_f32 v201, v201
    v_exp_f32 v202, v202
    v_cvt_pk_bf16_f32 v214, v200, v201
    s_waitcnt vmcnt(3) lgkmcnt(0)
    s_barrier
    ds_read_b128 v[172:175], v3 offset:112
    ds_read_b128 v[176:179], v4 offset:112
    v_cvt_pk_bf16_f32 v215, v202, 0
    ds_read_b128 v[220:223], v11 offset:15360
    buffer_load_dwordx4 v138, s[32:35], s53 offen lds
    v_mfma_f32_16x16x32_bf16 v[140:143], v[188:191], v[212:215], v[140:143]
    s_add_u32 m0, s52, 90112
    v_mfma_f32_16x16x32_bf16 v[144:147], v[192:195], v[212:215], v[144:147]
    ds_read_b128 v[224:227], v11 offset:15424
    buffer_load_dwordx4 v138, s[32:35], s53 offen offset:64 lds
    v_mfma_f32_16x16x32_bf16 v[204:207], v[180:183], v[116:119], v[80:83]
    ds_read_b128 v[228:231], v11 offset:15488
    ds_read_b128 v[180:183], v3 offset:752
    v_mfma_f32_16x16x32_bf16 v[208:211], v[184:187], v[116:119], v[88:91]
    ds_read_b128 v[184:187], v4 offset:752
    s_waitcnt lgkmcnt(5)
    v_mfma_f32_16x16x32_bf16 v[196:199], v[172:175], v[72:75], v[100:103]
    s_add_u32 m0, s52, 91072
    s_add_u32 s48, s48, s39
    v_mfma_f32_16x16x32_bf16 v[200:203], v[176:179], v[72:75], v[104:107]
    v_max3_f32 v236, v204, v205, v206
    s_nop 0
    v_max3_f32 v236, v236, v207, v208
    v_max3_f32 v236, v236, v209, v210
    v_mov_b32 v237, v236
    s_waitcnt lgkmcnt(4)
    buffer_load_dwordx4 v138, s[32:35], s53 offen offset:128 lds
    s_add_u32 m0, s42, 69120
    v_permlane32_swap_b32 v236, v237
    buffer_load_dwordx4 v136, s[16:19], s48 offen lds
    v_mfma_f32_16x16x32_bf16 v[244:247], v[48:51], v[220:223], 0
    s_waitcnt lgkmcnt(0)
    v_mfma_f32_16x16x32_bf16 v[244:247], v[52:55], v[224:227], v[244:247]
    v_mfma_f32_16x16x32_bf16 v[244:247], v[56:59], v[228:231], v[244:247]
    v_mfma_f32_16x16x32_bf16 v[248:251], v[60:63], v[220:223], 0
    ds_read_b128 v[220:223], v0 offset:3072
    v_mfma_f32_16x16x32_bf16 v[248:251], v[64:67], v[224:227], v[248:251]
    ds_read_b128 v[224:227], v0 offset:3136
    v_mfma_f32_16x16x32_bf16 v[248:251], v[68:71], v[228:231], v[248:251]
    ds_read_b128 v[228:231], v0 offset:3200
    v_max_f32 v236, v236, v237
    s_waitcnt lgkmcnt(2)
    v_mfma_f32_16x16x32_bf16 v[252:255], v[36:39], v[220:223], 0
    v_mul_f32 v244, v10, v244
    s_waitcnt lgkmcnt(1)
    v_mfma_f32_16x16x32_bf16 v[252:255], v[40:43], v[224:227], v[252:255]
    s_waitcnt lgkmcnt(0)
    v_mul_f32 v245, v10, v245
    v_cvt_pk_bf16_f32 v120, v244, v245
    v_mfma_f32_16x16x32_bf16 v[252:255], v[44:47], v[228:231], v[252:255]
    v_mul_f32 v246, v10, v246
    v_mul_f32 v247, v10, v247
    v_cvt_pk_bf16_f32 v121, v246, v247
    v_mfma_f32_16x16x32_bf16 v[244:247], v[12:15], v[220:223], 0
    v_mfma_f32_16x16x32_bf16 v[244:247], v[16:19], v[224:227], v[244:247]
    v_mfma_f32_16x16x32_bf16 v[244:247], v[20:23], v[228:231], v[244:247]
    v_mul_f32 v248, v10, v248
    v_mul_f32 v249, v10, v249
    v_cvt_pk_bf16_f32 v122, v248, v249
    v_mul_f32 v250, v10, v250
    v_mul_f32 v251, v10, v251
    v_cvt_pk_bf16_f32 v123, v250, v251
    v_mfma_f32_16x16x32_bf16 v[248:251], v[24:27], v[220:223], 0
    v_mov_b32 v237, v236
    v_cvt_pk_bf16_f32 v244, v244, v245
    v_cvt_pk_bf16_f32 v245, v246, v247
    v_permlane16_swap_b32 v236, v237
    ds_read_b128 v[220:223], v11 offset:23040
    v_mfma_f32_16x16x32_bf16 v[248:251], v[28:31], v[224:227], v[248:251]
    ds_read_b128 v[224:227], v11 offset:23104
    v_mfma_f32_16x16x32_bf16 v[248:251], v[32:35], v[228:231], v[248:251]
    ds_read_b128 v[228:231], v11 offset:23168
    v_max_f32 v233, v236, v237
    v_sub_f32 v204, v204, v233
    v_sub_f32 v205, v205, v233
    v_sub_f32 v206, v206, v233
    v_sub_f32 v207, v207, v233
    v_sub_f32 v208, v208, v233
    v_sub_f32 v209, v209, v233
    v_sub_f32 v210, v210, v233
    v_exp_f32 v204, v204
    v_exp_f32 v205, v205
    v_exp_f32 v206, v206
    v_cvt_pk_bf16_f32 v216, v204, v205
    v_exp_f32 v207, v207
    v_exp_f32 v208, v208
    v_cvt_pk_bf16_f32 v217, v206, v207
    v_exp_f32 v209, v209
    v_mfma_f32_16x16x32_bf16 v[204:207], v[172:175], v[116:119], v[92:95]
    v_cvt_pk_bf16_f32 v218, v208, v209
    v_exp_f32 v210, v210
    v_max3_f32 v236, v196, v197, v198
    v_cvt_pk_bf16_f32 v219, v210, 0
    v_mfma_f32_16x16x32_bf16 v[208:211], v[176:179], v[116:119], v[96:99]
    v_max3_f32 v236, v236, v199, v200
    v_max3_f32 v236, v236, v201, v202
    v_mov_b32 v237, v236
    v_cvt_pk_bf16_f32 v246, v248, v249
    v_mfma_f32_16x16x32_bf16 v[148:151], v[188:191], v[216:219], 0
    v_permlane32_swap_b32 v236, v237
    v_mfma_f32_16x16x32_bf16 v[152:155], v[192:195], v[216:219], 0
    ds_read_b64_tr_b16 v[188:189], v5 offset:5176
    ds_read_b64_tr_b16 v[190:191], v6 offset:5176
    ds_read_b64_tr_b16 v[192:193], v7
    ds_read_b64_tr_b16 v[194:195], v8
    v_max_f32 v236, v236, v237
    v_mov_b32 v237, v236
    v_cvt_pk_bf16_f32 v247, v250, v251
    s_waitcnt lgkmcnt(4)
    v_permlane16_swap_b32 v236, v237
    v_mfma_f32_16x16x32_bf16 v[248:251], v[60:63], v[220:223], 0
    ds_write_b128 v1, v[244:247] offset:32656
    v_mfma_f32_16x16x32_bf16 v[244:247], v[48:51], v[220:223], 0
    v_mfma_f32_16x16x32_bf16 v[244:247], v[52:55], v[224:227], v[244:247]
    ds_read_b128 v[220:223], v0 offset:9216
    v_mfma_f32_16x16x32_bf16 v[244:247], v[56:59], v[228:231], v[244:247]
    v_mfma_f32_16x16x32_bf16 v[248:251], v[64:67], v[224:227], v[248:251]
    ds_read_b128 v[224:227], v0 offset:9280
    v_mfma_f32_16x16x32_bf16 v[248:251], v[68:71], v[228:231], v[248:251]
    ds_read_b128 v[228:231], v0 offset:9344
    v_max3_f32 v236, v236, v237, v232
    v_sub_f32 v237, v232, v236
    v_exp_f32 v237, v237
    v_mov_b32 v232, v236
    v_mul_f32 v140, v237, v140
    v_mul_f32 v141, v237, v141
    v_mul_f32 v142, v237, v142
    v_mul_f32 v143, v237, v143
    v_mul_f32 v144, v237, v144
    v_mul_f32 v145, v237, v145
    v_mul_f32 v146, v237, v146
    v_mul_f32 v147, v237, v147
    v_sub_f32 v196, v196, v232
    v_sub_f32 v197, v197, v232
    v_sub_f32 v198, v198, v232
    v_sub_f32 v199, v199, v232
    v_sub_f32 v200, v200, v232
    v_sub_f32 v201, v201, v232
    v_sub_f32 v202, v202, v232
    v_exp_f32 v196, v196
    v_exp_f32 v197, v197
    v_exp_f32 v198, v198
    v_cvt_pk_bf16_f32 v212, v196, v197
    v_exp_f32 v199, v199
    v_exp_f32 v200, v200
    v_cvt_pk_bf16_f32 v213, v198, v199
    v_mfma_f32_16x16x32_bf16 v[196:199], v[172:175], v[120:123], v[84:87]
    v_exp_f32 v201, v201
    v_exp_f32 v202, v202
    v_cvt_pk_bf16_f32 v214, v200, v201
    v_cvt_pk_bf16_f32 v215, v202, 0
    v_mfma_f32_16x16x32_bf16 v[200:203], v[176:179], v[120:123], v[88:91]
    v_cvt_pk_bf16_f32 v252, v252, v253
    s_waitcnt lgkmcnt(0)
    v_mfma_f32_16x16x32_bf16 v[140:143], v[188:191], v[212:215], v[140:143]
    v_cvt_pk_bf16_f32 v253, v254, v255
    v_max3_f32 v236, v204, v205, v206
    v_mfma_f32_16x16x32_bf16 v[144:147], v[192:195], v[212:215], v[144:147]
    v_max3_f32 v236, v236, v207, v208
    v_max3_f32 v236, v236, v209, v210
    v_mov_b32 v237, v236
    v_mul_f32 v244, v10, v244
    v_mul_f32 v245, v10, v245
    v_permlane32_swap_b32 v236, v237
    v_max_f32 v236, v236, v237
    v_mov_b32 v237, v236
    v_cvt_pk_bf16_f32 v124, v244, v245
    v_mul_f32 v246, v10, v246
    v_permlane16_swap_b32 v236, v237
    v_max3_f32 v236, v236, v237, v233
    v_sub_f32 v237, v233, v236
    v_exp_f32 v237, v237
    v_mov_b32 v233, v236
    v_mul_f32 v148, v237, v148
    v_mul_f32 v149, v237, v149
    v_mul_f32 v150, v237, v150
    v_mul_f32 v151, v237, v151
    v_mul_f32 v152, v237, v152
    v_mul_f32 v153, v237, v153
    v_mul_f32 v154, v237, v154
    v_mul_f32 v155, v237, v155
    v_sub_f32 v204, v204, v233
    v_sub_f32 v205, v205, v233
    v_sub_f32 v206, v206, v233
    v_sub_f32 v207, v207, v233
    v_sub_f32 v208, v208, v233
    v_sub_f32 v209, v209, v233
    v_sub_f32 v210, v210, v233
    v_exp_f32 v204, v204
    v_exp_f32 v205, v205
    v_exp_f32 v206, v206
    v_cvt_pk_bf16_f32 v216, v204, v205
    v_exp_f32 v207, v207
    v_exp_f32 v208, v208
    v_cvt_pk_bf16_f32 v217, v206, v207
    v_mfma_f32_16x16x32_bf16 v[204:207], v[180:183], v[72:75], v[108:111]
    v_exp_f32 v209, v209
    v_exp_f32 v210, v210
    v_cvt_pk_bf16_f32 v218, v208, v209
    v_cvt_pk_bf16_f32 v219, v210, 0
    v_mfma_f32_16x16x32_bf16 v[208:211], v[184:187], v[72:75], v[112:115]
    v_mul_f32 v247, v10, v247
    v_cvt_pk_bf16_f32 v125, v246, v247
    v_mfma_f32_16x16x32_bf16 v[148:151], v[188:191], v[216:219], v[148:151]
    v_mul_f32 v248, v10, v248
    v_mul_f32 v249, v10, v249
    v_mfma_f32_16x16x32_bf16 v[152:155], v[192:195], v[216:219], v[152:155]
    v_cvt_pk_bf16_f32 v126, v248, v249
    v_mfma_f32_16x16x32_bf16 v[244:247], v[12:15], v[220:223], 0
    v_mul_f32 v250, v10, v250
    v_mfma_f32_16x16x32_bf16 v[244:247], v[16:19], v[224:227], v[244:247]
    v_mul_f32 v251, v10, v251
    v_mfma_f32_16x16x32_bf16 v[244:247], v[20:23], v[228:231], v[244:247]
    v_cvt_pk_bf16_f32 v127, v250, v251
    v_mfma_f32_16x16x32_bf16 v[248:251], v[24:27], v[220:223], 0
    v_max3_f32 v236, v196, v197, v198
    v_mfma_f32_16x16x32_bf16 v[248:251], v[28:31], v[224:227], v[248:251]
    v_max3_f32 v236, v236, v199, v200
    v_mfma_f32_16x16x32_bf16 v[248:251], v[32:35], v[228:231], v[248:251]
    v_max3_f32 v236, v236, v201, v202
    ds_write_b64 v2, v[252:253] offset:37648
    v_mfma_f32_16x16x32_bf16 v[252:255], v[36:39], v[220:223], 0
    v_mov_b32 v237, v236
    v_cvt_pk_bf16_f32 v244, v244, v245
    v_mfma_f32_16x16x32_bf16 v[252:255], v[40:43], v[224:227], v[252:255]
    v_permlane32_swap_b32 v236, v237
    v_mfma_f32_16x16x32_bf16 v[252:255], v[44:47], v[228:231], v[252:255]
    v_max_f32 v236, v236, v237
    v_mov_b32 v237, v236
    v_cvt_pk_bf16_f32 v245, v246, v247
    v_cvt_pk_bf16_f32 v246, v248, v249
    v_permlane16_swap_b32 v236, v237
    v_max_f32 v234, v236, v237
    v_sub_f32 v196, v196, v234
    v_sub_f32 v197, v197, v234
    v_sub_f32 v198, v198, v234
    v_sub_f32 v199, v199, v234
    v_sub_f32 v200, v200, v234
    v_sub_f32 v201, v201, v234
    v_sub_f32 v202, v202, v234
    v_exp_f32 v196, v196
    v_exp_f32 v197, v197
    v_exp_f32 v198, v198
    v_cvt_pk_bf16_f32 v212, v196, v197
    v_exp_f32 v199, v199
    v_exp_f32 v200, v200
    v_cvt_pk_bf16_f32 v213, v198, v199
    v_mfma_f32_16x16x32_bf16 v[196:199], v[180:183], v[116:119], v[100:103]
    v_exp_f32 v201, v201
    v_exp_f32 v202, v202
    v_cvt_pk_bf16_f32 v214, v200, v201
    v_cvt_pk_bf16_f32 v215, v202, 0
    v_mfma_f32_16x16x32_bf16 v[200:203], v[184:187], v[116:119], v[104:107]
    v_cvt_pk_bf16_f32 v247, v250, v251
    v_cvt_pk_bf16_f32 v252, v252, v253
    v_mfma_f32_16x16x32_bf16 v[156:159], v[188:191], v[212:215], 0
    v_cvt_pk_bf16_f32 v253, v254, v255
    v_max3_f32 v236, v204, v205, v206
    v_mfma_f32_16x16x32_bf16 v[160:163], v[192:195], v[212:215], 0
    v_max3_f32 v236, v236, v207, v208
    v_max3_f32 v236, v236, v209, v210
    v_mov_b32 v237, v236
    ds_read_b64_tr_b16 v[188:189], v5 offset:5496
    ds_read_b64_tr_b16 v[190:191], v6 offset:5496
    ds_read_b64_tr_b16 v[192:193], v7 offset:640
    ds_read_b64_tr_b16 v[194:195], v8 offset:640
    ds_write_b128 v1, v[244:247] offset:33168
    ds_write_b64 v2, v[252:253] offset:37904
    v_permlane32_swap_b32 v236, v237
    v_max_f32 v236, v236, v237
    v_mov_b32 v237, v236
    ds_read_b128 v[220:223], v0 offset:12288
    ds_read_b128 v[224:227], v0 offset:12352
    v_permlane16_swap_b32 v236, v237
    v_max3_f32 v236, v236, v237, v232
    v_sub_f32 v237, v232, v236
    v_exp_f32 v237, v237
    v_mov_b32 v232, v236
    v_mul_f32 v140, v237, v140
    v_mul_f32 v141, v237, v141
    v_mul_f32 v142, v237, v142
    v_mul_f32 v143, v237, v143
    v_mul_f32 v144, v237, v144
    v_mul_f32 v145, v237, v145
    v_mul_f32 v146, v237, v146
    v_mul_f32 v147, v237, v147
    v_sub_f32 v204, v204, v232
    v_sub_f32 v205, v205, v232
    v_sub_f32 v206, v206, v232
    v_sub_f32 v207, v207, v232
    v_sub_f32 v208, v208, v232
    v_sub_f32 v209, v209, v232
    v_sub_f32 v210, v210, v232
    v_exp_f32 v204, v204
    v_exp_f32 v205, v205
    v_exp_f32 v206, v206
    v_cvt_pk_bf16_f32 v216, v204, v205
    v_exp_f32 v207, v207
    v_exp_f32 v208, v208
    v_cvt_pk_bf16_f32 v217, v206, v207
    v_mfma_f32_16x16x32_bf16 v[204:207], v[180:183], v[120:123], v[92:95]
    v_exp_f32 v209, v209
    v_exp_f32 v210, v210
    v_cvt_pk_bf16_f32 v218, v208, v209
    s_waitcnt lgkmcnt(1)
    v_mfma_f32_16x16x32_bf16 v[244:247], v[12:15], v[220:223], 0
    v_cvt_pk_bf16_f32 v219, v210, 0
    v_max3_f32 v236, v196, v197, v198
    v_mfma_f32_16x16x32_bf16 v[248:251], v[24:27], v[220:223], 0
    v_max3_f32 v236, v236, v199, v200
    v_max3_f32 v236, v236, v201, v202
    v_mfma_f32_16x16x32_bf16 v[140:143], v[188:191], v[216:219], v[140:143]
    v_mov_b32 v237, v236
    v_mfma_f32_16x16x32_bf16 v[144:147], v[192:195], v[216:219], v[144:147]
    ds_read_b128 v[228:231], v0 offset:12416
    v_permlane32_swap_b32 v236, v237
    v_mfma_f32_16x16x32_bf16 v[252:255], v[36:39], v[220:223], 0
    v_max_f32 v236, v236, v237
    v_mov_b32 v237, v236
    v_mfma_f32_16x16x32_bf16 v[208:211], v[184:187], v[120:123], v[96:99]
    s_waitcnt lgkmcnt(1)
    v_permlane16_swap_b32 v236, v237
    v_mfma_f32_16x16x32_bf16 v[244:247], v[16:19], v[224:227], v[244:247]
    v_permlane32_swap_b32 v144, v146
    v_mfma_f32_16x16x32_bf16 v[248:251], v[28:31], v[224:227], v[248:251]
    v_permlane32_swap_b32 v145, v147
    v_mfma_f32_16x16x32_bf16 v[252:255], v[40:43], v[224:227], v[252:255]
    v_rcp_f32 v146, v146
    v_max3_f32 v236, v236, v237, v233
    v_mul_f32 v140, v146, v140
    v_mul_f32 v141, v146, v141
    v_cvt_pk_bf16_f32 v140, v140, v141
    v_mul_f32 v142, v146, v142
    v_mul_f32 v143, v146, v143
    v_cvt_pk_bf16_f32 v141, v142, v143
    v_mul_f32 v144, v146, v144
    s_waitcnt lgkmcnt(0)
    v_mfma_f32_16x16x32_bf16 v[244:247], v[20:23], v[228:231], v[244:247]
    v_mul_f32 v145, v146, v145
    v_cvt_pk_bf16_f32 v142, v144, v145
    v_mfma_f32_16x16x32_bf16 v[248:251], v[32:35], v[228:231], v[248:251]
    v_sub_f32 v237, v233, v236
    v_exp_f32 v237, v237
    v_mfma_f32_16x16x32_bf16 v[252:255], v[44:47], v[228:231], v[252:255]
    v_mov_b32 v233, v236
    v_mul_f32 v148, v237, v148
    v_mul_f32 v149, v237, v149
    v_mul_f32 v150, v237, v150
    v_mul_f32 v151, v237, v151
    v_mul_f32 v152, v237, v152
    v_mul_f32 v153, v237, v153
    v_mul_f32 v154, v237, v154
    v_mul_f32 v155, v237, v155
    v_sub_f32 v196, v196, v233
    v_sub_f32 v197, v197, v233
    v_sub_f32 v198, v198, v233
    v_sub_f32 v199, v199, v233
    v_sub_f32 v200, v200, v233
    v_sub_f32 v201, v201, v233
    v_sub_f32 v202, v202, v233
    v_exp_f32 v196, v196
    v_exp_f32 v197, v197
    v_exp_f32 v198, v198
    v_cvt_pk_bf16_f32 v212, v196, v197
    v_exp_f32 v199, v199
    v_exp_f32 v200, v200
    v_cvt_pk_bf16_f32 v213, v198, v199
    v_exp_f32 v201, v201
    v_exp_f32 v202, v202
    v_cvt_pk_bf16_f32 v214, v200, v201
    v_cvt_pk_bf16_f32 v215, v202, 0
    v_cvt_pk_bf16_f32 v244, v244, v245
    v_cvt_pk_bf16_f32 v245, v246, v247
    v_mfma_f32_16x16x32_bf16 v[148:151], v[188:191], v[212:215], v[148:151]
    v_cvt_pk_bf16_f32 v246, v248, v249
    v_cvt_pk_bf16_f32 v247, v250, v251
    v_mfma_f32_16x16x32_bf16 v[152:155], v[192:195], v[212:215], v[152:155]
    v_cvt_pk_bf16_f32 v252, v252, v253
    ds_write_b64 v99, v[140:141] offset:9216
    ds_write_b32 v107, v142 offset:11264
    ds_write_b128 v1, v[244:247] offset:33424
    v_cvt_pk_bf16_f32 v253, v254, v255
    v_max3_f32 v236, v204, v205, v206
    v_max3_f32 v236, v236, v207, v208
    v_max3_f32 v236, v236, v209, v210
    v_mov_b32 v237, v236
    s_mul_i32 s62, s50, 96
    s_lshl_b32 s61, s37, 2
    ds_write_b64 v2, v[252:253] offset:38032
    v_permlane32_swap_b32 v236, v237
    v_max_f32 v236, v236, v237
    v_mov_b32 v237, v236
    s_sub_u32 s61, 76864, s61
    s_lshl_b32 s63, s50, 11
    v_permlane16_swap_b32 v236, v237
    v_max3_f32 v236, v236, v237, v234
    v_sub_f32 v237, v234, v236
    v_exp_f32 v237, v237
    v_mov_b32 v234, v236
    v_mul_f32 v156, v237, v156
    v_mul_f32 v157, v237, v157
    v_mul_f32 v158, v237, v158
    v_mul_f32 v159, v237, v159
    v_mul_f32 v160, v237, v160
    v_mul_f32 v161, v237, v161
    v_mul_f32 v162, v237, v162
    v_mul_f32 v163, v237, v163
    v_sub_f32 v204, v204, v234
    v_sub_f32 v205, v205, v234
    v_sub_f32 v206, v206, v234
    v_sub_f32 v207, v207, v234
    v_sub_f32 v208, v208, v234
    v_sub_f32 v209, v209, v234
    v_sub_f32 v210, v210, v234
    v_exp_f32 v204, v204
    v_exp_f32 v205, v205
    v_exp_f32 v206, v206
    v_cvt_pk_bf16_f32 v216, v204, v205
    v_exp_f32 v207, v207
    v_exp_f32 v208, v208
    v_cvt_pk_bf16_f32 v217, v206, v207
    v_exp_f32 v209, v209
    v_exp_f32 v210, v210
    v_cvt_pk_bf16_f32 v218, v208, v209
    v_cvt_pk_bf16_f32 v219, v210, 0
    s_add_u32 s63, s63, s61
    s_waitcnt vmcnt(1) lgkmcnt(0)
    s_barrier
    ds_read_b128 v[172:175], v3 offset:32512
    ds_read_b128 v[176:179], v4 offset:32512
    s_lshl_b32 s60, s50, 5
    s_add_u32 s60, s60, s61
    ds_read_b128 v[220:223], v11 offset:30720
    ds_read_b128 v[224:227], v11 offset:30784
    v_mfma_f32_16x16x32_bf16 v[156:159], v[188:191], v[216:219], v[156:159]
    v_mfma_f32_16x16x32_bf16 v[160:163], v[192:195], v[216:219], v[160:163]
    v_mfma_f32_16x16x32_bf16 v[196:199], v[180:183], v[124:127], v[84:87]
    v_mfma_f32_16x16x32_bf16 v[200:203], v[184:187], v[124:127], v[88:91]
    ds_read_b128 v[228:231], v11 offset:30848
    s_waitcnt lgkmcnt(4)
    v_mfma_f32_16x16x32_bf16 v[204:207], v[172:175], v[116:119], v[108:111]
    ds_read_b128 v[180:183], v3 offset:33152
    s_waitcnt lgkmcnt(4)
    v_mfma_f32_16x16x32_bf16 v[208:211], v[176:179], v[116:119], v[112:115]
    ds_read_b128 v[184:187], v4 offset:33152
    v_max3_f32 v236, v196, v197, v198
    v_max3_f32 v236, v236, v199, v200
    s_waitcnt lgkmcnt(4)
    v_mfma_f32_16x16x32_bf16 v[244:247], v[48:51], v[220:223], 0
    s_waitcnt lgkmcnt(3)
    v_mfma_f32_16x16x32_bf16 v[244:247], v[52:55], v[224:227], v[244:247]
    v_max3_f32 v236, v236, v201, v202
    v_mov_b32 v237, v236
    s_waitcnt lgkmcnt(2)
    v_mfma_f32_16x16x32_bf16 v[244:247], v[56:59], v[228:231], v[244:247]
    v_mfma_f32_16x16x32_bf16 v[248:251], v[60:63], v[220:223], 0
    ds_read_b128 v[220:223], v11 offset:38400
    v_mfma_f32_16x16x32_bf16 v[248:251], v[64:67], v[224:227], v[248:251]
    ds_read_b128 v[224:227], v11 offset:38464
    v_mfma_f32_16x16x32_bf16 v[248:251], v[68:71], v[228:231], v[248:251]
    ds_read_b128 v[228:231], v11 offset:38528
    v_permlane32_swap_b32 v236, v237
    v_max_f32 v236, v236, v237
    v_mul_f32 v244, v10, v244
    v_mul_f32 v245, v10, v245
    v_cvt_pk_bf16_f32 v128, v244, v245
    v_mul_f32 v246, v10, v246
    v_mul_f32 v247, v10, v247
    v_cvt_pk_bf16_f32 v129, v246, v247
    s_waitcnt lgkmcnt(0)
    v_mfma_f32_16x16x32_bf16 v[244:247], v[48:51], v[220:223], 0
    v_mfma_f32_16x16x32_bf16 v[244:247], v[52:55], v[224:227], v[244:247]
    v_mfma_f32_16x16x32_bf16 v[244:247], v[56:59], v[228:231], v[244:247]
    v_mul_f32 v248, v10, v248
    v_mul_f32 v249, v10, v249
    v_cvt_pk_bf16_f32 v130, v248, v249
    v_mul_f32 v250, v10, v250
    v_mul_f32 v251, v10, v251
    v_cvt_pk_bf16_f32 v131, v250, v251
    v_mfma_f32_16x16x32_bf16 v[248:251], v[60:63], v[220:223], 0
    v_mov_b32 v237, v236
    v_mfma_f32_16x16x32_bf16 v[248:251], v[64:67], v[224:227], v[248:251]
    ds_read_b128 v[220:223], v11 offset:46080
    ds_read_b128 v[224:227], v11 offset:46144
    v_mfma_f32_16x16x32_bf16 v[248:251], v[68:71], v[228:231], v[248:251]
    ds_read_b128 v[228:231], v11 offset:46208
    v_mul_f32 v244, v10, v244
    v_mul_f32 v245, v10, v245
    v_cvt_pk_bf16_f32 v132, v244, v245
    v_mul_f32 v246, v10, v246
    v_mul_f32 v247, v10, v247
    v_cvt_pk_bf16_f32 v133, v246, v247
    v_permlane16_swap_b32 v236, v237
    s_waitcnt lgkmcnt(2)
    v_mul_f32 v248, v10, v248
    v_mul_f32 v249, v10, v249
    v_cvt_pk_bf16_f32 v134, v248, v249
    v_mfma_f32_16x16x32_bf16 v[244:247], v[48:51], v[220:223], 0
    v_mul_f32 v250, v10, v250
    s_waitcnt lgkmcnt(0)
    v_mfma_f32_16x16x32_bf16 v[244:247], v[52:55], v[224:227], v[244:247]
    v_mfma_f32_16x16x32_bf16 v[244:247], v[56:59], v[228:231], v[244:247]
    v_mul_f32 v251, v10, v251
    v_cvt_pk_bf16_f32 v135, v250, v251
    v_mfma_f32_16x16x32_bf16 v[248:251], v[60:63], v[220:223], 0
    v_max_f32 v235, v236, v237
    v_sub_f32 v196, v196, v235
    v_mfma_f32_16x16x32_bf16 v[248:251], v[64:67], v[224:227], v[248:251]
    v_sub_f32 v197, v197, v235
    ds_read_b128 v[220:223], v0 offset:18432
    ds_read_b128 v[224:227], v0 offset:18496
    v_sub_f32 v198, v198, v235
    v_sub_f32 v199, v199, v235
    v_mfma_f32_16x16x32_bf16 v[248:251], v[68:71], v[228:231], v[248:251]
    v_sub_f32 v200, v200, v235
    v_sub_f32 v201, v201, v235
    v_sub_f32 v202, v202, v235
    v_exp_f32 v196, v196
    ds_read_b128 v[228:231], v0 offset:18560
    v_exp_f32 v197, v197
    v_exp_f32 v198, v198
    v_cvt_pk_bf16_f32 v212, v196, v197
    s_waitcnt lgkmcnt(2)
    v_mfma_f32_16x16x32_bf16 v[252:255], v[36:39], v[220:223], 0
    s_waitcnt lgkmcnt(1)
    v_mfma_f32_16x16x32_bf16 v[252:255], v[40:43], v[224:227], v[252:255]
    v_exp_f32 v199, v199
    v_exp_f32 v200, v200
    v_cvt_pk_bf16_f32 v213, v198, v199
    v_mfma_f32_16x16x32_bf16 v[196:199], v[172:175], v[120:123], v[100:103]
    v_exp_f32 v201, v201
    v_exp_f32 v202, v202
    v_cvt_pk_bf16_f32 v214, v200, v201
    s_waitcnt lgkmcnt(0)
    v_mfma_f32_16x16x32_bf16 v[252:255], v[44:47], v[228:231], v[252:255]
    v_cvt_pk_bf16_f32 v215, v202, 0
    v_mfma_f32_16x16x32_bf16 v[200:203], v[176:179], v[120:123], v[104:107]
    v_mul_f32 v244, v10, v244
    v_mul_f32 v245, v10, v245
    v_cvt_pk_bf16_f32 v136, v244, v245
    v_mul_f32 v246, v10, v246
    v_mfma_f32_16x16x32_bf16 v[164:167], v[188:191], v[212:215], 0
    ds_read_b64_tr_b16 v[188:189], v5 offset:37576
    ds_read_b64_tr_b16 v[190:191], v6 offset:37576
    v_mfma_f32_16x16x32_bf16 v[168:171], v[192:195], v[212:215], 0
    ds_read_b64_tr_b16 v[192:193], v7 offset:32400
    ds_read_b64_tr_b16 v[194:195], v8 offset:32400
    v_mul_f32 v247, v10, v247
    v_cvt_pk_bf16_f32 v137, v246, v247
    v_mul_f32 v248, v10, v248
    v_mul_f32 v249, v10, v249
    v_cvt_pk_bf16_f32 v138, v248, v249
    v_mul_f32 v250, v10, v250
    v_mul_f32 v251, v10, v251
    v_cvt_pk_bf16_f32 v139, v250, v251
    v_max3_f32 v236, v204, v205, v206
    v_max3_f32 v236, v236, v207, v208
    v_mfma_f32_16x16x32_bf16 v[248:251], v[24:27], v[220:223], 0
    v_max3_f32 v236, v236, v209, v210
    v_mov_b32 v237, v236
    v_mfma_f32_16x16x32_bf16 v[248:251], v[28:31], v[224:227], v[248:251]
    v_add_u32 v10, s51, v107
    v_mfma_f32_16x16x32_bf16 v[248:251], v[32:35], v[228:231], v[248:251]
    v_permlane32_swap_b32 v236, v237
    v_max_f32 v236, v236, v237
    v_mov_b32 v237, v236
    v_bfe_u32 v244, v107, 8, 2
    v_mad_i32_i24 v11, v244, -8, v115
    v_permlane16_swap_b32 v236, v237
    v_max3_f32 v236, v236, v237, v233
    v_sub_f32 v237, v233, v236
    v_exp_f32 v237, v237
    v_mov_b32 v233, v236
    v_mul_f32 v148, v237, v148
    v_mul_f32 v149, v237, v149
    v_mul_f32 v150, v237, v150
    v_mul_f32 v151, v237, v151
    v_mul_f32 v152, v237, v152
    v_mul_f32 v153, v237, v153
    v_mul_f32 v154, v237, v154
    v_mul_f32 v155, v237, v155
    v_sub_f32 v204, v204, v233
    v_sub_f32 v205, v205, v233
    v_sub_f32 v206, v206, v233
    v_sub_f32 v207, v207, v233
    v_sub_f32 v208, v208, v233
    v_sub_f32 v209, v209, v233
    v_sub_f32 v210, v210, v233
    v_exp_f32 v204, v204
    v_exp_f32 v205, v205
    v_exp_f32 v206, v206
    v_cvt_pk_bf16_f32 v216, v204, v205
    v_exp_f32 v207, v207
    v_exp_f32 v208, v208
    v_cvt_pk_bf16_f32 v217, v206, v207
    v_exp_f32 v209, v209
    v_exp_f32 v210, v210
    v_mfma_f32_16x16x32_bf16 v[204:207], v[172:175], v[124:127], v[92:95]
    v_cvt_pk_bf16_f32 v218, v208, v209
    v_cvt_pk_bf16_f32 v219, v210, 0
    v_mfma_f32_16x16x32_bf16 v[208:211], v[176:179], v[124:127], v[96:99]
    v_subrev_u32 v11, s62, v11
    s_waitcnt lgkmcnt(0)
    v_mfma_f32_16x16x32_bf16 v[148:151], v[188:191], v[216:219], v[148:151]
    v_bfe_u32 v245, v107, 4, 2
    v_add_u32 v247, s63, v107
    v_mfma_f32_16x16x32_bf16 v[152:155], v[192:195], v[216:219], v[152:155]
    v_mad_i32_i24 v246, v245, -8, v107
    v_add_u32 v246, s60, v246
    v_cvt_pk_bf16_f32 v252, v252, v253
    v_cvt_pk_bf16_f32 v253, v254, v255
    v_max3_f32 v236, v196, v197, v198
    v_max3_f32 v236, v236, v199, v200
    v_max3_f32 v236, v236, v201, v202
    v_mov_b32 v237, v236
    v_permlane32_swap_b32 v152, v154
    v_permlane32_swap_b32 v153, v155
    v_rcp_f32 v154, v154
    v_permlane32_swap_b32 v236, v237
    v_mul_f32 v148, v154, v148
    v_mul_f32 v149, v154, v149
    v_cvt_pk_bf16_f32 v148, v148, v149
    v_mul_f32 v150, v154, v150
    v_mul_f32 v151, v154, v151
    v_cvt_pk_bf16_f32 v149, v150, v151
    v_mul_f32 v152, v154, v152
    v_mul_f32 v153, v154, v153
    v_cvt_pk_bf16_f32 v150, v152, v153
    ds_write_b64 v99, v[148:149] offset:15360
    ds_write_b32 v107, v150 offset:17408
    ds_read_b64_tr_b16 v[48:49], v247
    v_max_f32 v236, v236, v237
    v_mov_b32 v237, v236
    ds_read_b64_tr_b16 v[50:51], v247 offset:3072
    v_cndmask_b32 v109, v109, v91, s[68:69]
    v_permlane16_swap_b32 v236, v237
    v_max3_f32 v236, v236, v237, v234
    v_sub_f32 v237, v234, v236
    v_exp_f32 v237, v237
    v_mov_b32 v234, v236
    v_mul_f32 v156, v237, v156
    v_mul_f32 v157, v237, v157
    v_mul_f32 v158, v237, v158
    v_mul_f32 v159, v237, v159
    v_mul_f32 v160, v237, v160
    v_mul_f32 v161, v237, v161
    v_mul_f32 v162, v237, v162
    v_mul_f32 v163, v237, v163
    v_sub_f32 v196, v196, v234
    v_sub_f32 v197, v197, v234
    v_sub_f32 v198, v198, v234
    ds_read_b64_tr_b16 v[52:53], v247 offset:6144
    ds_read_b64_tr_b16 v[54:55], v247 offset:9216
    ds_read_b64_tr_b16 v[56:57], v247 offset:12288
    ds_read_b64_tr_b16 v[58:59], v247 offset:15360
    ds_read_b64_tr_b16 v[60:61], v247 offset:8
    ds_read_b64_tr_b16 v[62:63], v247 offset:3080
    v_sub_f32 v199, v199, v234
    v_sub_f32 v200, v200, v234
    v_sub_f32 v201, v201, v234
    v_sub_f32 v202, v202, v234
    v_exp_f32 v196, v196
    v_exp_f32 v197, v197
    ds_read_b64_tr_b16 v[64:65], v247 offset:6152
    ds_read_b64_tr_b16 v[66:67], v247 offset:9224
    ds_read_b64_tr_b16 v[68:69], v247 offset:12296
    v_cvt_pk_bf16_f32 v212, v196, v197
    v_exp_f32 v198, v198
    v_exp_f32 v199, v199
    ds_read_b64_tr_b16 v[70:71], v247 offset:15368
    ds_read_b64_tr_b16 v[72:73], v246 offset:1024
    ds_read_b64_tr_b16 v[74:75], v246 offset:4096
    v_cvt_pk_bf16_f32 v213, v198, v199
    v_mfma_f32_16x16x32_bf16 v[196:199], v[172:175], v[128:131], v[84:87]
    v_exp_f32 v200, v200
    v_exp_f32 v201, v201
    ds_read_b64_tr_b16 v[76:77], v246 offset:7168
    ds_read_b64_tr_b16 v[78:79], v246 offset:10240
    ds_read_b64_tr_b16 v[80:81], v246 offset:13312
    v_cvt_pk_bf16_f32 v214, v200, v201
    v_exp_f32 v202, v202
    ds_read_b64_tr_b16 v[82:83], v246 offset:16384
    v_mfma_f32_16x16x32_bf16 v[244:247], v[12:15], v[220:223], 0
    v_cvt_pk_bf16_f32 v215, v202, 0
    v_cndmask_b32 v110, v110, v91, s[68:69]
    v_mfma_f32_16x16x32_bf16 v[244:247], v[16:19], v[224:227], v[244:247]
    v_cndmask_b32 v111, v111, v91, s[68:69]
    v_cndmask_b32 v112, v112, v91, s[70:71]
    v_mfma_f32_16x16x32_bf16 v[244:247], v[20:23], v[228:231], v[244:247]
    v_cndmask_b32 v113, v113, v91, s[70:71]
    v_cndmask_b32 v114, v114, v91, s[70:71]
    v_mfma_f32_16x16x32_bf16 v[156:159], v[188:191], v[212:215], v[156:159]
    v_max3_f32 v236, v204, v205, v206
    v_max3_f32 v236, v236, v207, v208
    v_mfma_f32_16x16x32_bf16 v[160:163], v[192:195], v[212:215], v[160:163]
    v_max3_f32 v236, v236, v209, v210
    v_mov_b32 v237, v236
    v_mfma_f32_16x16x32_bf16 v[200:203], v[176:179], v[128:131], v[88:91]
    v_cvt_pk_bf16_f32 v244, v244, v245
    v_cvt_pk_bf16_f32 v245, v246, v247
    v_cvt_pk_bf16_f32 v246, v248, v249
    v_cvt_pk_bf16_f32 v247, v250, v251
    v_permlane32_swap_b32 v236, v237
    v_max_f32 v236, v236, v237
    v_mov_b32 v237, v236
    s_mul_i32 s56, s39, 0
    s_add_u32 s56, s56, s54
    ds_write_b128 v1, v[244:247] offset:256
    ds_write_b64 v2, v[252:253] offset:5248
    ds_read_b128 v[220:223], v0 offset:24576
    ds_read_b128 v[224:227], v0 offset:24640
    v_permlane16_swap_b32 v236, v237
    v_max3_f32 v236, v236, v237, v235
    v_sub_f32 v237, v235, v236
    v_exp_f32 v237, v237
    v_mov_b32 v235, v236
    v_mul_f32 v164, v237, v164
    v_mul_f32 v165, v237, v165
    v_mul_f32 v166, v237, v166
    v_mul_f32 v167, v237, v167
    v_mul_f32 v168, v237, v168
    v_mul_f32 v169, v237, v169
    v_mul_f32 v170, v237, v170
    v_mul_f32 v171, v237, v171
    v_sub_f32 v204, v204, v235
    v_sub_f32 v205, v205, v235
    v_sub_f32 v206, v206, v235
    v_sub_f32 v207, v207, v235
    v_sub_f32 v208, v208, v235
    v_sub_f32 v209, v209, v235
    v_sub_f32 v210, v210, v235
    v_exp_f32 v204, v204
    v_exp_f32 v205, v205
    v_exp_f32 v206, v206
    v_cvt_pk_bf16_f32 v216, v204, v205
    v_exp_f32 v207, v207
    v_exp_f32 v208, v208
    v_cvt_pk_bf16_f32 v217, v206, v207
    v_mfma_f32_16x16x32_bf16 v[204:207], v[180:183], v[120:123], v[108:111]
    v_exp_f32 v209, v209
    v_exp_f32 v210, v210
    v_cvt_pk_bf16_f32 v218, v208, v209
    s_waitcnt lgkmcnt(1)
    v_mfma_f32_16x16x32_bf16 v[244:247], v[12:15], v[220:223], 0
    v_cvt_pk_bf16_f32 v219, v210, 0
    v_max3_f32 v236, v196, v197, v198
    v_mfma_f32_16x16x32_bf16 v[248:251], v[24:27], v[220:223], 0
    v_max3_f32 v236, v236, v199, v200
    v_max3_f32 v236, v236, v201, v202
    v_mfma_f32_16x16x32_bf16 v[164:167], v[188:191], v[216:219], v[164:167]
    v_mov_b32 v237, v236
    s_mul_i32 s57, s39, 2
    v_mfma_f32_16x16x32_bf16 v[168:171], v[192:195], v[216:219], v[168:171]
    v_permlane32_swap_b32 v236, v237
    v_mfma_f32_16x16x32_bf16 v[252:255], v[36:39], v[220:223], 0
    v_max_f32 v236, v236, v237
    v_mov_b32 v237, v236
    v_mfma_f32_16x16x32_bf16 v[208:211], v[184:187], v[120:123], v[112:115]
    ds_read_b128 v[228:231], v0 offset:24704
    s_waitcnt lgkmcnt(1)
    v_mfma_f32_16x16x32_bf16 v[244:247], v[16:19], v[224:227], v[244:247]
    v_permlane16_swap_b32 v236, v237
    v_mfma_f32_16x16x32_bf16 v[248:251], v[28:31], v[224:227], v[248:251]
    v_max_f32 v232, v236, v237
    v_sub_f32 v196, v196, v232
    v_mfma_f32_16x16x32_bf16 v[252:255], v[40:43], v[224:227], v[252:255]
    v_sub_f32 v197, v197, v232
    v_sub_f32 v198, v198, v232
    v_sub_f32 v199, v199, v232
    v_sub_f32 v200, v200, v232
    v_sub_f32 v201, v201, v232
    v_sub_f32 v202, v202, v232
    v_exp_f32 v196, v196
    v_exp_f32 v197, v197
    v_exp_f32 v198, v198
    v_cvt_pk_bf16_f32 v212, v196, v197
    v_exp_f32 v199, v199
    v_exp_f32 v200, v200
    v_cvt_pk_bf16_f32 v213, v198, v199
    v_mfma_f32_16x16x32_bf16 v[196:199], v[180:183], v[124:127], v[100:103]
    v_exp_f32 v201, v201
    s_waitcnt lgkmcnt(0)
    v_mfma_f32_16x16x32_bf16 v[244:247], v[20:23], v[228:231], v[244:247]
    v_cvt_pk_bf16_f32 v214, v200, v201
    v_exp_f32 v202, v202
    v_mfma_f32_16x16x32_bf16 v[248:251], v[32:35], v[228:231], v[248:251]
    v_cvt_pk_bf16_f32 v215, v202, 0
    v_max3_f32 v236, v204, v205, v206
    v_mfma_f32_16x16x32_bf16 v[252:255], v[44:47], v[228:231], v[252:255]
    v_max3_f32 v236, v236, v207, v208
    v_max3_f32 v236, v236, v209, v210
    v_mfma_f32_16x16x32_bf16 v[140:143], v[188:191], v[212:215], 0
    v_cvt_pk_bf16_f32 v244, v244, v245
    v_cvt_pk_bf16_f32 v245, v246, v247
    v_mfma_f32_16x16x32_bf16 v[144:147], v[192:195], v[212:215], 0
    v_cvt_pk_bf16_f32 v246, v248, v249
    v_cvt_pk_bf16_f32 v247, v250, v251
    v_mfma_f32_16x16x32_bf16 v[200:203], v[184:187], v[124:127], v[104:107]
    v_cvt_pk_bf16_f32 v252, v252, v253
    v_cvt_pk_bf16_f32 v253, v254, v255
    v_mov_b32 v237, v236
    s_add_u32 s57, s57, s54
    ds_write_b128 v1, v[244:247] offset:768
    ds_write_b64 v2, v[252:253] offset:5504
    ds_read_b64_tr_b16 v[188:189], v5 offset:37896
    ds_read_b64_tr_b16 v[190:191], v6 offset:37896
    ds_read_b64_tr_b16 v[192:193], v7 offset:33040
    ds_read_b64_tr_b16 v[194:195], v8 offset:33040
    v_permlane32_swap_b32 v236, v237
    v_max_f32 v236, v236, v237
    v_mov_b32 v237, v236
    ds_read_b128 v[220:223], v10 offset:6144
    ds_read_b128 v[224:227], v10 offset:7168
    v_permlane16_swap_b32 v236, v237
    v_max3_f32 v236, v236, v237, v234
    v_sub_f32 v237, v234, v236
    v_exp_f32 v237, v237
    v_mov_b32 v234, v236
    v_mul_f32 v156, v237, v156
    v_mul_f32 v157, v237, v157
    v_mul_f32 v158, v237, v158
    v_mul_f32 v159, v237, v159
    v_mul_f32 v160, v237, v160
    v_mul_f32 v161, v237, v161
    v_mul_f32 v162, v237, v162
    v_mul_f32 v163, v237, v163
    v_sub_f32 v204, v204, v234
    v_sub_f32 v205, v205, v234
    v_sub_f32 v206, v206, v234
    v_sub_f32 v207, v207, v234
    v_sub_f32 v208, v208, v234
    v_sub_f32 v209, v209, v234
    v_sub_f32 v210, v210, v234
    v_exp_f32 v204, v204
    v_exp_f32 v205, v205
    v_exp_f32 v206, v206
    v_cvt_pk_bf16_f32 v216, v204, v205
    v_exp_f32 v207, v207
    v_exp_f32 v208, v208
    v_cvt_pk_bf16_f32 v217, v206, v207
    v_mfma_f32_16x16x32_bf16 v[204:207], v[180:183], v[128:131], v[92:95]
    v_exp_f32 v209, v209
    v_exp_f32 v210, v210
    v_cvt_pk_bf16_f32 v218, v208, v209
    s_waitcnt lgkmcnt(1)
    v_mfma_f32_16x16x32_bf16 v[244:247], v[48:51], v[220:223], 0
    v_cvt_pk_bf16_f32 v219, v210, 0
    v_max3_f32 v236, v196, v197, v198
    v_mfma_f32_16x16x32_bf16 v[248:251], v[60:63], v[220:223], 0
    v_max3_f32 v236, v236, v199, v200
    v_max3_f32 v236, v236, v201, v202
    v_mfma_f32_16x16x32_bf16 v[156:159], v[188:191], v[216:219], v[156:159]
    v_mov_b32 v237, v236
    v_mfma_f32_16x16x32_bf16 v[160:163], v[192:195], v[216:219], v[160:163]
    ds_read_b128 v[228:231], v10 offset:8192
    v_permlane32_swap_b32 v236, v237
    v_mfma_f32_16x16x32_bf16 v[252:255], v[72:75], v[220:223], 0
    v_max_f32 v236, v236, v237
    v_mov_b32 v237, v236
    v_mfma_f32_16x16x32_bf16 v[208:211], v[184:187], v[128:131], v[96:99]
    s_waitcnt lgkmcnt(1)
    v_permlane16_swap_b32 v236, v237
    v_mfma_f32_16x16x32_bf16 v[244:247], v[52:55], v[224:227], v[244:247]
    v_permlane32_swap_b32 v160, v162
    v_mfma_f32_16x16x32_bf16 v[248:251], v[64:67], v[224:227], v[248:251]
    v_permlane32_swap_b32 v161, v163
    v_mfma_f32_16x16x32_bf16 v[252:255], v[76:79], v[224:227], v[252:255]
    v_rcp_f32 v162, v162
    v_max3_f32 v236, v236, v237, v235
    v_mul_f32 v156, v162, v156
    v_mul_f32 v157, v162, v157
    v_cvt_pk_bf16_f32 v156, v156, v157
    v_mul_f32 v158, v162, v158
    v_mul_f32 v159, v162, v159
    v_cvt_pk_bf16_f32 v157, v158, v159
    v_mul_f32 v160, v162, v160
    s_waitcnt lgkmcnt(0)
    v_mfma_f32_16x16x32_bf16 v[244:247], v[56:59], v[228:231], v[244:247]
    v_mul_f32 v161, v162, v161
    v_cvt_pk_bf16_f32 v158, v160, v161
    v_mfma_f32_16x16x32_bf16 v[248:251], v[68:71], v[228:231], v[248:251]
    v_sub_f32 v237, v235, v236
    v_exp_f32 v237, v237
    v_mfma_f32_16x16x32_bf16 v[252:255], v[80:83], v[228:231], v[252:255]
    v_mov_b32 v235, v236
    v_mul_f32 v164, v237, v164
    v_cvt_pk_bf16_f32 v244, v244, v245
    v_cvt_pk_bf16_f32 v245, v246, v247
    v_mul_f32 v165, v237, v165
    v_cvt_pk_bf16_f32 v246, v248, v249
    v_cvt_pk_bf16_f32 v247, v250, v251
    v_mul_f32 v166, v237, v166
    v_cvt_pk_bf16_f32 v252, v252, v253
    v_cvt_pk_bf16_f32 v253, v254, v255
    v_mul_f32 v167, v237, v167
    v_mul_f32 v168, v237, v168
    v_mul_f32 v169, v237, v169
    v_mul_f32 v170, v237, v170
    v_mul_f32 v171, v237, v171
    v_sub_f32 v196, v196, v235
    v_sub_f32 v197, v197, v235
    v_sub_f32 v198, v198, v235
    v_sub_f32 v199, v199, v235
    v_sub_f32 v200, v200, v235
    v_sub_f32 v201, v201, v235
    v_sub_f32 v202, v202, v235
    v_exp_f32 v196, v196
    v_exp_f32 v197, v197
    v_exp_f32 v198, v198
    v_cvt_pk_bf16_f32 v212, v196, v197
    v_exp_f32 v199, v199
    v_exp_f32 v200, v200
    v_cvt_pk_bf16_f32 v213, v198, v199
    v_exp_f32 v201, v201
    ds_write_b64 v99, v[156:157] offset:21504
    ds_write_b32 v107, v158 offset:23552
    buffer_store_dwordx4 v[244:247], v115, s[28:31], s56 offen sc0 sc1
    buffer_store_dwordx2 v[252:253], v11, s[28:31], s56 offen offset:64 sc0 sc1
    v_cvt_pk_bf16_f32 v214, v200, v201
    v_exp_f32 v202, v202
    v_max3_f32 v236, v204, v205, v206
    v_cvt_pk_bf16_f32 v215, v202, 0
    v_max3_f32 v236, v236, v207, v208
    v_max3_f32 v236, v236, v209, v210
    v_mfma_f32_16x16x32_bf16 v[164:167], v[188:191], v[212:215], v[164:167]
    v_mov_b32 v237, v236
    v_mfma_f32_16x16x32_bf16 v[168:171], v[192:195], v[212:215], v[168:171]
    s_nop 0
    v_permlane32_swap_b32 v236, v237
    v_max_f32 v236, v236, v237
    v_mov_b32 v237, v236
    s_nop 1
    v_permlane16_swap_b32 v236, v237
    v_max3_f32 v236, v236, v237, v232
    v_sub_f32 v237, v232, v236
    v_exp_f32 v237, v237
    v_mov_b32 v232, v236
    s_waitcnt vmcnt(2) lgkmcnt(0)
    s_barrier
    ds_read_b128 v[172:175], v3 offset:112
    ds_read_b128 v[176:179], v4 offset:112
    v_mul_f32 v140, v237, v140
    v_mul_f32 v141, v237, v141
    v_mul_f32 v142, v237, v142
    v_mul_f32 v143, v237, v143
    v_mfma_f32_16x16x32_bf16 v[196:199], v[180:183], v[132:135], v[84:87]
    v_mul_f32 v144, v237, v144
    v_mul_f32 v145, v237, v145
    v_mfma_f32_16x16x32_bf16 v[200:203], v[184:187], v[132:135], v[88:91]
    v_mul_f32 v146, v237, v146
    v_mul_f32 v147, v237, v147
    v_sub_f32 v204, v204, v232
    v_sub_f32 v205, v205, v232
    v_sub_f32 v206, v206, v232
    ds_read_b128 v[220:223], v10 offset:18432
    v_sub_f32 v207, v207, v232
    v_sub_f32 v208, v208, v232
    ds_read_b128 v[224:227], v10 offset:19456
    ds_read_b128 v[228:231], v10 offset:20480
    v_sub_f32 v209, v209, v232
    v_sub_f32 v210, v210, v232
    ds_read_b128 v[180:183], v3 offset:752
    ds_read_b128 v[184:187], v4 offset:752
    v_exp_f32 v204, v204
    v_exp_f32 v205, v205
    v_exp_f32 v206, v206
    v_cvt_pk_bf16_f32 v216, v204, v205
    s_waitcnt lgkmcnt(4)
    v_exp_f32 v207, v207
    v_mfma_f32_16x16x32_bf16 v[244:247], v[48:51], v[220:223], 0
    v_cvt_pk_bf16_f32 v217, v206, v207
    v_exp_f32 v208, v208
    v_mfma_f32_16x16x32_bf16 v[248:251], v[60:63], v[220:223], 0
    v_exp_f32 v209, v209
    s_waitcnt lgkmcnt(0)
    v_cvt_pk_bf16_f32 v218, v208, v209
    v_exp_f32 v210, v210
    v_mfma_f32_16x16x32_bf16 v[244:247], v[52:55], v[224:227], v[244:247]
    v_cvt_pk_bf16_f32 v219, v210, 0
    v_max3_f32 v236, v196, v197, v198
    v_mfma_f32_16x16x32_bf16 v[244:247], v[56:59], v[228:231], v[244:247]
    v_max3_f32 v236, v236, v199, v200
    v_max3_f32 v236, v236, v201, v202
    v_mfma_f32_16x16x32_bf16 v[140:143], v[188:191], v[216:219], v[140:143]
    v_mov_b32 v237, v236
    v_mfma_f32_16x16x32_bf16 v[144:147], v[192:195], v[216:219], v[144:147]
    v_mfma_f32_16x16x32_bf16 v[248:251], v[64:67], v[224:227], v[248:251]
    v_mfma_f32_16x16x32_bf16 v[248:251], v[68:71], v[228:231], v[248:251]
    v_mfma_f32_16x16x32_bf16 v[252:255], v[72:75], v[220:223], 0
    ds_read_b128 v[220:223], v0 offset:33792
    v_mfma_f32_16x16x32_bf16 v[252:255], v[76:79], v[224:227], v[252:255]
    ds_read_b128 v[224:227], v0 offset:33856
    v_mfma_f32_16x16x32_bf16 v[252:255], v[80:83], v[228:231], v[252:255]
    ds_read_b128 v[228:231], v0 offset:33920
    v_mfma_f32_16x16x32_bf16 v[204:207], v[172:175], v[124:127], v[108:111]
    v_mfma_f32_16x16x32_bf16 v[208:211], v[176:179], v[124:127], v[112:115]
    v_cvt_pk_bf16_f32 v244, v244, v245
    v_cvt_pk_bf16_f32 v245, v246, v247
    v_cvt_pk_bf16_f32 v246, v248, v249
    v_cvt_pk_bf16_f32 v247, v250, v251
    s_waitcnt lgkmcnt(0)
    v_cvt_pk_bf16_f32 v252, v252, v253
    v_cvt_pk_bf16_f32 v253, v254, v255
    v_permlane32_swap_b32 v236, v237
    v_max_f32 v236, v236, v237
    v_mov_b32 v237, v236
    v_mfma_f32_16x16x32_bf16 v[248:251], v[24:27], v[220:223], 0
    buffer_store_dwordx4 v[244:247], v115, s[28:31], s57 offen sc0 sc1
    v_mfma_f32_16x16x32_bf16 v[248:251], v[28:31], v[224:227], v[248:251]
    buffer_store_dwordx2 v[252:253], v11, s[28:31], s57 offen offset:64 sc0 sc1
    v_mfma_f32_16x16x32_bf16 v[244:247], v[12:15], v[220:223], 0
    v_mfma_f32_16x16x32_bf16 v[244:247], v[16:19], v[224:227], v[244:247]
    v_permlane16_swap_b32 v236, v237
    v_mfma_f32_16x16x32_bf16 v[244:247], v[20:23], v[228:231], v[244:247]
    v_max_f32 v233, v236, v237
    v_sub_f32 v196, v196, v233
    v_sub_f32 v197, v197, v233
    v_mfma_f32_16x16x32_bf16 v[248:251], v[32:35], v[228:231], v[248:251]
    v_mfma_f32_16x16x32_bf16 v[252:255], v[36:39], v[220:223], 0
    ds_read_b128 v[220:223], v0 offset:39936
    v_mfma_f32_16x16x32_bf16 v[252:255], v[40:43], v[224:227], v[252:255]
    ds_read_b128 v[224:227], v0 offset:40000
    v_sub_f32 v198, v198, v233
    v_mfma_f32_16x16x32_bf16 v[252:255], v[44:47], v[228:231], v[252:255]
    ds_read_b128 v[228:231], v0 offset:40064
    v_sub_f32 v199, v199, v233
    v_sub_f32 v200, v200, v233
    v_sub_f32 v201, v201, v233
    v_sub_f32 v202, v202, v233
    v_exp_f32 v196, v196
    v_exp_f32 v197, v197
    v_exp_f32 v198, v198
    v_cvt_pk_bf16_f32 v212, v196, v197
    v_exp_f32 v199, v199
    v_exp_f32 v200, v200
    v_cvt_pk_bf16_f32 v213, v198, v199
    v_mfma_f32_16x16x32_bf16 v[196:199], v[172:175], v[128:131], v[100:103]
    v_exp_f32 v201, v201
    v_exp_f32 v202, v202
    v_cvt_pk_bf16_f32 v214, v200, v201
    v_cvt_pk_bf16_f32 v215, v202, 0
    v_mfma_f32_16x16x32_bf16 v[200:203], v[176:179], v[128:131], v[104:107]
    v_max3_f32 v236, v204, v205, v206
    v_mfma_f32_16x16x32_bf16 v[148:151], v[188:191], v[212:215], 0
    ds_read_b64_tr_b16 v[188:189], v5 offset:5176
    ds_read_b64_tr_b16 v[190:191], v6 offset:5176
    v_max3_f32 v236, v236, v207, v208
    v_mfma_f32_16x16x32_bf16 v[152:155], v[192:195], v[212:215], 0
    ds_read_b64_tr_b16 v[192:193], v7
    ds_read_b64_tr_b16 v[194:195], v8
    v_max3_f32 v236, v236, v209, v210
    v_mov_b32 v237, v236
    v_cvt_pk_bf16_f32 v244, v244, v245
    v_cvt_pk_bf16_f32 v245, v246, v247
    v_permlane32_swap_b32 v236, v237
    v_max_f32 v236, v236, v237
    v_mov_b32 v237, v236
    v_cvt_pk_bf16_f32 v246, v248, v249
    v_cvt_pk_bf16_f32 v247, v250, v251
    s_waitcnt lgkmcnt(0)
    ds_write_b128 v1, v[244:247] offset:32656
    v_mfma_f32_16x16x32_bf16 v[244:247], v[12:15], v[220:223], 0
    v_permlane16_swap_b32 v236, v237
    v_mfma_f32_16x16x32_bf16 v[244:247], v[16:19], v[224:227], v[244:247]
    v_max3_f32 v236, v236, v237, v235
    v_sub_f32 v237, v235, v236
    v_mfma_f32_16x16x32_bf16 v[244:247], v[20:23], v[228:231], v[244:247]
    v_exp_f32 v237, v237
    v_mfma_f32_16x16x32_bf16 v[248:251], v[24:27], v[220:223], 0
    v_mov_b32 v235, v236
    v_mul_f32 v164, v237, v164
    v_mfma_f32_16x16x32_bf16 v[248:251], v[28:31], v[224:227], v[248:251]
    v_mul_f32 v165, v237, v165
    v_mul_f32 v166, v237, v166
    v_mfma_f32_16x16x32_bf16 v[248:251], v[32:35], v[228:231], v[248:251]
    v_mul_f32 v167, v237, v167
    v_mul_f32 v168, v237, v168
    v_mul_f32 v169, v237, v169
    v_mul_f32 v170, v237, v170
    v_mul_f32 v171, v237, v171
    v_sub_f32 v204, v204, v235
    v_sub_f32 v205, v205, v235
    v_sub_f32 v206, v206, v235
    v_sub_f32 v207, v207, v235
    v_sub_f32 v208, v208, v235
    v_sub_f32 v209, v209, v235
    v_sub_f32 v210, v210, v235
    v_exp_f32 v204, v204
    v_exp_f32 v205, v205
    v_exp_f32 v206, v206
    v_cvt_pk_bf16_f32 v216, v204, v205
    v_exp_f32 v207, v207
    v_exp_f32 v208, v208
    v_cvt_pk_bf16_f32 v217, v206, v207
    v_mfma_f32_16x16x32_bf16 v[204:207], v[172:175], v[132:135], v[92:95]
    v_exp_f32 v209, v209
    v_exp_f32 v210, v210
    v_cvt_pk_bf16_f32 v218, v208, v209
    v_cvt_pk_bf16_f32 v219, v210, 0
    v_mfma_f32_16x16x32_bf16 v[208:211], v[176:179], v[132:135], v[96:99]
    v_cvt_pk_bf16_f32 v252, v252, v253
    v_cvt_pk_bf16_f32 v253, v254, v255
    v_mfma_f32_16x16x32_bf16 v[164:167], v[188:191], v[216:219], v[164:167]
    v_max3_f32 v236, v196, v197, v198
    v_max3_f32 v236, v236, v199, v200
    v_mfma_f32_16x16x32_bf16 v[168:171], v[192:195], v[216:219], v[168:171]
    v_max3_f32 v236, v236, v201, v202
    v_mov_b32 v237, v236
    v_cvt_pk_bf16_f32 v244, v244, v245
    v_cvt_pk_bf16_f32 v245, v246, v247
    v_permlane32_swap_b32 v236, v237
    v_max_f32 v236, v236, v237
    v_mov_b32 v237, v236
    v_cvt_pk_bf16_f32 v246, v248, v249
    v_permlane32_swap_b32 v168, v170
    v_permlane32_swap_b32 v169, v171
    v_rcp_f32 v170, v170
    v_permlane16_swap_b32 v236, v237
    v_mul_f32 v164, v170, v164
    v_mul_f32 v165, v170, v165
    v_cvt_pk_bf16_f32 v164, v164, v165
    v_mul_f32 v166, v170, v166
    v_mul_f32 v167, v170, v167
    v_cvt_pk_bf16_f32 v165, v166, v167
    v_mul_f32 v168, v170, v168
    v_mul_f32 v169, v170, v169
    v_cvt_pk_bf16_f32 v166, v168, v169
    v_max3_f32 v236, v236, v237, v232
    v_sub_f32 v237, v232, v236
    v_exp_f32 v237, v237
    v_mov_b32 v232, v236
    v_mul_f32 v140, v237, v140
    v_mul_f32 v141, v237, v141
    v_mul_f32 v142, v237, v142
    v_mul_f32 v143, v237, v143
    v_mul_f32 v144, v237, v144
    v_mul_f32 v145, v237, v145
    v_mul_f32 v146, v237, v146
    v_mul_f32 v147, v237, v147
    v_sub_f32 v196, v196, v232
    v_sub_f32 v197, v197, v232
    v_sub_f32 v198, v198, v232
    v_sub_f32 v199, v199, v232
    v_sub_f32 v200, v200, v232
    v_sub_f32 v201, v201, v232
    v_sub_f32 v202, v202, v232
    v_exp_f32 v196, v196
    v_exp_f32 v197, v197
    v_exp_f32 v198, v198
    v_cvt_pk_bf16_f32 v212, v196, v197
    v_exp_f32 v199, v199
    v_exp_f32 v200, v200
    v_cvt_pk_bf16_f32 v213, v198, v199
    v_mfma_f32_16x16x32_bf16 v[196:199], v[172:175], v[136:139], v[84:87]
    v_exp_f32 v201, v201
    v_exp_f32 v202, v202
    v_cvt_pk_bf16_f32 v214, v200, v201
    ds_write_b64 v99, v[164:165] offset:27648
    ds_write_b32 v107, v166 offset:29696
    ds_write_b64 v2, v[252:253] offset:37648
    v_mfma_f32_16x16x32_bf16 v[252:255], v[36:39], v[220:223], 0
    v_cvt_pk_bf16_f32 v215, v202, 0
    v_cvt_pk_bf16_f32 v247, v250, v251
    v_mfma_f32_16x16x32_bf16 v[252:255], v[40:43], v[224:227], v[252:255]
    v_max3_f32 v236, v204, v205, v206
    v_max3_f32 v236, v236, v207, v208
    v_mfma_f32_16x16x32_bf16 v[140:143], v[188:191], v[212:215], v[140:143]
    v_max3_f32 v236, v236, v209, v210
    v_mov_b32 v237, v236
    v_mfma_f32_16x16x32_bf16 v[144:147], v[192:195], v[212:215], v[144:147]
    ds_write_b128 v1, v[244:247] offset:33168
    v_mfma_f32_16x16x32_bf16 v[252:255], v[44:47], v[228:231], v[252:255]
    v_permlane32_swap_b32 v236, v237
    v_mfma_f32_16x16x32_bf16 v[200:203], v[176:179], v[136:139], v[88:91]
    v_max_f32 v236, v236, v237
    v_mov_b32 v237, v236
    s_mul_i32 s58, s39, 4
    s_add_u32 s58, s58, s54
    ds_read_b128 v[220:223], v0 offset:43008
    ds_read_b128 v[224:227], v0 offset:43072
    ds_read_b128 v[228:231], v0 offset:43136
    v_cvt_pk_bf16_f32 v252, v252, v253
    v_cvt_pk_bf16_f32 v253, v254, v255
    v_permlane16_swap_b32 v236, v237
    v_max3_f32 v236, v236, v237, v233
    v_sub_f32 v237, v233, v236
    v_exp_f32 v237, v237
    v_mov_b32 v233, v236
    v_mul_f32 v148, v237, v148
    v_mul_f32 v149, v237, v149
    v_mul_f32 v150, v237, v150
    v_mul_f32 v151, v237, v151
    v_mul_f32 v152, v237, v152
    v_mul_f32 v153, v237, v153
    v_mul_f32 v154, v237, v154
    v_mul_f32 v155, v237, v155
    v_sub_f32 v204, v204, v233
    v_sub_f32 v205, v205, v233
    v_sub_f32 v206, v206, v233
    v_sub_f32 v207, v207, v233
    v_sub_f32 v208, v208, v233
    v_sub_f32 v209, v209, v233
    v_sub_f32 v210, v210, v233
    v_exp_f32 v204, v204
    v_exp_f32 v205, v205
    v_exp_f32 v206, v206
    v_cvt_pk_bf16_f32 v216, v204, v205
    s_waitcnt lgkmcnt(2)
    v_mfma_f32_16x16x32_bf16 v[244:247], v[12:15], v[220:223], 0
    v_exp_f32 v207, v207
    v_mfma_f32_16x16x32_bf16 v[248:251], v[24:27], v[220:223], 0
    v_cvt_pk_bf16_f32 v217, v206, v207
    v_exp_f32 v208, v208
    v_mfma_f32_16x16x32_bf16 v[204:207], v[180:183], v[128:131], v[108:111]
    v_exp_f32 v209, v209
    s_waitcnt lgkmcnt(0)
    v_mfma_f32_16x16x32_bf16 v[244:247], v[16:19], v[224:227], v[244:247]
    v_cvt_pk_bf16_f32 v218, v208, v209
    v_exp_f32 v210, v210
    v_mfma_f32_16x16x32_bf16 v[244:247], v[20:23], v[228:231], v[244:247]
    v_cvt_pk_bf16_f32 v219, v210, 0
    v_max3_f32 v236, v196, v197, v198
    v_mfma_f32_16x16x32_bf16 v[208:211], v[184:187], v[128:131], v[112:115]
    v_max3_f32 v236, v236, v199, v200
    v_max3_f32 v236, v236, v201, v202
    v_mfma_f32_16x16x32_bf16 v[148:151], v[188:191], v[216:219], v[148:151]
    v_mov_b32 v237, v236
    v_mfma_f32_16x16x32_bf16 v[152:155], v[192:195], v[216:219], v[152:155]
    v_cvt_pk_bf16_f32 v244, v244, v245
    v_permlane32_swap_b32 v236, v237
    v_mfma_f32_16x16x32_bf16 v[248:251], v[28:31], v[224:227], v[248:251]
    v_max_f32 v236, v236, v237
    v_mov_b32 v237, v236
    v_mfma_f32_16x16x32_bf16 v[248:251], v[32:35], v[228:231], v[248:251]
    v_cvt_pk_bf16_f32 v245, v246, v247
    v_permlane16_swap_b32 v236, v237
    v_max_f32 v234, v236, v237
    v_sub_f32 v196, v196, v234
    v_sub_f32 v197, v197, v234
    v_sub_f32 v198, v198, v234
    v_sub_f32 v199, v199, v234
    v_sub_f32 v200, v200, v234
    v_sub_f32 v201, v201, v234
    v_sub_f32 v202, v202, v234
    ds_write_b64 v2, v[252:253] offset:37904
    v_mfma_f32_16x16x32_bf16 v[252:255], v[36:39], v[220:223], 0
    v_exp_f32 v196, v196
    v_mfma_f32_16x16x32_bf16 v[252:255], v[40:43], v[224:227], v[252:255]
    v_exp_f32 v197, v197
    v_mfma_f32_16x16x32_bf16 v[252:255], v[44:47], v[228:231], v[252:255]
    v_cvt_pk_bf16_f32 v212, v196, v197
    v_exp_f32 v198, v198
    v_exp_f32 v199, v199
    v_exp_f32 v200, v200
    v_cvt_pk_bf16_f32 v213, v198, v199
    v_mfma_f32_16x16x32_bf16 v[196:199], v[180:183], v[132:135], v[100:103]
    v_exp_f32 v201, v201
    v_exp_f32 v202, v202
    v_cvt_pk_bf16_f32 v214, v200, v201
    v_cvt_pk_bf16_f32 v215, v202, 0
    v_mfma_f32_16x16x32_bf16 v[200:203], v[184:187], v[132:135], v[104:107]
    v_max3_f32 v236, v204, v205, v206
    v_max3_f32 v236, v236, v207, v208
    v_mfma_f32_16x16x32_bf16 v[156:159], v[188:191], v[212:215], 0
    v_max3_f32 v236, v236, v209, v210
    v_mov_b32 v237, v236
    v_mfma_f32_16x16x32_bf16 v[160:163], v[192:195], v[212:215], 0
    v_cvt_pk_bf16_f32 v246, v248, v249
    v_permlane32_swap_b32 v236, v237
    v_max_f32 v236, v236, v237
    v_mov_b32 v237, v236
    ds_read_b64_tr_b16 v[188:189], v5 offset:5496
    ds_read_b64_tr_b16 v[190:191], v6 offset:5496
    ds_read_b64_tr_b16 v[192:193], v7 offset:640
    ds_read_b64_tr_b16 v[194:195], v8 offset:640
    v_permlane16_swap_b32 v236, v237
    v_max3_f32 v236, v236, v237, v232
    v_sub_f32 v237, v232, v236
    v_exp_f32 v237, v237
    v_mov_b32 v232, v236
    v_mul_f32 v140, v237, v140
    v_mul_f32 v141, v237, v141
    v_mul_f32 v142, v237, v142
    v_mul_f32 v143, v237, v143
    v_mul_f32 v144, v237, v144
    v_mul_f32 v145, v237, v145
    v_mul_f32 v146, v237, v146
    v_mul_f32 v147, v237, v147
    v_sub_f32 v204, v204, v232
    v_sub_f32 v205, v205, v232
    v_sub_f32 v206, v206, v232
    v_sub_f32 v207, v207, v232
    v_sub_f32 v208, v208, v232
    v_sub_f32 v209, v209, v232
    v_sub_f32 v210, v210, v232
    v_exp_f32 v204, v204
    v_exp_f32 v205, v205
    v_exp_f32 v206, v206
    v_cvt_pk_bf16_f32 v216, v204, v205
    v_exp_f32 v207, v207
    v_exp_f32 v208, v208
    v_cvt_pk_bf16_f32 v217, v206, v207
    v_exp_f32 v209, v209
    v_exp_f32 v210, v210
    v_cvt_pk_bf16_f32 v218, v208, v209
    v_cvt_pk_bf16_f32 v219, v210, 0
    s_waitcnt lgkmcnt(0)
    v_cvt_pk_bf16_f32 v247, v250, v251
    v_mfma_f32_16x16x32_bf16 v[140:143], v[188:191], v[216:219], v[140:143]
    v_cvt_pk_bf16_f32 v252, v252, v253
    v_cvt_pk_bf16_f32 v253, v254, v255
    v_mfma_f32_16x16x32_bf16 v[144:147], v[192:195], v[216:219], v[144:147]
    v_max3_f32 v236, v196, v197, v198
    v_max3_f32 v236, v236, v199, v200
    v_max3_f32 v236, v236, v201, v202
    v_mov_b32 v237, v236
    s_mul_i32 s59, s39, 5
    s_add_u32 s59, s59, s54
    ds_write_b128 v1, v[244:247] offset:33424
    ds_write_b64 v2, v[252:253] offset:38032
    v_permlane32_swap_b32 v144, v146
    v_permlane32_swap_b32 v145, v147
    v_rcp_f32 v146, v146
    v_permlane32_swap_b32 v236, v237
    v_mul_f32 v140, v146, v140
    v_mul_f32 v141, v146, v141
    v_cvt_pk_bf16_f32 v140, v140, v141
    v_mul_f32 v142, v146, v142
    v_mul_f32 v143, v146, v143
    v_cvt_pk_bf16_f32 v141, v142, v143
    v_mul_f32 v144, v146, v144
    v_mul_f32 v145, v146, v145
    v_cvt_pk_bf16_f32 v142, v144, v145
    v_max_f32 v236, v236, v237
    v_mov_b32 v237, v236
    ds_write_b64 v99, v[140:141] offset:33792
    ds_write_b32 v107, v142 offset:35840
    v_permlane16_swap_b32 v236, v237
    v_max3_f32 v236, v236, v237, v233
    v_sub_f32 v237, v233, v236
    v_exp_f32 v237, v237
    v_mov_b32 v233, v236
    v_mul_f32 v148, v237, v148
    v_mul_f32 v149, v237, v149
    v_mul_f32 v150, v237, v150
    v_mul_f32 v151, v237, v151
    v_mul_f32 v152, v237, v152
    v_mul_f32 v153, v237, v153
    v_mul_f32 v154, v237, v154
    v_mul_f32 v155, v237, v155
    v_sub_f32 v196, v196, v233
    v_sub_f32 v197, v197, v233
    v_sub_f32 v198, v198, v233
    v_sub_f32 v199, v199, v233
    v_sub_f32 v200, v200, v233
    v_sub_f32 v201, v201, v233
    v_sub_f32 v202, v202, v233
    v_exp_f32 v196, v196
    v_exp_f32 v197, v197
    v_exp_f32 v198, v198
    v_cvt_pk_bf16_f32 v212, v196, v197
    v_exp_f32 v199, v199
    v_exp_f32 v200, v200
    v_cvt_pk_bf16_f32 v213, v198, v199
    v_exp_f32 v201, v201
    v_exp_f32 v202, v202
    v_cvt_pk_bf16_f32 v214, v200, v201
    v_cvt_pk_bf16_f32 v215, v202, 0
    s_nop 1
    v_mfma_f32_16x16x32_bf16 v[148:151], v[188:191], v[212:215], v[148:151]
    s_waitcnt lgkmcnt(0)
    s_barrier
    ds_read_b128 v[172:175], v3 offset:32512
    ds_read_b128 v[176:179], v4 offset:32512
    s_mul_i32 s60, s39, 6
    s_add_u32 s60, s60, s54
    ds_read_b128 v[220:223], v10 offset:30720
    ds_read_b128 v[224:227], v10 offset:31744
    v_mfma_f32_16x16x32_bf16 v[152:155], v[192:195], v[212:215], v[152:155]
    v_mfma_f32_16x16x32_bf16 v[204:207], v[180:183], v[136:139], v[92:95]
    v_mfma_f32_16x16x32_bf16 v[208:211], v[184:187], v[136:139], v[96:99]
    ds_read_b128 v[228:231], v10 offset:32768
    s_waitcnt lgkmcnt(4)
    v_mfma_f32_16x16x32_bf16 v[196:199], v[172:175], v[132:135], v[108:111]
    ds_read_b128 v[180:183], v3 offset:33152
    s_waitcnt lgkmcnt(4)
    v_mfma_f32_16x16x32_bf16 v[200:203], v[176:179], v[132:135], v[112:115]
    ds_read_b128 v[184:187], v4 offset:33152
    v_max3_f32 v236, v204, v205, v206
    v_max3_f32 v236, v236, v207, v208
    s_waitcnt lgkmcnt(4)
    v_mfma_f32_16x16x32_bf16 v[244:247], v[48:51], v[220:223], 0
    s_waitcnt lgkmcnt(3)
    v_mfma_f32_16x16x32_bf16 v[244:247], v[52:55], v[224:227], v[244:247]
    v_mfma_f32_16x16x32_bf16 v[248:251], v[60:63], v[220:223], 0
    s_waitcnt lgkmcnt(2)
    v_max3_f32 v236, v236, v209, v210
    v_mfma_f32_16x16x32_bf16 v[244:247], v[56:59], v[228:231], v[244:247]
    v_mfma_f32_16x16x32_bf16 v[248:251], v[64:67], v[224:227], v[248:251]
    v_mov_b32 v237, v236
    v_mfma_f32_16x16x32_bf16 v[248:251], v[68:71], v[228:231], v[248:251]
    v_mfma_f32_16x16x32_bf16 v[252:255], v[72:75], v[220:223], 0
    v_mfma_f32_16x16x32_bf16 v[252:255], v[76:79], v[224:227], v[252:255]
    v_mfma_f32_16x16x32_bf16 v[252:255], v[80:83], v[228:231], v[252:255]
    v_permlane32_swap_b32 v236, v237
    v_max_f32 v236, v236, v237
    v_cvt_pk_bf16_f32 v244, v244, v245
    v_cvt_pk_bf16_f32 v245, v246, v247
    v_mov_b32 v237, v236
    v_cvt_pk_bf16_f32 v246, v248, v249
    v_cvt_pk_bf16_f32 v247, v250, v251
    buffer_store_dwordx4 v[244:247], v115, s[28:31], s58 offen
    v_cvt_pk_bf16_f32 v252, v252, v253
    v_cvt_pk_bf16_f32 v253, v254, v255
    buffer_store_dwordx2 v[252:253], v11, s[28:31], s58 offen offset:64
    v_permlane16_swap_b32 v236, v237
    v_max3_f32 v236, v236, v237, v234
    v_sub_f32 v237, v234, v236
    v_exp_f32 v237, v237
    v_mov_b32 v234, v236
    v_mul_f32 v156, v237, v156
    v_mul_f32 v157, v237, v157
    v_mul_f32 v158, v237, v158
    v_mul_f32 v159, v237, v159
    v_mul_f32 v160, v237, v160
    v_mul_f32 v161, v237, v161
    v_mul_f32 v162, v237, v162
    v_mul_f32 v163, v237, v163
    v_sub_f32 v204, v204, v234
    v_sub_f32 v205, v205, v234
    v_sub_f32 v206, v206, v234
    v_sub_f32 v207, v207, v234
    v_sub_f32 v208, v208, v234
    v_sub_f32 v209, v209, v234
    v_sub_f32 v210, v210, v234
    v_exp_f32 v204, v204
    v_exp_f32 v205, v205
    v_exp_f32 v206, v206
    v_cvt_pk_bf16_f32 v216, v204, v205
    v_exp_f32 v207, v207
    v_exp_f32 v208, v208
    v_cvt_pk_bf16_f32 v217, v206, v207
    v_exp_f32 v209, v209
    v_exp_f32 v210, v210
    v_cvt_pk_bf16_f32 v218, v208, v209
    v_cvt_pk_bf16_f32 v219, v210, 0
    v_max3_f32 v236, v196, v197, v198
    v_max3_f32 v236, v236, v199, v200
    v_mfma_f32_16x16x32_bf16 v[156:159], v[188:191], v[216:219], v[156:159]
    v_max3_f32 v236, v236, v201, v202
    v_mov_b32 v237, v236
    v_mfma_f32_16x16x32_bf16 v[160:163], v[192:195], v[216:219], v[160:163]
    ds_read_b64_tr_b16 v[188:189], v5 offset:37576
    ds_read_b64_tr_b16 v[190:191], v6 offset:37576
    ds_read_b64_tr_b16 v[192:193], v7 offset:32400
    ds_read_b64_tr_b16 v[194:195], v8 offset:32400
    v_permlane32_swap_b32 v236, v237
    v_max_f32 v236, v236, v237
    v_mov_b32 v237, v236
    s_nop 1
    v_permlane16_swap_b32 v236, v237
    v_max3_f32 v236, v236, v237, v233
    v_sub_f32 v237, v233, v236
    v_exp_f32 v237, v237
    v_mov_b32 v233, v236
    v_mul_f32 v148, v237, v148
    v_mul_f32 v149, v237, v149
    v_mul_f32 v150, v237, v150
    v_mul_f32 v151, v237, v151
    v_mul_f32 v152, v237, v152
    v_mul_f32 v153, v237, v153
    v_mul_f32 v154, v237, v154
    v_mul_f32 v155, v237, v155
    v_sub_f32 v196, v196, v233
    v_sub_f32 v197, v197, v233
    v_sub_f32 v198, v198, v233
    v_sub_f32 v199, v199, v233
    v_sub_f32 v200, v200, v233
    v_sub_f32 v201, v201, v233
    v_sub_f32 v202, v202, v233
    v_exp_f32 v196, v196
    v_exp_f32 v197, v197
    v_exp_f32 v198, v198
    v_cvt_pk_bf16_f32 v212, v196, v197
    v_exp_f32 v199, v199
    v_exp_f32 v200, v200
    v_cvt_pk_bf16_f32 v213, v198, v199
    s_waitcnt lgkmcnt(0)
    v_mfma_f32_16x16x32_bf16 v[196:199], v[180:183], v[136:139], v[108:111]
    v_exp_f32 v201, v201
    v_exp_f32 v202, v202
    v_cvt_pk_bf16_f32 v214, v200, v201
    v_cvt_pk_bf16_f32 v215, v202, 0
    v_mfma_f32_16x16x32_bf16 v[200:203], v[184:187], v[136:139], v[112:115]
    s_nop 0
    v_mfma_f32_16x16x32_bf16 v[148:151], v[188:191], v[212:215], v[148:151]
    v_mfma_f32_16x16x32_bf16 v[152:155], v[192:195], v[212:215], v[152:155]
    s_nop 7
    v_permlane32_swap_b32 v152, v154
    v_permlane32_swap_b32 v153, v155
    v_rcp_f32 v154, v154
    s_nop 0
    v_mul_f32 v148, v154, v148
    v_mul_f32 v149, v154, v149
    v_cvt_pk_bf16_f32 v148, v148, v149
    v_mul_f32 v150, v154, v150
    v_mul_f32 v151, v154, v151
    v_cvt_pk_bf16_f32 v149, v150, v151
    v_mul_f32 v152, v154, v152
    v_mul_f32 v153, v154, v153
    v_cvt_pk_bf16_f32 v150, v152, v153
    ds_write_b64 v99, v[148:149] offset:39936
    ds_write_b32 v107, v150 offset:41984
    s_waitcnt lgkmcnt(0)
    s_barrier
    ds_read_b128 v[220:223], v10 offset:36864
    ds_read_b128 v[224:227], v10 offset:37888
    ds_read_b128 v[228:231], v10 offset:38912
    v_mfma_f32_16x16x32_bf16 v[204:207], v[172:175], v[136:139], v[100:103]
    v_mfma_f32_16x16x32_bf16 v[208:211], v[176:179], v[136:139], v[104:107]
    s_nop 6
    v_max3_f32 v236, v204, v205, v206
    v_max3_f32 v236, v236, v207, v208
    s_waitcnt lgkmcnt(2)
    v_mfma_f32_16x16x32_bf16 v[244:247], v[48:51], v[220:223], 0
    s_waitcnt lgkmcnt(1)
    v_mfma_f32_16x16x32_bf16 v[244:247], v[52:55], v[224:227], v[244:247]
    v_max3_f32 v236, v236, v209, v210
    v_mov_b32 v237, v236
    s_waitcnt lgkmcnt(0)
    v_mfma_f32_16x16x32_bf16 v[244:247], v[56:59], v[228:231], v[244:247]
    v_permlane32_swap_b32 v236, v237
    v_mfma_f32_16x16x32_bf16 v[248:251], v[60:63], v[220:223], 0
    v_mfma_f32_16x16x32_bf16 v[248:251], v[64:67], v[224:227], v[248:251]
    v_mfma_f32_16x16x32_bf16 v[248:251], v[68:71], v[228:231], v[248:251]
    v_max_f32 v236, v236, v237
    v_mov_b32 v237, v236
    s_nop 1
    v_permlane16_swap_b32 v236, v237
    v_max3_f32 v236, v236, v237, v234
    v_sub_f32 v237, v234, v236
    v_exp_f32 v237, v237
    v_mov_b32 v234, v236
    v_mul_f32 v156, v237, v156
    v_mul_f32 v157, v237, v157
    v_mul_f32 v158, v237, v158
    v_mul_f32 v159, v237, v159
    v_mul_f32 v160, v237, v160
    v_mul_f32 v161, v237, v161
    v_mul_f32 v162, v237, v162
    v_mul_f32 v163, v237, v163
    v_sub_f32 v204, v204, v234
    v_sub_f32 v205, v205, v234
    v_sub_f32 v206, v206, v234
    v_sub_f32 v207, v207, v234
    v_sub_f32 v208, v208, v234
    v_sub_f32 v209, v209, v234
    v_sub_f32 v210, v210, v234
    v_exp_f32 v204, v204
    v_exp_f32 v205, v205
    v_exp_f32 v206, v206
    v_cvt_pk_bf16_f32 v216, v204, v205
    v_exp_f32 v207, v207
    v_exp_f32 v208, v208
    v_cvt_pk_bf16_f32 v217, v206, v207
    v_exp_f32 v209, v209
    v_exp_f32 v210, v210
    v_cvt_pk_bf16_f32 v218, v208, v209
    v_cvt_pk_bf16_f32 v219, v210, 0
    v_cvt_pk_bf16_f32 v244, v244, v245
    v_cvt_pk_bf16_f32 v245, v246, v247
    v_mfma_f32_16x16x32_bf16 v[156:159], v[188:191], v[216:219], v[156:159]
    v_cvt_pk_bf16_f32 v246, v248, v249
    v_cvt_pk_bf16_f32 v247, v250, v251
    v_mfma_f32_16x16x32_bf16 v[160:163], v[192:195], v[216:219], v[160:163]
    buffer_store_dwordx4 v[244:247], v115, s[28:31], s59 offen
    ds_read_b64_tr_b16 v[188:189], v5 offset:37896
    ds_read_b64_tr_b16 v[190:191], v6 offset:37896
    ds_read_b64_tr_b16 v[192:193], v7 offset:33040
    ds_read_b64_tr_b16 v[194:195], v8 offset:33040
    v_max3_f32 v236, v196, v197, v198
    v_max3_f32 v236, v236, v199, v200
    v_max3_f32 v236, v236, v201, v202
    v_mov_b32 v237, v236
    s_nop 1
    v_permlane32_swap_b32 v236, v237
    v_max_f32 v236, v236, v237
    v_mov_b32 v237, v236
    s_nop 1
    v_permlane16_swap_b32 v236, v237
    v_max3_f32 v236, v236, v237, v234
    v_sub_f32 v237, v234, v236
    v_exp_f32 v237, v237
    v_mov_b32 v234, v236
    v_mul_f32 v156, v237, v156
    v_mul_f32 v157, v237, v157
    v_mul_f32 v158, v237, v158
    v_mul_f32 v159, v237, v159
    v_mul_f32 v160, v237, v160
    v_mul_f32 v161, v237, v161
    v_mul_f32 v162, v237, v162
    v_mul_f32 v163, v237, v163
    v_sub_f32 v196, v196, v234
    v_sub_f32 v197, v197, v234
    v_sub_f32 v198, v198, v234
    v_sub_f32 v199, v199, v234
    v_sub_f32 v200, v200, v234
    v_sub_f32 v201, v201, v234
    v_sub_f32 v202, v202, v234
    v_exp_f32 v196, v196
    v_exp_f32 v197, v197
    v_exp_f32 v198, v198
    v_cvt_pk_bf16_f32 v212, v196, v197
    v_exp_f32 v199, v199
    v_exp_f32 v200, v200
    v_cvt_pk_bf16_f32 v213, v198, v199
    v_exp_f32 v201, v201
    v_exp_f32 v202, v202
    v_cvt_pk_bf16_f32 v214, v200, v201
    v_cvt_pk_bf16_f32 v215, v202, 0
    s_waitcnt lgkmcnt(0)
    s_nop 0
    v_mfma_f32_16x16x32_bf16 v[156:159], v[188:191], v[212:215], v[156:159]
    v_mfma_f32_16x16x32_bf16 v[160:163], v[192:195], v[212:215], v[160:163]
    s_nop 7
    v_permlane32_swap_b32 v160, v162
    v_permlane32_swap_b32 v161, v163
    v_rcp_f32 v162, v162
    s_nop 0
    v_mul_f32 v156, v162, v156
    v_mul_f32 v157, v162, v157
    v_cvt_pk_bf16_f32 v156, v156, v157
    v_mul_f32 v158, v162, v158
    v_mul_f32 v159, v162, v159
    v_cvt_pk_bf16_f32 v157, v158, v159
    v_mul_f32 v160, v162, v160
    v_mul_f32 v161, v162, v161
    v_cvt_pk_bf16_f32 v158, v160, v161
    ds_write_b64 v99, v[156:157] offset:46080
    ds_write_b32 v107, v158 offset:48128
    s_waitcnt lgkmcnt(0)
    s_barrier
    ds_read_b128 v[220:223], v10 offset:43008
    ds_read_b128 v[224:227], v10 offset:44032
    ds_read_b128 v[228:231], v10 offset:45056
    s_waitcnt lgkmcnt(2)
    v_mfma_f32_16x16x32_bf16 v[252:255], v[72:75], v[220:223], 0
    s_waitcnt lgkmcnt(0)
    v_mfma_f32_16x16x32_bf16 v[252:255], v[76:79], v[224:227], v[252:255]
    v_mfma_f32_16x16x32_bf16 v[252:255], v[80:83], v[228:231], v[252:255]
    s_nop 7
    v_cvt_pk_bf16_f32 v252, v252, v253
    v_cvt_pk_bf16_f32 v253, v254, v255
    buffer_store_dwordx2 v[252:253], v11, s[28:31], s60 offen offset:64
L_fin:
L_end:
    s_endpgm
.section .rodata,"a"
.p2align 6
.amdhsa_kernel standalone__neighborhood_dinat__vision_kernel
  .amdhsa_next_free_vgpr 256
  .amdhsa_next_free_sgpr 96
  .amdhsa_accum_offset 256
  .amdhsa_group_segment_fixed_size 0
  .amdhsa_kernarg_size 56
  .amdhsa_user_sgpr_count 2
  .amdhsa_user_sgpr_kernarg_segment_ptr 1
  .amdhsa_system_sgpr_workgroup_id_x 1
.end_amdhsa_kernel
```
